```python
import torch

def _softmax(x, axis=-1):
    return torch.softmax(x, dim=axis)

def _gelu(x):
    return torch.nn.functional.gelu(x, approximate='tanh')

def _silu(x):
    return torch.nn.functional.silu(x)

def _sigmoid(x):
    return torch.sigmoid(x)

def _layernorm(x, axis=-1, eps=1e-05):
    m = x.mean(dim=axis, keepdim=True)
    v = x.var(dim=axis, keepdim=True, unbiased=False)
    return (x - m) / torch.sqrt(v + eps)

def _scatter_add(tgt, idx, src, axis=0):
    return tgt.clone().index_add_(axis, idx, src)

def _segment_sum(src, seg, n):
    out = torch.zeros((n,) + src.shape[1:], dtype=src.dtype)
    return out.index_add_(0, seg, src)

def _pad(x, pw):
    flat = tuple((v for pair in reversed(pw) for v in pair))
    return torch.nn.functional.pad(x, flat)
kernel_name = 'standalone__memory_aug_recurrent_mem_tr__prompt'

def setup_inputs():

    _w = lambda a: (lambda t: t.to(torch.bfloat16) if t.is_floating_point() else t)(torch.as_tensor(a))
    B, S, Dm = (1, 2048, 640)
    H, Dh = (32, 128)
    M, seg = (8, 32)
    seg = min(seg, S)
    S = S // seg * seg
    return {'x': _w((lambda *s: torch.randn(*s, dtype=torch.bfloat16) * 0.05)(B, S, Dm)), 'mem0': _w((lambda *s: torch.randn(*s, dtype=torch.bfloat16) * 0.4)(B, M, Dm)), 'Wq': _w((lambda *s: torch.randn(*s, dtype=torch.bfloat16) * 6.4)(Dm, H, Dh) * Dm ** (-0.5)), 'Wk': _w((lambda *s: torch.randn(*s, dtype=torch.bfloat16) * 6.4)(Dm, H, Dh) * Dm ** (-0.5)), 'Wv': _w((lambda *s: torch.randn(*s, dtype=torch.bfloat16) * 0.4)(Dm, H, Dh) * Dm ** (-0.5)), 'Wo': _w((lambda *s: torch.randn(*s, dtype=torch.bfloat16) * 0.4)(H, Dh, Dm) * (H * Dh) ** (-0.5)), 'seg_len': seg}

def reference(x, mem0, Wq, Wk, Wv, Wo, seg_len):
    B, S, Dm = x.shape
    H, Dh = (Wq.shape[1], Wq.shape[2])
    M = mem0.shape[1]
    scale = Dh ** (-0.5)
    n_seg = S // seg_len
    L = M + seg_len
    idx = torch.arange(L)
    mask = (idx[:, None] < M) | (idx[:, None] >= idx[None, :])
    mem = mem0
    outs = []
    for s in range(n_seg):
        xs = x[:, s * seg_len:(s + 1) * seg_len, :].clone()
        h = torch.concatenate([mem, xs], axis=1)
        q = torch.einsum('btd,dhe->bhte', h, Wq)
        k = torch.einsum('btd,dhe->bhte', h, Wk)
        v = torch.einsum('btd,dhe->bhte', h, Wv)
        scores = torch.einsum('bhqe,bhke->bhqk', q, k) * scale
        scores = torch.where(mask[None, None], scores, -1000000000.0)
        p = _softmax(scores, axis=-1)
        o = torch.einsum('bhqk,bhke->bhqe', p, v)
        o = torch.einsum('bhte,hed->btd', o, Wo)
        mem = o[:, :M, :].clone()
        outs.append(o[:, M:, :])
    return torch.concatenate(outs, axis=1)
```

```asm
; @launch grid=(256,1,1) block=(256,1,1) lds=163840
.amdgcn_target "amdgcn-amd-amdhsa--gfx950"
.text
.globl standalone__memory_aug_recurrent_mem_tr__prompt_kernel
.p2align 8
.type standalone__memory_aug_recurrent_mem_tr__prompt_kernel,@function
standalone__memory_aug_recurrent_mem_tr__prompt_kernel:
  s_cmp_ge_u32 s2, 256
  s_cbranch_scc1 L_end
  s_load_dwordx16 s[64:79], s[0:1], 0
  s_load_dwordx4 s[80:83], s[0:1], 64
  s_getpc_b64 s[4:5]
L_pc:
  v_lshlrev_b32 v4, 7, v0
  s_mov_b32 s6, L_end-L_pc
  v_min_u32 v5, s6, v4
  global_load_dword v6, v5, s[4:5]
  v_add_u32 v4, 0x8000, v4
  v_min_u32 v5, s6, v4
  global_load_dword v6, v5, s[4:5]
  v_lshrrev_b32 v2, 6, v0
  v_and_b32 v1, 63, v0
  v_mov_b32 v3, 0
  v_readfirstlane_b32 s44, v2
  s_waitcnt lgkmcnt(0)
  s_mov_b32 s8, s64
  s_and_b32 s9, s65, 0xffff
  s_mov_b32 s10, 2621440
  s_mov_b32 s11, 0x20000
  s_mov_b32 s12, s66
  s_and_b32 s13, s67, 0xffff
  s_mov_b32 s14, 10240
  s_mov_b32 s15, 0x20000
  s_mov_b32 s16, s68
  s_and_b32 s17, s69, 0xffff
  s_mov_b32 s18, 5242880
  s_mov_b32 s19, 0x20000
  s_mov_b32 s20, s70
  s_and_b32 s21, s71, 0xffff
  s_mov_b32 s22, 5242880
  s_mov_b32 s23, 0x20000
  s_mov_b32 s24, s72
  s_and_b32 s25, s73, 0xffff
  s_mov_b32 s26, 5242880
  s_mov_b32 s27, 0x20000
  s_mov_b32 s28, s74
  s_and_b32 s29, s75, 0xffff
  s_mov_b32 s30, 5242880
  s_mov_b32 s31, 0x20000
  s_mov_b32 s32, s78
  s_and_b32 s33, s79, 0xffff
  s_mov_b32 s34, 2621440
  s_mov_b32 s35, 0x20000
  s_mov_b32 s36, s80
  s_and_b32 s37, s81, 0xffff
  s_mov_b32 s38, 256
  s_mov_b32 s39, 0x20000
  s_mov_b32 s40, s82
  s_and_b32 s41, s83, 0xffff
  s_mov_b32 s42, 268435456
  s_mov_b32 s43, 0x20000
  s_cmp_lg_u32 s44, 0
  s_cbranch_scc1 L_role_wait
  s_mov_b64 exec, 1
  s_getreg_b32 s46, hwreg(HW_REG_XCC_ID, 0, 4)
  s_and_b32 s46, s46, 7
  s_lshl_b32 s47, s46, 2
  v_mov_b32 v4, 1
  v_mov_b32 v5, 1
  buffer_atomic_add v4, v3, s[36:39], s47 offen sc0
  s_waitcnt vmcnt(0)
  s_lshl_b32 s47, s46, 5
  v_cmp_gt_u32 vcc, 32, v4
  v_add_u32 v4, s47, v4
  s_cbranch_vccnz L_role_pub
  v_mov_b32 v6, 1
  buffer_atomic_add v6, v3, s[36:39], 0 offen offset:36 sc0
  s_mov_b32 s47, 262144
L_ovf_1:
  buffer_load_dwordx4 v[8:11], v3, s[36:39], 0 offen sc1
  buffer_load_dwordx4 v[12:15], v3, s[36:39], 0 offen offset:16 sc1
  s_waitcnt vmcnt(0)
  s_sub_u32 s47, s47, 1
  s_cbranch_scc1 L_abort
  v_add3_u32 v4, v8, v9, v10
  v_add3_u32 v4, v4, v11, v12
  v_add3_u32 v4, v4, v13, v14
  v_add_u32 v4, v4, v15
  v_cmp_gt_u32 vcc, 256, v4
  s_cbranch_vccnz L_ovf_1
  v_mov_b32 v4, 0
  v_min_u32 v16, 32, v8
  v_sub_u32 v17, 32, v16
  v_add_u32 v18, v16, v6
  v_add_u32 v18, 0, v18
  v_cmp_lt_u32 vcc, v6, v17
  s_nop 1
  v_cndmask_b32 v4, v4, v18, vcc
  v_sub_u32 v6, v6, v17
  v_min_u32 v16, 32, v9
  v_sub_u32 v17, 32, v16
  v_add_u32 v18, v16, v6
  v_add_u32 v18, 32, v18
  v_cmp_lt_u32 vcc, v6, v17
  s_nop 1
  v_cndmask_b32 v4, v4, v18, vcc
  v_sub_u32 v6, v6, v17
  v_min_u32 v16, 32, v10
  v_sub_u32 v17, 32, v16
  v_add_u32 v18, v16, v6
  v_add_u32 v18, 64, v18
  v_cmp_lt_u32 vcc, v6, v17
  s_nop 1
  v_cndmask_b32 v4, v4, v18, vcc
  v_sub_u32 v6, v6, v17
  v_min_u32 v16, 32, v11
  v_sub_u32 v17, 32, v16
  v_add_u32 v18, v16, v6
  v_add_u32 v18, 96, v18
  v_cmp_lt_u32 vcc, v6, v17
  s_nop 1
  v_cndmask_b32 v4, v4, v18, vcc
  v_sub_u32 v6, v6, v17
  v_min_u32 v16, 32, v12
  v_sub_u32 v17, 32, v16
  v_add_u32 v18, v16, v6
  v_add_u32 v18, 128, v18
  v_cmp_lt_u32 vcc, v6, v17
  s_nop 1
  v_cndmask_b32 v4, v4, v18, vcc
  v_sub_u32 v6, v6, v17
  v_min_u32 v16, 32, v13
  v_sub_u32 v17, 32, v16
  v_add_u32 v18, v16, v6
  v_add_u32 v18, 160, v18
  v_cmp_lt_u32 vcc, v6, v17
  s_nop 1
  v_cndmask_b32 v4, v4, v18, vcc
  v_sub_u32 v6, v6, v17
  v_min_u32 v16, 32, v14
  v_sub_u32 v17, 32, v16
  v_add_u32 v18, v16, v6
  v_add_u32 v18, 192, v18
  v_cmp_lt_u32 vcc, v6, v17
  s_nop 1
  v_cndmask_b32 v4, v4, v18, vcc
  v_sub_u32 v6, v6, v17
  v_min_u32 v16, 32, v15
  v_sub_u32 v17, 32, v16
  v_add_u32 v18, v16, v6
  v_add_u32 v18, 224, v18
  v_cmp_lt_u32 vcc, v6, v17
  s_nop 1
  v_cndmask_b32 v4, v4, v18, vcc
  v_sub_u32 v6, v6, v17
L_role_pub:
  ds_write_b32 v3, v4
  s_waitcnt lgkmcnt(0)
  s_mov_b64 exec, -1
L_role_wait:
  s_barrier
  ds_read_b32 v4, v3
  s_waitcnt vmcnt(0) lgkmcnt(0)
  v_readfirstlane_b32 s45, v4
  s_barrier
  s_and_b32 s45, s45, 255
  s_cmp_lt_u32 s45, 32
  s_cbranch_scc1 L_chain
  s_cmp_lt_u32 s45, 64
  s_cbranch_scc1 L_helper
  s_branch L_worker
L_worker:
  s_sub_u32 s48, s45, 64
  s_lshr_b32 s62, s48, 6
  s_add_u32 s62, s62, 1
  s_cmp_eq_u32 s62, 3
  s_cselect_b32 s62, 0, s62
  s_mov_b32 s57, 0
  v_and_b32 v4, 15, v1
  v_lshrrev_b32 v5, 4, v1
  v_lshlrev_b32 v16, 4, v1
  v_mul_u32_u24 v8, 1280, v4
  v_lshl_add_u32 v8, v5, 4, v8
  s_mul_i32 s46, s44, 40960
  v_add_u32 v8, s46, v8
  v_lshrrev_b32 v6, 2, v1
  v_and_b32 v7, 3, v1
  v_lshrrev_b32 v17, 5, v1
  v_lshlrev_b32 v17, 1, v17
  v_xor_b32 v7, v7, v17
  v_lshlrev_b32 v9, 13, v6
  v_lshl_add_u32 v9, v7, 4, v9
  s_lshl_b32 s46, s44, 6
  v_add_u32 v9, s46, v9
  v_mov_b32 v10, v16
  v_add_u32 v11, 0x10000, v16
  v_lshrrev_b32 v6, 2, v4
  v_lshl_add_u32 v6, v5, 3, v6
  v_lshlrev_b32 v6, 6, v6
  v_and_b32 v7, 3, v1
  v_lshl_add_u32 v6, v7, 3, v6
  s_mul_i32 s46, s44, 6144
  s_add_u32 s46, s46, 8192
  v_add_u32 v6, s46, v6
  v_and_b32 v7, 1, v5
  v_lshl_add_u32 v12, v7, 5, v6
  v_xor_b32 v7, 1, v7
  v_lshl_add_u32 v14, v7, 5, v6
  v_add_u32 v13, 0x10000, v12
  v_add_u32 v15, 0x10000, v14
  s_lshl_b32 s54, s44, 11
  s_mul_i32 s55, s44, 6144
  s_add_u32 s55, s55, 8192
  s_lshl_b32 s46, s48, 2
  s_add_u32 s46, s46, s44
  s_lshl_b32 s46, s46, 13
  v_lshlrev_b32 v18, 7, v1
  s_cmp_ge_u32 s48, 128
  s_cbranch_scc1 L_gemm_task
  s_lshr_b32 s50, s48, 5
  s_lshl_b32 s50, s50, 3
  s_and_b32 s46, s48, 7
  s_add_u32 s50, s50, s46
  s_bfe_u32 s51, s48, 0x20003
  s_lshl_b32 s46, s51, 1
  s_and_b32 s47, s44, 1
  s_add_u32 s46, s46, s47
  s_mul_i32 s52, s46, 20480
  s_lshr_b32 s47, s44, 1
  s_lshl_b32 s46, s47, 6
  s_add_u32 s52, s52, s46
  s_lshl_b32 s53, s50, 8
  s_lshl_b32 s58, s44, 10
  v_and_b32 v4, 15, v1
  v_lshrrev_b32 v5, 4, v1
  v_mul_u32_u24 v20, 1280, v4
  v_lshl_add_u32 v20, v5, 4, v20
  s_lshl_b32 s46, s47, 2
  v_or_b32 v6, s46, v5
  v_lshlrev_b32 v6, 1, v6
  v_xor_b32 v6, v6, v4
  s_lshl_b32 s46, s44, 2
  v_add_u32 v7, s46, v5
  v_lshlrev_b32 v21, 13, v7
  v_lshl_add_u32 v21, v6, 4, v21
  v_lshrrev_b32 v6, 2, v4
  v_lshl_add_u32 v7, v5, 3, v6
  v_lshlrev_b32 v7, 8, v7
  v_and_b32 v25, 3, v1
  v_lshl_add_u32 v7, v25, 3, v7
  v_and_b32 v25, 1, v5
  v_lshl_add_u32 v6, v25, 2, v6
  s_lshl_b32 s46, s44, 1
  v_xor_b32 v6, s46, v6
  v_lshl_add_u32 v22, v6, 5, v7
  v_xor_b32 v6, 1, v6
  v_lshl_add_u32 v23, v6, 5, v7
  s_add_u32 m0, s58, 0
  s_add_u32 s56, s52, 0
  buffer_load_dwordx4 v20, s[8:11], s56 offen lds
  s_add_u32 m0, s58, 4096
  s_add_u32 s56, s53, 0
  buffer_load_dwordx4 v21, s[20:23], s56 offen lds
  s_add_u32 m0, s58, 8192
  s_add_u32 s56, s53, 131072
  buffer_load_dwordx4 v21, s[20:23], s56 offen lds
  s_add_u32 m0, s58, 12288
  s_add_u32 s56, s53, 262144
  buffer_load_dwordx4 v21, s[20:23], s56 offen lds
  s_add_u32 m0, s58, 16384
  s_add_u32 s56, s53, 393216
  buffer_load_dwordx4 v21, s[20:23], s56 offen lds
  s_add_u32 m0, s58, 20480
  s_add_u32 s56, s53, 0
  buffer_load_dwordx4 v21, s[24:27], s56 offen lds
  s_add_u32 m0, s58, 24576
  s_add_u32 s56, s53, 131072
  buffer_load_dwordx4 v21, s[24:27], s56 offen lds
  s_add_u32 m0, s58, 28672
  s_add_u32 s56, s53, 262144
  buffer_load_dwordx4 v21, s[24:27], s56 offen lds
  s_add_u32 m0, s58, 32768
  s_add_u32 s56, s53, 393216
  buffer_load_dwordx4 v21, s[24:27], s56 offen lds
  s_add_u32 m0, s58, 36864
  s_add_u32 s56, s52, 128
  buffer_load_dwordx4 v20, s[8:11], s56 offen lds
  s_add_u32 m0, s58, 40960
  s_add_u32 s56, s53, 524288
  buffer_load_dwordx4 v21, s[20:23], s56 offen lds
  s_add_u32 m0, s58, 45056
  s_add_u32 s56, s53, 655360
  buffer_load_dwordx4 v21, s[20:23], s56 offen lds
  s_add_u32 m0, s58, 49152
  s_add_u32 s56, s53, 786432
  buffer_load_dwordx4 v21, s[20:23], s56 offen lds
  s_add_u32 m0, s58, 53248
  s_add_u32 s56, s53, 917504
  buffer_load_dwordx4 v21, s[20:23], s56 offen lds
  s_add_u32 m0, s58, 57344
  s_add_u32 s56, s53, 524288
  buffer_load_dwordx4 v21, s[24:27], s56 offen lds
  s_add_u32 m0, s58, 61440
  s_add_u32 s56, s53, 655360
  buffer_load_dwordx4 v21, s[24:27], s56 offen lds
  s_add_u32 m0, s58, 65536
  s_add_u32 s56, s53, 786432
  buffer_load_dwordx4 v21, s[24:27], s56 offen lds
  s_add_u32 m0, s58, 69632
  s_add_u32 s56, s53, 917504
  buffer_load_dwordx4 v21, s[24:27], s56 offen lds
  s_add_u32 m0, s58, 73728
  s_add_u32 s56, s52, 256
  buffer_load_dwordx4 v20, s[8:11], s56 offen lds
  s_add_u32 m0, s58, 77824
  s_add_u32 s56, s53, 1048576
  buffer_load_dwordx4 v21, s[20:23], s56 offen lds
  s_add_u32 m0, s58, 81920
  s_add_u32 s56, s53, 1179648
  buffer_load_dwordx4 v21, s[20:23], s56 offen lds
  s_add_u32 m0, s58, 86016
  s_add_u32 s56, s53, 1310720
  buffer_load_dwordx4 v21, s[20:23], s56 offen lds
  s_add_u32 m0, s58, 90112
  s_add_u32 s56, s53, 1441792
  buffer_load_dwordx4 v21, s[20:23], s56 offen lds
  s_add_u32 m0, s58, 94208
  s_add_u32 s56, s53, 1048576
  buffer_load_dwordx4 v21, s[24:27], s56 offen lds
  s_add_u32 m0, s58, 98304
  s_add_u32 s56, s53, 1179648
  buffer_load_dwordx4 v21, s[24:27], s56 offen lds
  s_add_u32 m0, s58, 102400
  s_add_u32 s56, s53, 1310720
  buffer_load_dwordx4 v21, s[24:27], s56 offen lds
  s_add_u32 m0, s58, 106496
  s_add_u32 s56, s53, 1441792
  buffer_load_dwordx4 v21, s[24:27], s56 offen lds
  s_waitcnt vmcnt(18)
  s_barrier
  s_add_u32 m0, s58, 110592
  s_add_u32 s56, s52, 384
  buffer_load_dwordx4 v20, s[8:11], s56 offen lds
  s_add_u32 m0, s58, 114688
  s_add_u32 s56, s53, 1572864
  buffer_load_dwordx4 v21, s[20:23], s56 offen lds
  s_add_u32 m0, s58, 118784
  s_add_u32 s56, s53, 1703936
  buffer_load_dwordx4 v21, s[20:23], s56 offen lds
  s_add_u32 m0, s58, 122880
  s_add_u32 s56, s53, 1835008
  buffer_load_dwordx4 v21, s[20:23], s56 offen lds
  s_add_u32 m0, s58, 126976
  s_add_u32 s56, s53, 1966080
  buffer_load_dwordx4 v21, s[20:23], s56 offen lds
  s_add_u32 m0, s58, 131072
  s_add_u32 s56, s53, 1572864
  buffer_load_dwordx4 v21, s[24:27], s56 offen lds
  s_add_u32 m0, s58, 135168
  s_add_u32 s56, s53, 1703936
  buffer_load_dwordx4 v21, s[24:27], s56 offen lds
  s_add_u32 m0, s58, 139264
  s_add_u32 s56, s53, 1835008
  buffer_load_dwordx4 v21, s[24:27], s56 offen lds
  s_add_u32 m0, s58, 143360
  s_add_u32 s56, s53, 1966080
  buffer_load_dwordx4 v21, s[24:27], s56 offen lds
  v_add_u32 v24, 0, v16
  v_add_u32 v26, 4096, v22
  v_add_u32 v27, 4096, v23
  ds_read_b128 v[32:35], v24 offset:0
  ds_read_b128 v[36:39], v24 offset:1024
  ds_read_b128 v[40:43], v24 offset:2048
  ds_read_b128 v[44:47], v24 offset:3072
  ds_read_b64_tr_b16 v[48:49], v26 offset:0
  ds_read_b64_tr_b16 v[50:51], v26 offset:1024
  ds_read_b64_tr_b16 v[52:53], v27 offset:0
  ds_read_b64_tr_b16 v[54:55], v27 offset:1024
  ds_read_b64_tr_b16 v[56:57], v26 offset:16384
  ds_read_b64_tr_b16 v[58:59], v26 offset:17408
  ds_read_b64_tr_b16 v[60:61], v27 offset:16384
  ds_read_b64_tr_b16 v[62:63], v27 offset:17408
  ds_read_b64_tr_b16 v[64:65], v26 offset:8192
  ds_read_b64_tr_b16 v[66:67], v26 offset:9216
  ds_read_b64_tr_b16 v[68:69], v27 offset:8192
  ds_read_b64_tr_b16 v[70:71], v27 offset:9216
  ds_read_b64_tr_b16 v[72:73], v26 offset:24576
  ds_read_b64_tr_b16 v[74:75], v26 offset:25600
  ds_read_b64_tr_b16 v[76:77], v27 offset:24576
  ds_read_b64_tr_b16 v[78:79], v27 offset:25600
  s_waitcnt lgkmcnt(0)
  v_mfma_f32_16x16x32_bf16 v[96:99], v[48:51], v[32:35], 0
  v_mfma_f32_16x16x32_bf16 v[100:103], v[48:51], v[36:39], 0
  v_mfma_f32_16x16x32_bf16 v[104:107], v[52:55], v[32:35], 0
  v_mfma_f32_16x16x32_bf16 v[108:111], v[52:55], v[36:39], 0
  v_mfma_f32_16x16x32_bf16 v[112:115], v[32:35], v[56:59], 0
  v_mfma_f32_16x16x32_bf16 v[116:119], v[36:39], v[56:59], 0
  v_mfma_f32_16x16x32_bf16 v[120:123], v[32:35], v[60:63], 0
  v_mfma_f32_16x16x32_bf16 v[124:127], v[36:39], v[60:63], 0
  v_mfma_f32_16x16x32_bf16 v[96:99], v[64:67], v[40:43], v[96:99]
  v_mfma_f32_16x16x32_bf16 v[100:103], v[64:67], v[44:47], v[100:103]
  v_mfma_f32_16x16x32_bf16 v[104:107], v[68:71], v[40:43], v[104:107]
  v_mfma_f32_16x16x32_bf16 v[108:111], v[68:71], v[44:47], v[108:111]
  v_mfma_f32_16x16x32_bf16 v[112:115], v[40:43], v[72:75], v[112:115]
  v_mfma_f32_16x16x32_bf16 v[116:119], v[44:47], v[72:75], v[116:119]
  v_mfma_f32_16x16x32_bf16 v[120:123], v[40:43], v[76:79], v[120:123]
  v_mfma_f32_16x16x32_bf16 v[124:127], v[44:47], v[76:79], v[124:127]
  s_waitcnt vmcnt(18)
  s_barrier
  s_add_u32 m0, s58, 0
  s_add_u32 s56, s52, 512
  buffer_load_dwordx4 v20, s[8:11], s56 offen lds
  s_add_u32 m0, s58, 4096
  s_add_u32 s56, s53, 2097152
  buffer_load_dwordx4 v21, s[20:23], s56 offen lds
  s_add_u32 m0, s58, 8192
  s_add_u32 s56, s53, 2228224
  buffer_load_dwordx4 v21, s[20:23], s56 offen lds
  s_add_u32 m0, s58, 12288
  s_add_u32 s56, s53, 2359296
  buffer_load_dwordx4 v21, s[20:23], s56 offen lds
  s_add_u32 m0, s58, 16384
  s_add_u32 s56, s53, 2490368
  buffer_load_dwordx4 v21, s[20:23], s56 offen lds
  s_add_u32 m0, s58, 20480
  s_add_u32 s56, s53, 2097152
  buffer_load_dwordx4 v21, s[24:27], s56 offen lds
  s_add_u32 m0, s58, 24576
  s_add_u32 s56, s53, 2228224
  buffer_load_dwordx4 v21, s[24:27], s56 offen lds
  s_add_u32 m0, s58, 28672
  s_add_u32 s56, s53, 2359296
  buffer_load_dwordx4 v21, s[24:27], s56 offen lds
  s_add_u32 m0, s58, 32768
  s_add_u32 s56, s53, 2490368
  buffer_load_dwordx4 v21, s[24:27], s56 offen lds
  v_add_u32 v24, 36864, v16
  v_add_u32 v26, 40960, v22
  v_add_u32 v27, 40960, v23
  ds_read_b128 v[32:35], v24 offset:0
  ds_read_b128 v[36:39], v24 offset:1024
  ds_read_b128 v[40:43], v24 offset:2048
  ds_read_b128 v[44:47], v24 offset:3072
  ds_read_b64_tr_b16 v[48:49], v26 offset:0
  ds_read_b64_tr_b16 v[50:51], v26 offset:1024
  ds_read_b64_tr_b16 v[52:53], v27 offset:0
  ds_read_b64_tr_b16 v[54:55], v27 offset:1024
  ds_read_b64_tr_b16 v[56:57], v26 offset:16384
  ds_read_b64_tr_b16 v[58:59], v26 offset:17408
  ds_read_b64_tr_b16 v[60:61], v27 offset:16384
  ds_read_b64_tr_b16 v[62:63], v27 offset:17408
  ds_read_b64_tr_b16 v[64:65], v26 offset:8192
  ds_read_b64_tr_b16 v[66:67], v26 offset:9216
  ds_read_b64_tr_b16 v[68:69], v27 offset:8192
  ds_read_b64_tr_b16 v[70:71], v27 offset:9216
  ds_read_b64_tr_b16 v[72:73], v26 offset:24576
  ds_read_b64_tr_b16 v[74:75], v26 offset:25600
  ds_read_b64_tr_b16 v[76:77], v27 offset:24576
  ds_read_b64_tr_b16 v[78:79], v27 offset:25600
  s_waitcnt lgkmcnt(0)
  v_mfma_f32_16x16x32_bf16 v[96:99], v[48:51], v[32:35], v[96:99]
  v_mfma_f32_16x16x32_bf16 v[100:103], v[48:51], v[36:39], v[100:103]
  v_mfma_f32_16x16x32_bf16 v[104:107], v[52:55], v[32:35], v[104:107]
  v_mfma_f32_16x16x32_bf16 v[108:111], v[52:55], v[36:39], v[108:111]
  v_mfma_f32_16x16x32_bf16 v[112:115], v[32:35], v[56:59], v[112:115]
  v_mfma_f32_16x16x32_bf16 v[116:119], v[36:39], v[56:59], v[116:119]
  v_mfma_f32_16x16x32_bf16 v[120:123], v[32:35], v[60:63], v[120:123]
  v_mfma_f32_16x16x32_bf16 v[124:127], v[36:39], v[60:63], v[124:127]
  v_mfma_f32_16x16x32_bf16 v[96:99], v[64:67], v[40:43], v[96:99]
  v_mfma_f32_16x16x32_bf16 v[100:103], v[64:67], v[44:47], v[100:103]
  v_mfma_f32_16x16x32_bf16 v[104:107], v[68:71], v[40:43], v[104:107]
  v_mfma_f32_16x16x32_bf16 v[108:111], v[68:71], v[44:47], v[108:111]
  v_mfma_f32_16x16x32_bf16 v[112:115], v[40:43], v[72:75], v[112:115]
  v_mfma_f32_16x16x32_bf16 v[116:119], v[44:47], v[72:75], v[116:119]
  v_mfma_f32_16x16x32_bf16 v[120:123], v[40:43], v[76:79], v[120:123]
  v_mfma_f32_16x16x32_bf16 v[124:127], v[44:47], v[76:79], v[124:127]
  s_waitcnt vmcnt(18)
  s_barrier
  s_add_u32 m0, s58, 36864
  s_add_u32 s56, s52, 640
  buffer_load_dwordx4 v20, s[8:11], s56 offen lds
  s_add_u32 m0, s58, 40960
  s_add_u32 s56, s53, 2621440
  buffer_load_dwordx4 v21, s[20:23], s56 offen lds
  s_add_u32 m0, s58, 45056
  s_add_u32 s56, s53, 2752512
  buffer_load_dwordx4 v21, s[20:23], s56 offen lds
  s_add_u32 m0, s58, 49152
  s_add_u32 s56, s53, 2883584
  buffer_load_dwordx4 v21, s[20:23], s56 offen lds
  s_add_u32 m0, s58, 53248
  s_add_u32 s56, s53, 3014656
  buffer_load_dwordx4 v21, s[20:23], s56 offen lds
  s_add_u32 m0, s58, 57344
  s_add_u32 s56, s53, 2621440
  buffer_load_dwordx4 v21, s[24:27], s56 offen lds
  s_add_u32 m0, s58, 61440
  s_add_u32 s56, s53, 2752512
  buffer_load_dwordx4 v21, s[24:27], s56 offen lds
  s_add_u32 m0, s58, 65536
  s_add_u32 s56, s53, 2883584
  buffer_load_dwordx4 v21, s[24:27], s56 offen lds
  s_add_u32 m0, s58, 69632
  s_add_u32 s56, s53, 3014656
  buffer_load_dwordx4 v21, s[24:27], s56 offen lds
  v_add_u32 v24, 73728, v16
  v_add_u32 v26, 77824, v22
  v_add_u32 v27, 77824, v23
  ds_read_b128 v[32:35], v24 offset:0
  ds_read_b128 v[36:39], v24 offset:1024
  ds_read_b128 v[40:43], v24 offset:2048
  ds_read_b128 v[44:47], v24 offset:3072
  ds_read_b64_tr_b16 v[48:49], v26 offset:0
  ds_read_b64_tr_b16 v[50:51], v26 offset:1024
  ds_read_b64_tr_b16 v[52:53], v27 offset:0
  ds_read_b64_tr_b16 v[54:55], v27 offset:1024
  ds_read_b64_tr_b16 v[56:57], v26 offset:16384
  ds_read_b64_tr_b16 v[58:59], v26 offset:17408
  ds_read_b64_tr_b16 v[60:61], v27 offset:16384
  ds_read_b64_tr_b16 v[62:63], v27 offset:17408
  ds_read_b64_tr_b16 v[64:65], v26 offset:8192
  ds_read_b64_tr_b16 v[66:67], v26 offset:9216
  ds_read_b64_tr_b16 v[68:69], v27 offset:8192
  ds_read_b64_tr_b16 v[70:71], v27 offset:9216
  ds_read_b64_tr_b16 v[72:73], v26 offset:24576
  ds_read_b64_tr_b16 v[74:75], v26 offset:25600
  ds_read_b64_tr_b16 v[76:77], v27 offset:24576
  ds_read_b64_tr_b16 v[78:79], v27 offset:25600
  s_waitcnt lgkmcnt(0)
  v_mfma_f32_16x16x32_bf16 v[96:99], v[48:51], v[32:35], v[96:99]
  v_mfma_f32_16x16x32_bf16 v[100:103], v[48:51], v[36:39], v[100:103]
  v_mfma_f32_16x16x32_bf16 v[104:107], v[52:55], v[32:35], v[104:107]
  v_mfma_f32_16x16x32_bf16 v[108:111], v[52:55], v[36:39], v[108:111]
  v_mfma_f32_16x16x32_bf16 v[112:115], v[32:35], v[56:59], v[112:115]
  v_mfma_f32_16x16x32_bf16 v[116:119], v[36:39], v[56:59], v[116:119]
  v_mfma_f32_16x16x32_bf16 v[120:123], v[32:35], v[60:63], v[120:123]
  v_mfma_f32_16x16x32_bf16 v[124:127], v[36:39], v[60:63], v[124:127]
  v_mfma_f32_16x16x32_bf16 v[96:99], v[64:67], v[40:43], v[96:99]
  v_mfma_f32_16x16x32_bf16 v[100:103], v[64:67], v[44:47], v[100:103]
  v_mfma_f32_16x16x32_bf16 v[104:107], v[68:71], v[40:43], v[104:107]
  v_mfma_f32_16x16x32_bf16 v[108:111], v[68:71], v[44:47], v[108:111]
  v_mfma_f32_16x16x32_bf16 v[112:115], v[40:43], v[72:75], v[112:115]
  v_mfma_f32_16x16x32_bf16 v[116:119], v[44:47], v[72:75], v[116:119]
  v_mfma_f32_16x16x32_bf16 v[120:123], v[40:43], v[76:79], v[120:123]
  v_mfma_f32_16x16x32_bf16 v[124:127], v[44:47], v[76:79], v[124:127]
  s_waitcnt vmcnt(18)
  s_barrier
  s_add_u32 m0, s58, 73728
  s_add_u32 s56, s52, 768
  buffer_load_dwordx4 v20, s[8:11], s56 offen lds
  s_add_u32 m0, s58, 77824
  s_add_u32 s56, s53, 3145728
  buffer_load_dwordx4 v21, s[20:23], s56 offen lds
  s_add_u32 m0, s58, 81920
  s_add_u32 s56, s53, 3276800
  buffer_load_dwordx4 v21, s[20:23], s56 offen lds
  s_add_u32 m0, s58, 86016
  s_add_u32 s56, s53, 3407872
  buffer_load_dwordx4 v21, s[20:23], s56 offen lds
  s_add_u32 m0, s58, 90112
  s_add_u32 s56, s53, 3538944
  buffer_load_dwordx4 v21, s[20:23], s56 offen lds
  s_add_u32 m0, s58, 94208
  s_add_u32 s56, s53, 3145728
  buffer_load_dwordx4 v21, s[24:27], s56 offen lds
  s_add_u32 m0, s58, 98304
  s_add_u32 s56, s53, 3276800
  buffer_load_dwordx4 v21, s[24:27], s56 offen lds
  s_add_u32 m0, s58, 102400
  s_add_u32 s56, s53, 3407872
  buffer_load_dwordx4 v21, s[24:27], s56 offen lds
  s_add_u32 m0, s58, 106496
  s_add_u32 s56, s53, 3538944
  buffer_load_dwordx4 v21, s[24:27], s56 offen lds
  v_add_u32 v24, 110592, v16
  v_add_u32 v26, 114688, v22
  v_add_u32 v27, 114688, v23
  ds_read_b128 v[32:35], v24 offset:0
  ds_read_b128 v[36:39], v24 offset:1024
  ds_read_b128 v[40:43], v24 offset:2048
  ds_read_b128 v[44:47], v24 offset:3072
  ds_read_b64_tr_b16 v[48:49], v26 offset:0
  ds_read_b64_tr_b16 v[50:51], v26 offset:1024
  ds_read_b64_tr_b16 v[52:53], v27 offset:0
  ds_read_b64_tr_b16 v[54:55], v27 offset:1024
  ds_read_b64_tr_b16 v[56:57], v26 offset:16384
  ds_read_b64_tr_b16 v[58:59], v26 offset:17408
  ds_read_b64_tr_b16 v[60:61], v27 offset:16384
  ds_read_b64_tr_b16 v[62:63], v27 offset:17408
  ds_read_b64_tr_b16 v[64:65], v26 offset:8192
  ds_read_b64_tr_b16 v[66:67], v26 offset:9216
  ds_read_b64_tr_b16 v[68:69], v27 offset:8192
  ds_read_b64_tr_b16 v[70:71], v27 offset:9216
  ds_read_b64_tr_b16 v[72:73], v26 offset:24576
  ds_read_b64_tr_b16 v[74:75], v26 offset:25600
  ds_read_b64_tr_b16 v[76:77], v27 offset:24576
  ds_read_b64_tr_b16 v[78:79], v27 offset:25600
  s_waitcnt lgkmcnt(0)
  v_mfma_f32_16x16x32_bf16 v[96:99], v[48:51], v[32:35], v[96:99]
  v_mfma_f32_16x16x32_bf16 v[100:103], v[48:51], v[36:39], v[100:103]
  v_mfma_f32_16x16x32_bf16 v[104:107], v[52:55], v[32:35], v[104:107]
  v_mfma_f32_16x16x32_bf16 v[108:111], v[52:55], v[36:39], v[108:111]
  v_mfma_f32_16x16x32_bf16 v[112:115], v[32:35], v[56:59], v[112:115]
  v_mfma_f32_16x16x32_bf16 v[116:119], v[36:39], v[56:59], v[116:119]
  v_mfma_f32_16x16x32_bf16 v[120:123], v[32:35], v[60:63], v[120:123]
  v_mfma_f32_16x16x32_bf16 v[124:127], v[36:39], v[60:63], v[124:127]
  v_mfma_f32_16x16x32_bf16 v[96:99], v[64:67], v[40:43], v[96:99]
  v_mfma_f32_16x16x32_bf16 v[100:103], v[64:67], v[44:47], v[100:103]
  v_mfma_f32_16x16x32_bf16 v[104:107], v[68:71], v[40:43], v[104:107]
  v_mfma_f32_16x16x32_bf16 v[108:111], v[68:71], v[44:47], v[108:111]
  v_mfma_f32_16x16x32_bf16 v[112:115], v[40:43], v[72:75], v[112:115]
  v_mfma_f32_16x16x32_bf16 v[116:119], v[44:47], v[72:75], v[116:119]
  v_mfma_f32_16x16x32_bf16 v[120:123], v[40:43], v[76:79], v[120:123]
  v_mfma_f32_16x16x32_bf16 v[124:127], v[44:47], v[76:79], v[124:127]
  s_waitcnt vmcnt(18)
  s_barrier
  s_add_u32 m0, s58, 110592
  s_add_u32 s56, s52, 896
  buffer_load_dwordx4 v20, s[8:11], s56 offen lds
  s_add_u32 m0, s58, 114688
  s_add_u32 s56, s53, 3670016
  buffer_load_dwordx4 v21, s[20:23], s56 offen lds
  s_add_u32 m0, s58, 118784
  s_add_u32 s56, s53, 3801088
  buffer_load_dwordx4 v21, s[20:23], s56 offen lds
  s_add_u32 m0, s58, 122880
  s_add_u32 s56, s53, 3932160
  buffer_load_dwordx4 v21, s[20:23], s56 offen lds
  s_add_u32 m0, s58, 126976
  s_add_u32 s56, s53, 4063232
  buffer_load_dwordx4 v21, s[20:23], s56 offen lds
  s_add_u32 m0, s58, 131072
  s_add_u32 s56, s53, 3670016
  buffer_load_dwordx4 v21, s[24:27], s56 offen lds
  s_add_u32 m0, s58, 135168
  s_add_u32 s56, s53, 3801088
  buffer_load_dwordx4 v21, s[24:27], s56 offen lds
  s_add_u32 m0, s58, 139264
  s_add_u32 s56, s53, 3932160
  buffer_load_dwordx4 v21, s[24:27], s56 offen lds
  s_add_u32 m0, s58, 143360
  s_add_u32 s56, s53, 4063232
  buffer_load_dwordx4 v21, s[24:27], s56 offen lds
  v_add_u32 v24, 0, v16
  v_add_u32 v26, 4096, v22
  v_add_u32 v27, 4096, v23
  ds_read_b128 v[32:35], v24 offset:0
  ds_read_b128 v[36:39], v24 offset:1024
  ds_read_b128 v[40:43], v24 offset:2048
  ds_read_b128 v[44:47], v24 offset:3072
  ds_read_b64_tr_b16 v[48:49], v26 offset:0
  ds_read_b64_tr_b16 v[50:51], v26 offset:1024
  ds_read_b64_tr_b16 v[52:53], v27 offset:0
  ds_read_b64_tr_b16 v[54:55], v27 offset:1024
  ds_read_b64_tr_b16 v[56:57], v26 offset:16384
  ds_read_b64_tr_b16 v[58:59], v26 offset:17408
  ds_read_b64_tr_b16 v[60:61], v27 offset:16384
  ds_read_b64_tr_b16 v[62:63], v27 offset:17408
  ds_read_b64_tr_b16 v[64:65], v26 offset:8192
  ds_read_b64_tr_b16 v[66:67], v26 offset:9216
  ds_read_b64_tr_b16 v[68:69], v27 offset:8192
  ds_read_b64_tr_b16 v[70:71], v27 offset:9216
  ds_read_b64_tr_b16 v[72:73], v26 offset:24576
  ds_read_b64_tr_b16 v[74:75], v26 offset:25600
  ds_read_b64_tr_b16 v[76:77], v27 offset:24576
  ds_read_b64_tr_b16 v[78:79], v27 offset:25600
  s_waitcnt lgkmcnt(0)
  v_mfma_f32_16x16x32_bf16 v[96:99], v[48:51], v[32:35], v[96:99]
  v_mfma_f32_16x16x32_bf16 v[100:103], v[48:51], v[36:39], v[100:103]
  v_mfma_f32_16x16x32_bf16 v[104:107], v[52:55], v[32:35], v[104:107]
  v_mfma_f32_16x16x32_bf16 v[108:111], v[52:55], v[36:39], v[108:111]
  v_mfma_f32_16x16x32_bf16 v[112:115], v[32:35], v[56:59], v[112:115]
  v_mfma_f32_16x16x32_bf16 v[116:119], v[36:39], v[56:59], v[116:119]
  v_mfma_f32_16x16x32_bf16 v[120:123], v[32:35], v[60:63], v[120:123]
  v_mfma_f32_16x16x32_bf16 v[124:127], v[36:39], v[60:63], v[124:127]
  v_mfma_f32_16x16x32_bf16 v[96:99], v[64:67], v[40:43], v[96:99]
  v_mfma_f32_16x16x32_bf16 v[100:103], v[64:67], v[44:47], v[100:103]
  v_mfma_f32_16x16x32_bf16 v[104:107], v[68:71], v[40:43], v[104:107]
  v_mfma_f32_16x16x32_bf16 v[108:111], v[68:71], v[44:47], v[108:111]
  v_mfma_f32_16x16x32_bf16 v[112:115], v[40:43], v[72:75], v[112:115]
  v_mfma_f32_16x16x32_bf16 v[116:119], v[44:47], v[72:75], v[116:119]
  v_mfma_f32_16x16x32_bf16 v[120:123], v[40:43], v[76:79], v[120:123]
  v_mfma_f32_16x16x32_bf16 v[124:127], v[44:47], v[76:79], v[124:127]
  s_waitcnt vmcnt(18)
  s_barrier
  s_add_u32 m0, s58, 0
  s_add_u32 s56, s52, 1024
  buffer_load_dwordx4 v20, s[8:11], s56 offen lds
  s_add_u32 m0, s58, 4096
  s_add_u32 s56, s53, 4194304
  buffer_load_dwordx4 v21, s[20:23], s56 offen lds
  s_add_u32 m0, s58, 8192
  s_add_u32 s56, s53, 4325376
  buffer_load_dwordx4 v21, s[20:23], s56 offen lds
  s_add_u32 m0, s58, 12288
  s_add_u32 s56, s53, 4456448
  buffer_load_dwordx4 v21, s[20:23], s56 offen lds
  s_add_u32 m0, s58, 16384
  s_add_u32 s56, s53, 4587520
  buffer_load_dwordx4 v21, s[20:23], s56 offen lds
  s_add_u32 m0, s58, 20480
  s_add_u32 s56, s53, 4194304
  buffer_load_dwordx4 v21, s[24:27], s56 offen lds
  s_add_u32 m0, s58, 24576
  s_add_u32 s56, s53, 4325376
  buffer_load_dwordx4 v21, s[24:27], s56 offen lds
  s_add_u32 m0, s58, 28672
  s_add_u32 s56, s53, 4456448
  buffer_load_dwordx4 v21, s[24:27], s56 offen lds
  s_add_u32 m0, s58, 32768
  s_add_u32 s56, s53, 4587520
  buffer_load_dwordx4 v21, s[24:27], s56 offen lds
  v_add_u32 v24, 36864, v16
  v_add_u32 v26, 40960, v22
  v_add_u32 v27, 40960, v23
  ds_read_b128 v[32:35], v24 offset:0
  ds_read_b128 v[36:39], v24 offset:1024
  ds_read_b128 v[40:43], v24 offset:2048
  ds_read_b128 v[44:47], v24 offset:3072
  ds_read_b64_tr_b16 v[48:49], v26 offset:0
  ds_read_b64_tr_b16 v[50:51], v26 offset:1024
  ds_read_b64_tr_b16 v[52:53], v27 offset:0
  ds_read_b64_tr_b16 v[54:55], v27 offset:1024
  ds_read_b64_tr_b16 v[56:57], v26 offset:16384
  ds_read_b64_tr_b16 v[58:59], v26 offset:17408
  ds_read_b64_tr_b16 v[60:61], v27 offset:16384
  ds_read_b64_tr_b16 v[62:63], v27 offset:17408
  ds_read_b64_tr_b16 v[64:65], v26 offset:8192
  ds_read_b64_tr_b16 v[66:67], v26 offset:9216
  ds_read_b64_tr_b16 v[68:69], v27 offset:8192
  ds_read_b64_tr_b16 v[70:71], v27 offset:9216
  ds_read_b64_tr_b16 v[72:73], v26 offset:24576
  ds_read_b64_tr_b16 v[74:75], v26 offset:25600
  ds_read_b64_tr_b16 v[76:77], v27 offset:24576
  ds_read_b64_tr_b16 v[78:79], v27 offset:25600
  s_waitcnt lgkmcnt(0)
  v_mfma_f32_16x16x32_bf16 v[96:99], v[48:51], v[32:35], v[96:99]
  v_mfma_f32_16x16x32_bf16 v[100:103], v[48:51], v[36:39], v[100:103]
  v_mfma_f32_16x16x32_bf16 v[104:107], v[52:55], v[32:35], v[104:107]
  v_mfma_f32_16x16x32_bf16 v[108:111], v[52:55], v[36:39], v[108:111]
  v_mfma_f32_16x16x32_bf16 v[112:115], v[32:35], v[56:59], v[112:115]
  v_mfma_f32_16x16x32_bf16 v[116:119], v[36:39], v[56:59], v[116:119]
  v_mfma_f32_16x16x32_bf16 v[120:123], v[32:35], v[60:63], v[120:123]
  v_mfma_f32_16x16x32_bf16 v[124:127], v[36:39], v[60:63], v[124:127]
  v_mfma_f32_16x16x32_bf16 v[96:99], v[64:67], v[40:43], v[96:99]
  v_mfma_f32_16x16x32_bf16 v[100:103], v[64:67], v[44:47], v[100:103]
  v_mfma_f32_16x16x32_bf16 v[104:107], v[68:71], v[40:43], v[104:107]
  v_mfma_f32_16x16x32_bf16 v[108:111], v[68:71], v[44:47], v[108:111]
  v_mfma_f32_16x16x32_bf16 v[112:115], v[40:43], v[72:75], v[112:115]
  v_mfma_f32_16x16x32_bf16 v[116:119], v[44:47], v[72:75], v[116:119]
  v_mfma_f32_16x16x32_bf16 v[120:123], v[40:43], v[76:79], v[120:123]
  v_mfma_f32_16x16x32_bf16 v[124:127], v[44:47], v[76:79], v[124:127]
  s_waitcnt vmcnt(18)
  s_barrier
  s_add_u32 m0, s58, 36864
  s_add_u32 s56, s52, 1152
  buffer_load_dwordx4 v20, s[8:11], s56 offen lds
  s_add_u32 m0, s58, 40960
  s_add_u32 s56, s53, 4718592
  buffer_load_dwordx4 v21, s[20:23], s56 offen lds
  s_add_u32 m0, s58, 45056
  s_add_u32 s56, s53, 4849664
  buffer_load_dwordx4 v21, s[20:23], s56 offen lds
  s_add_u32 m0, s58, 49152
  s_add_u32 s56, s53, 4980736
  buffer_load_dwordx4 v21, s[20:23], s56 offen lds
  s_add_u32 m0, s58, 53248
  s_add_u32 s56, s53, 5111808
  buffer_load_dwordx4 v21, s[20:23], s56 offen lds
  s_add_u32 m0, s58, 57344
  s_add_u32 s56, s53, 4718592
  buffer_load_dwordx4 v21, s[24:27], s56 offen lds
  s_add_u32 m0, s58, 61440
  s_add_u32 s56, s53, 4849664
  buffer_load_dwordx4 v21, s[24:27], s56 offen lds
  s_add_u32 m0, s58, 65536
  s_add_u32 s56, s53, 4980736
  buffer_load_dwordx4 v21, s[24:27], s56 offen lds
  s_add_u32 m0, s58, 69632
  s_add_u32 s56, s53, 5111808
  buffer_load_dwordx4 v21, s[24:27], s56 offen lds
  v_add_u32 v24, 73728, v16
  v_add_u32 v26, 77824, v22
  v_add_u32 v27, 77824, v23
  ds_read_b128 v[32:35], v24 offset:0
  ds_read_b128 v[36:39], v24 offset:1024
  ds_read_b128 v[40:43], v24 offset:2048
  ds_read_b128 v[44:47], v24 offset:3072
  ds_read_b64_tr_b16 v[48:49], v26 offset:0
  ds_read_b64_tr_b16 v[50:51], v26 offset:1024
  ds_read_b64_tr_b16 v[52:53], v27 offset:0
  ds_read_b64_tr_b16 v[54:55], v27 offset:1024
  ds_read_b64_tr_b16 v[56:57], v26 offset:16384
  ds_read_b64_tr_b16 v[58:59], v26 offset:17408
  ds_read_b64_tr_b16 v[60:61], v27 offset:16384
  ds_read_b64_tr_b16 v[62:63], v27 offset:17408
  ds_read_b64_tr_b16 v[64:65], v26 offset:8192
  ds_read_b64_tr_b16 v[66:67], v26 offset:9216
  ds_read_b64_tr_b16 v[68:69], v27 offset:8192
  ds_read_b64_tr_b16 v[70:71], v27 offset:9216
  ds_read_b64_tr_b16 v[72:73], v26 offset:24576
  ds_read_b64_tr_b16 v[74:75], v26 offset:25600
  ds_read_b64_tr_b16 v[76:77], v27 offset:24576
  ds_read_b64_tr_b16 v[78:79], v27 offset:25600
  s_waitcnt lgkmcnt(0)
  v_mfma_f32_16x16x32_bf16 v[96:99], v[48:51], v[32:35], v[96:99]
  v_mfma_f32_16x16x32_bf16 v[100:103], v[48:51], v[36:39], v[100:103]
  v_mfma_f32_16x16x32_bf16 v[104:107], v[52:55], v[32:35], v[104:107]
  v_mfma_f32_16x16x32_bf16 v[108:111], v[52:55], v[36:39], v[108:111]
  v_mfma_f32_16x16x32_bf16 v[112:115], v[32:35], v[56:59], v[112:115]
  v_mfma_f32_16x16x32_bf16 v[116:119], v[36:39], v[56:59], v[116:119]
  v_mfma_f32_16x16x32_bf16 v[120:123], v[32:35], v[60:63], v[120:123]
  v_mfma_f32_16x16x32_bf16 v[124:127], v[36:39], v[60:63], v[124:127]
  v_mfma_f32_16x16x32_bf16 v[96:99], v[64:67], v[40:43], v[96:99]
  v_mfma_f32_16x16x32_bf16 v[100:103], v[64:67], v[44:47], v[100:103]
  v_mfma_f32_16x16x32_bf16 v[104:107], v[68:71], v[40:43], v[104:107]
  v_mfma_f32_16x16x32_bf16 v[108:111], v[68:71], v[44:47], v[108:111]
  v_mfma_f32_16x16x32_bf16 v[112:115], v[40:43], v[72:75], v[112:115]
  v_mfma_f32_16x16x32_bf16 v[116:119], v[44:47], v[72:75], v[116:119]
  v_mfma_f32_16x16x32_bf16 v[120:123], v[40:43], v[76:79], v[120:123]
  v_mfma_f32_16x16x32_bf16 v[124:127], v[44:47], v[76:79], v[124:127]
  s_waitcnt vmcnt(18)
  s_barrier
  v_add_u32 v24, 110592, v16
  v_add_u32 v26, 114688, v22
  v_add_u32 v27, 114688, v23
  ds_read_b128 v[32:35], v24 offset:0
  ds_read_b128 v[36:39], v24 offset:1024
  ds_read_b128 v[40:43], v24 offset:2048
  ds_read_b128 v[44:47], v24 offset:3072
  ds_read_b64_tr_b16 v[48:49], v26 offset:0
  ds_read_b64_tr_b16 v[50:51], v26 offset:1024
  ds_read_b64_tr_b16 v[52:53], v27 offset:0
  ds_read_b64_tr_b16 v[54:55], v27 offset:1024
  ds_read_b64_tr_b16 v[56:57], v26 offset:16384
  ds_read_b64_tr_b16 v[58:59], v26 offset:17408
  ds_read_b64_tr_b16 v[60:61], v27 offset:16384
  ds_read_b64_tr_b16 v[62:63], v27 offset:17408
  ds_read_b64_tr_b16 v[64:65], v26 offset:8192
  ds_read_b64_tr_b16 v[66:67], v26 offset:9216
  ds_read_b64_tr_b16 v[68:69], v27 offset:8192
  ds_read_b64_tr_b16 v[70:71], v27 offset:9216
  ds_read_b64_tr_b16 v[72:73], v26 offset:24576
  ds_read_b64_tr_b16 v[74:75], v26 offset:25600
  ds_read_b64_tr_b16 v[76:77], v27 offset:24576
  ds_read_b64_tr_b16 v[78:79], v27 offset:25600
  s_waitcnt lgkmcnt(0)
  v_mfma_f32_16x16x32_bf16 v[96:99], v[48:51], v[32:35], v[96:99]
  v_mfma_f32_16x16x32_bf16 v[100:103], v[48:51], v[36:39], v[100:103]
  v_mfma_f32_16x16x32_bf16 v[104:107], v[52:55], v[32:35], v[104:107]
  v_mfma_f32_16x16x32_bf16 v[108:111], v[52:55], v[36:39], v[108:111]
  v_mfma_f32_16x16x32_bf16 v[112:115], v[32:35], v[56:59], v[112:115]
  v_mfma_f32_16x16x32_bf16 v[116:119], v[36:39], v[56:59], v[116:119]
  v_mfma_f32_16x16x32_bf16 v[120:123], v[32:35], v[60:63], v[120:123]
  v_mfma_f32_16x16x32_bf16 v[124:127], v[36:39], v[60:63], v[124:127]
  v_mfma_f32_16x16x32_bf16 v[96:99], v[64:67], v[40:43], v[96:99]
  v_mfma_f32_16x16x32_bf16 v[100:103], v[64:67], v[44:47], v[100:103]
  v_mfma_f32_16x16x32_bf16 v[104:107], v[68:71], v[40:43], v[104:107]
  v_mfma_f32_16x16x32_bf16 v[108:111], v[68:71], v[44:47], v[108:111]
  v_mfma_f32_16x16x32_bf16 v[112:115], v[40:43], v[72:75], v[112:115]
  v_mfma_f32_16x16x32_bf16 v[116:119], v[44:47], v[72:75], v[116:119]
  v_mfma_f32_16x16x32_bf16 v[120:123], v[40:43], v[76:79], v[120:123]
  v_mfma_f32_16x16x32_bf16 v[124:127], v[44:47], v[76:79], v[124:127]
  s_waitcnt vmcnt(9)
  s_barrier
  v_add_u32 v24, 0, v16
  v_add_u32 v26, 4096, v22
  v_add_u32 v27, 4096, v23
  ds_read_b128 v[32:35], v24 offset:0
  ds_read_b128 v[36:39], v24 offset:1024
  ds_read_b128 v[40:43], v24 offset:2048
  ds_read_b128 v[44:47], v24 offset:3072
  ds_read_b64_tr_b16 v[48:49], v26 offset:0
  ds_read_b64_tr_b16 v[50:51], v26 offset:1024
  ds_read_b64_tr_b16 v[52:53], v27 offset:0
  ds_read_b64_tr_b16 v[54:55], v27 offset:1024
  ds_read_b64_tr_b16 v[56:57], v26 offset:16384
  ds_read_b64_tr_b16 v[58:59], v26 offset:17408
  ds_read_b64_tr_b16 v[60:61], v27 offset:16384
  ds_read_b64_tr_b16 v[62:63], v27 offset:17408
  ds_read_b64_tr_b16 v[64:65], v26 offset:8192
  ds_read_b64_tr_b16 v[66:67], v26 offset:9216
  ds_read_b64_tr_b16 v[68:69], v27 offset:8192
  ds_read_b64_tr_b16 v[70:71], v27 offset:9216
  ds_read_b64_tr_b16 v[72:73], v26 offset:24576
  ds_read_b64_tr_b16 v[74:75], v26 offset:25600
  ds_read_b64_tr_b16 v[76:77], v27 offset:24576
  ds_read_b64_tr_b16 v[78:79], v27 offset:25600
  s_waitcnt lgkmcnt(0)
  v_mfma_f32_16x16x32_bf16 v[96:99], v[48:51], v[32:35], v[96:99]
  v_mfma_f32_16x16x32_bf16 v[100:103], v[48:51], v[36:39], v[100:103]
  v_mfma_f32_16x16x32_bf16 v[104:107], v[52:55], v[32:35], v[104:107]
  v_mfma_f32_16x16x32_bf16 v[108:111], v[52:55], v[36:39], v[108:111]
  v_mfma_f32_16x16x32_bf16 v[112:115], v[32:35], v[56:59], v[112:115]
  v_mfma_f32_16x16x32_bf16 v[116:119], v[36:39], v[56:59], v[116:119]
  v_mfma_f32_16x16x32_bf16 v[120:123], v[32:35], v[60:63], v[120:123]
  v_mfma_f32_16x16x32_bf16 v[124:127], v[36:39], v[60:63], v[124:127]
  v_mfma_f32_16x16x32_bf16 v[96:99], v[64:67], v[40:43], v[96:99]
  v_mfma_f32_16x16x32_bf16 v[100:103], v[64:67], v[44:47], v[100:103]
  v_mfma_f32_16x16x32_bf16 v[104:107], v[68:71], v[40:43], v[104:107]
  v_mfma_f32_16x16x32_bf16 v[108:111], v[68:71], v[44:47], v[108:111]
  v_mfma_f32_16x16x32_bf16 v[112:115], v[40:43], v[72:75], v[112:115]
  v_mfma_f32_16x16x32_bf16 v[116:119], v[44:47], v[72:75], v[116:119]
  v_mfma_f32_16x16x32_bf16 v[120:123], v[40:43], v[76:79], v[120:123]
  v_mfma_f32_16x16x32_bf16 v[124:127], v[44:47], v[76:79], v[124:127]
  s_waitcnt vmcnt(0)
  s_barrier
  v_add_u32 v24, 36864, v16
  v_add_u32 v26, 40960, v22
  v_add_u32 v27, 40960, v23
  ds_read_b128 v[32:35], v24 offset:0
  ds_read_b128 v[36:39], v24 offset:1024
  ds_read_b128 v[40:43], v24 offset:2048
  ds_read_b128 v[44:47], v24 offset:3072
  ds_read_b64_tr_b16 v[48:49], v26 offset:0
  ds_read_b64_tr_b16 v[50:51], v26 offset:1024
  ds_read_b64_tr_b16 v[52:53], v27 offset:0
  ds_read_b64_tr_b16 v[54:55], v27 offset:1024
  ds_read_b64_tr_b16 v[56:57], v26 offset:16384
  ds_read_b64_tr_b16 v[58:59], v26 offset:17408
  ds_read_b64_tr_b16 v[60:61], v27 offset:16384
  ds_read_b64_tr_b16 v[62:63], v27 offset:17408
  ds_read_b64_tr_b16 v[64:65], v26 offset:8192
  ds_read_b64_tr_b16 v[66:67], v26 offset:9216
  ds_read_b64_tr_b16 v[68:69], v27 offset:8192
  ds_read_b64_tr_b16 v[70:71], v27 offset:9216
  ds_read_b64_tr_b16 v[72:73], v26 offset:24576
  ds_read_b64_tr_b16 v[74:75], v26 offset:25600
  ds_read_b64_tr_b16 v[76:77], v27 offset:24576
  ds_read_b64_tr_b16 v[78:79], v27 offset:25600
  s_waitcnt lgkmcnt(0)
  v_mfma_f32_16x16x32_bf16 v[96:99], v[48:51], v[32:35], v[96:99]
  v_mfma_f32_16x16x32_bf16 v[100:103], v[48:51], v[36:39], v[100:103]
  v_mfma_f32_16x16x32_bf16 v[104:107], v[52:55], v[32:35], v[104:107]
  v_mfma_f32_16x16x32_bf16 v[108:111], v[52:55], v[36:39], v[108:111]
  v_mfma_f32_16x16x32_bf16 v[112:115], v[32:35], v[56:59], v[112:115]
  v_mfma_f32_16x16x32_bf16 v[116:119], v[36:39], v[56:59], v[116:119]
  v_mfma_f32_16x16x32_bf16 v[120:123], v[32:35], v[60:63], v[120:123]
  v_mfma_f32_16x16x32_bf16 v[124:127], v[36:39], v[60:63], v[124:127]
  v_mfma_f32_16x16x32_bf16 v[96:99], v[64:67], v[40:43], v[96:99]
  v_mfma_f32_16x16x32_bf16 v[100:103], v[64:67], v[44:47], v[100:103]
  v_mfma_f32_16x16x32_bf16 v[104:107], v[68:71], v[40:43], v[104:107]
  v_mfma_f32_16x16x32_bf16 v[108:111], v[68:71], v[44:47], v[108:111]
  v_mfma_f32_16x16x32_bf16 v[112:115], v[40:43], v[72:75], v[112:115]
  v_mfma_f32_16x16x32_bf16 v[116:119], v[44:47], v[72:75], v[116:119]
  v_mfma_f32_16x16x32_bf16 v[120:123], v[40:43], v[76:79], v[120:123]
  v_mfma_f32_16x16x32_bf16 v[124:127], v[44:47], v[76:79], v[124:127]
  s_lshl_b32 s46, s51, 5
  s_add_u32 s46, s46, s50
  s_lshl_b32 s46, s46, 14
  s_add_u32 s52, s46, s58
  s_add_u32 s53, s52, s58
  s_add_u32 s53, s53, 8192
  s_add_u32 s56, s52, 4096
  v_cvt_pk_bf16_f32 v32, v96, v97
  v_cvt_pk_bf16_f32 v33, v98, v99
  v_cvt_pk_bf16_f32 v34, v104, v105
  v_cvt_pk_bf16_f32 v35, v106, v107
  buffer_store_dwordx4 v[32:35], v16, s[40:43], s52 offen offset:0 sc1
  v_cvt_pk_bf16_f32 v36, v100, v101
  v_cvt_pk_bf16_f32 v37, v102, v103
  v_cvt_pk_bf16_f32 v38, v108, v109
  v_cvt_pk_bf16_f32 v39, v110, v111
  buffer_store_dwordx4 v[36:39], v16, s[40:43], s56 offen offset:0 sc1
  v_cvt_pk_bf16_f32 v40, v112, v113
  v_cvt_pk_bf16_f32 v41, v114, v115
  v_cvt_pk_bf16_f32 v42, v116, v117
  v_cvt_pk_bf16_f32 v43, v118, v119
  buffer_store_dwordx4 v[40:43], v16, s[40:43], s53 offen offset:0 sc1
  v_cvt_pk_bf16_f32 v44, v120, v121
  v_cvt_pk_bf16_f32 v45, v122, v123
  v_cvt_pk_bf16_f32 v46, v124, v125
  v_cvt_pk_bf16_f32 v47, v126, v127
  buffer_store_dwordx4 v[44:47], v16, s[40:43], s53 offen offset:1024 sc1
  s_waitcnt vmcnt(0)
  s_barrier
  s_cmp_lg_u32 s44, 0
  s_cbranch_scc1 L_gemm_task
  s_mov_b32 s47, 262144
L_wdbg_2:
  buffer_load_dword v4, v3, s[36:39], 0 offen offset:40 sc1
  s_waitcnt vmcnt(0)
  s_sub_u32 s47, s47, 1
  s_cbranch_scc1 L_abort
  v_cmp_gt_u32 vcc, 64, v4
  s_cbranch_vccnz L_wdbg_2
  s_mov_b32 s57, 1
  s_lshl_b32 s46, s50, 2
  s_add_u32 s46, s46, s51
  s_lshl_b32 s46, s46, 2
  s_add_u32 s46, s46, 78725120
  v_mov_b32 v4, 1
  s_mov_b64 exec, 1
  buffer_store_dword v4, v3, s[40:43], s46 offen sc1
  s_mov_b64 exec, -1
L_gemm_task:
  s_lshl_b32 s50, s62, 1
  s_bfe_u32 s46, s48, 0x10004
  s_add_u32 s50, s50, s46
  s_add_u32 s47, s46, 1
  s_cmp_eq_u32 s62, 0
  s_cselect_b32 s50, s47, s50
  s_mul_i32 s47, s46, 3
  s_cmp_eq_u32 s62, 1
  s_cselect_b32 s50, s47, s50
  s_bfe_u32 s46, s48, 0x10005
  s_lshl_b32 s46, s46, 4
  s_and_b32 s51, s48, 15
  s_add_u32 s51, s51, s46
  s_lshl_b32 s49, s50, 5
  s_add_u32 s49, s49, s51
  s_mul_i32 s52, s50, 163840
  s_lshl_b32 s53, s51, 8
  s_add_u32 m0, s54, 0
  s_add_u32 s56, s52, 0
  buffer_load_dwordx4 v8, s[8:11], s56 offen lds
  s_add_u32 m0, s54, 1024
  s_add_u32 s56, s52, 20480
  buffer_load_dwordx4 v8, s[8:11], s56 offen lds
  s_add_u32 m0, s55, 0
  s_add_u32 s56, s53, 0
  buffer_load_dwordx4 v9, s[16:19], s56 offen lds
  s_add_u32 m0, s55, 1024
  s_add_u32 s56, s53, 131072
  buffer_load_dwordx4 v9, s[16:19], s56 offen lds
  s_add_u32 m0, s55, 2048
  s_add_u32 s56, s53, 0
  buffer_load_dwordx4 v9, s[20:23], s56 offen lds
  s_add_u32 m0, s55, 3072
  s_add_u32 s56, s53, 131072
  buffer_load_dwordx4 v9, s[20:23], s56 offen lds
  s_add_u32 m0, s55, 4096
  s_add_u32 s56, s53, 0
  buffer_load_dwordx4 v9, s[24:27], s56 offen lds
  s_add_u32 m0, s55, 5120
  s_add_u32 s56, s53, 131072
  buffer_load_dwordx4 v9, s[24:27], s56 offen lds
  s_add_u32 m0, s54, 32768
  s_add_u32 s56, s52, 64
  buffer_load_dwordx4 v8, s[8:11], s56 offen lds
  s_add_u32 m0, s54, 33792
  s_add_u32 s56, s52, 20544
  buffer_load_dwordx4 v8, s[8:11], s56 offen lds
  s_add_u32 m0, s55, 32768
  s_add_u32 s56, s53, 262144
  buffer_load_dwordx4 v9, s[16:19], s56 offen lds
  s_add_u32 m0, s55, 33792
  s_add_u32 s56, s53, 393216
  buffer_load_dwordx4 v9, s[16:19], s56 offen lds
  s_add_u32 m0, s55, 34816
  s_add_u32 s56, s53, 262144
  buffer_load_dwordx4 v9, s[20:23], s56 offen lds
  s_add_u32 m0, s55, 35840
  s_add_u32 s56, s53, 393216
  buffer_load_dwordx4 v9, s[20:23], s56 offen lds
  s_add_u32 m0, s55, 36864
  s_add_u32 s56, s53, 262144
  buffer_load_dwordx4 v9, s[24:27], s56 offen lds
  s_add_u32 m0, s55, 37888
  s_add_u32 s56, s53, 393216
  buffer_load_dwordx4 v9, s[24:27], s56 offen lds
  s_add_u32 m0, s54, 65536
  s_add_u32 s56, s52, 128
  buffer_load_dwordx4 v8, s[8:11], s56 offen lds
  s_add_u32 m0, s54, 66560
  s_add_u32 s56, s52, 20608
  buffer_load_dwordx4 v8, s[8:11], s56 offen lds
  s_add_u32 m0, s55, 65536
  s_add_u32 s56, s53, 524288
  buffer_load_dwordx4 v9, s[16:19], s56 offen lds
  s_add_u32 m0, s55, 66560
  s_add_u32 s56, s53, 655360
  buffer_load_dwordx4 v9, s[16:19], s56 offen lds
  s_add_u32 m0, s55, 67584
  s_add_u32 s56, s53, 524288
  buffer_load_dwordx4 v9, s[20:23], s56 offen lds
  s_add_u32 m0, s55, 68608
  s_add_u32 s56, s53, 655360
  buffer_load_dwordx4 v9, s[20:23], s56 offen lds
  s_add_u32 m0, s55, 69632
  s_add_u32 s56, s53, 524288
  buffer_load_dwordx4 v9, s[24:27], s56 offen lds
  s_add_u32 m0, s55, 70656
  s_add_u32 s56, s53, 655360
  buffer_load_dwordx4 v9, s[24:27], s56 offen lds
  s_add_u32 m0, s54, 98304
  s_add_u32 s56, s52, 192
  buffer_load_dwordx4 v8, s[8:11], s56 offen lds
  s_add_u32 m0, s54, 99328
  s_add_u32 s56, s52, 20672
  buffer_load_dwordx4 v8, s[8:11], s56 offen lds
  s_add_u32 m0, s55, 98304
  s_add_u32 s56, s53, 786432
  buffer_load_dwordx4 v9, s[16:19], s56 offen lds
  s_add_u32 m0, s55, 99328
  s_add_u32 s56, s53, 917504
  buffer_load_dwordx4 v9, s[16:19], s56 offen lds
  s_add_u32 m0, s55, 100352
  s_add_u32 s56, s53, 786432
  buffer_load_dwordx4 v9, s[20:23], s56 offen lds
  s_add_u32 m0, s55, 101376
  s_add_u32 s56, s53, 917504
  buffer_load_dwordx4 v9, s[20:23], s56 offen lds
  s_add_u32 m0, s55, 102400
  s_add_u32 s56, s53, 786432
  buffer_load_dwordx4 v9, s[24:27], s56 offen lds
  s_add_u32 m0, s55, 103424
  s_add_u32 s56, s53, 917504
  buffer_load_dwordx4 v9, s[24:27], s56 offen lds
  s_waitcnt vmcnt(24)
  s_barrier
  ds_read_b128 a[0:3], v10 offset:0
  ds_read_b64_tr_b16 a[32:33], v12 offset:0
  ds_read_b64_tr_b16 a[34:35], v12 offset:256
  ds_read_b128 a[4:7], v10 offset:1024
  ds_read_b64_tr_b16 a[36:37], v14 offset:0
  ds_read_b64_tr_b16 a[38:39], v14 offset:256
  ds_read_b128 a[8:11], v10 offset:2048
  ds_read_b64_tr_b16 a[40:41], v12 offset:2048
  ds_read_b64_tr_b16 a[42:43], v12 offset:2304
  ds_read_b128 a[12:15], v10 offset:3072
  ds_read_b64_tr_b16 a[44:45], v14 offset:2048
  ds_read_b64_tr_b16 a[46:47], v14 offset:2304
  ds_read_b128 a[16:19], v10 offset:4096
  ds_read_b64_tr_b16 a[48:49], v12 offset:4096
  ds_read_b64_tr_b16 a[50:51], v12 offset:4352
  ds_read_b128 a[20:23], v10 offset:5120
  ds_read_b64_tr_b16 a[52:53], v14 offset:4096
  ds_read_b64_tr_b16 a[54:55], v14 offset:4352
  ds_read_b128 a[24:27], v10 offset:6144
  ds_read_b128 a[28:31], v10 offset:7168
  s_waitcnt vmcnt(16) lgkmcnt(0)
  s_barrier
  v_mfma_f32_16x16x32_bf16 v[64:67], a[32:35], a[0:3], 0
  ds_read_b128 a[56:59], v10 offset:32768
  v_mfma_f32_16x16x32_bf16 v[68:71], a[32:35], a[4:7], 0
  v_mfma_f32_16x16x32_bf16 v[72:75], a[32:35], a[8:11], 0
  ds_read_b64_tr_b16 a[88:89], v12 offset:32768
  ds_read_b64_tr_b16 a[90:91], v12 offset:33024
  v_mfma_f32_16x16x32_bf16 v[76:79], a[32:35], a[12:15], 0
  v_mfma_f32_16x16x32_bf16 v[80:83], a[32:35], a[16:19], 0
  ds_read_b128 a[60:63], v10 offset:33792
  v_mfma_f32_16x16x32_bf16 v[84:87], a[32:35], a[20:23], 0
  v_mfma_f32_16x16x32_bf16 v[88:91], a[32:35], a[24:27], 0
  ds_read_b64_tr_b16 a[92:93], v14 offset:32768
  ds_read_b64_tr_b16 a[94:95], v14 offset:33024
  v_mfma_f32_16x16x32_bf16 v[92:95], a[32:35], a[28:31], 0
  v_mfma_f32_16x16x32_bf16 v[96:99], a[36:39], a[0:3], 0
  ds_read_b128 a[64:67], v10 offset:34816
  v_mfma_f32_16x16x32_bf16 v[100:103], a[36:39], a[4:7], 0
  v_mfma_f32_16x16x32_bf16 v[104:107], a[36:39], a[8:11], 0
  ds_read_b64_tr_b16 a[96:97], v12 offset:34816
  ds_read_b64_tr_b16 a[98:99], v12 offset:35072
  v_mfma_f32_16x16x32_bf16 v[108:111], a[36:39], a[12:15], 0
  v_mfma_f32_16x16x32_bf16 v[112:115], a[36:39], a[16:19], 0
  ds_read_b128 a[68:71], v10 offset:35840
  v_mfma_f32_16x16x32_bf16 v[116:119], a[36:39], a[20:23], 0
  v_mfma_f32_16x16x32_bf16 v[120:123], a[36:39], a[24:27], 0
  ds_read_b64_tr_b16 a[100:101], v14 offset:34816
  ds_read_b64_tr_b16 a[102:103], v14 offset:35072
  v_mfma_f32_16x16x32_bf16 v[124:127], a[36:39], a[28:31], 0
  v_mfma_f32_16x16x32_bf16 v[128:131], a[40:43], a[0:3], 0
  ds_read_b128 a[72:75], v10 offset:36864
  v_mfma_f32_16x16x32_bf16 v[132:135], a[40:43], a[4:7], 0
  v_mfma_f32_16x16x32_bf16 v[136:139], a[40:43], a[8:11], 0
  ds_read_b64_tr_b16 a[104:105], v12 offset:36864
  ds_read_b64_tr_b16 a[106:107], v12 offset:37120
  v_mfma_f32_16x16x32_bf16 v[140:143], a[40:43], a[12:15], 0
  v_mfma_f32_16x16x32_bf16 v[144:147], a[40:43], a[16:19], 0
  ds_read_b128 a[76:79], v10 offset:37888
  v_mfma_f32_16x16x32_bf16 v[148:151], a[40:43], a[20:23], 0
  v_mfma_f32_16x16x32_bf16 v[152:155], a[40:43], a[24:27], 0
  ds_read_b64_tr_b16 a[108:109], v14 offset:36864
  ds_read_b64_tr_b16 a[110:111], v14 offset:37120
  v_mfma_f32_16x16x32_bf16 v[156:159], a[40:43], a[28:31], 0
  v_mfma_f32_16x16x32_bf16 v[160:163], a[44:47], a[0:3], 0
  ds_read_b128 a[80:83], v10 offset:38912
  v_mfma_f32_16x16x32_bf16 v[164:167], a[44:47], a[4:7], 0
  v_mfma_f32_16x16x32_bf16 v[168:171], a[44:47], a[8:11], 0
  ds_read_b128 a[84:87], v10 offset:39936
  v_mfma_f32_16x16x32_bf16 v[172:175], a[44:47], a[12:15], 0
  v_mfma_f32_16x16x32_bf16 v[176:179], a[44:47], a[16:19], 0
  s_add_u32 m0, s54, 0
  s_add_u32 s56, s52, 256
  buffer_load_dwordx4 v8, s[8:11], s56 offen lds
  v_mfma_f32_16x16x32_bf16 v[180:183], a[44:47], a[20:23], 0
  v_mfma_f32_16x16x32_bf16 v[184:187], a[44:47], a[24:27], 0
  s_add_u32 m0, s54, 1024
  s_add_u32 s56, s52, 20736
  buffer_load_dwordx4 v8, s[8:11], s56 offen lds
  v_mfma_f32_16x16x32_bf16 v[188:191], a[44:47], a[28:31], 0
  v_mfma_f32_16x16x32_bf16 v[192:195], a[0:3], a[48:51], 0
  s_add_u32 m0, s55, 0
  s_add_u32 s56, s53, 1048576
  buffer_load_dwordx4 v9, s[16:19], s56 offen lds
  v_mfma_f32_16x16x32_bf16 v[196:199], a[4:7], a[48:51], 0
  v_mfma_f32_16x16x32_bf16 v[200:203], a[8:11], a[48:51], 0
  s_add_u32 m0, s55, 1024
  s_add_u32 s56, s53, 1179648
  buffer_load_dwordx4 v9, s[16:19], s56 offen lds
  v_mfma_f32_16x16x32_bf16 v[204:207], a[12:15], a[48:51], 0
  v_mfma_f32_16x16x32_bf16 v[208:211], a[16:19], a[48:51], 0
  s_add_u32 m0, s55, 2048
  s_add_u32 s56, s53, 1048576
  buffer_load_dwordx4 v9, s[20:23], s56 offen lds
  v_mfma_f32_16x16x32_bf16 v[212:215], a[20:23], a[48:51], 0
  v_mfma_f32_16x16x32_bf16 v[216:219], a[24:27], a[48:51], 0
  s_add_u32 m0, s55, 3072
  s_add_u32 s56, s53, 1179648
  buffer_load_dwordx4 v9, s[20:23], s56 offen lds
  v_mfma_f32_16x16x32_bf16 v[220:223], a[28:31], a[48:51], 0
  v_mfma_f32_16x16x32_bf16 v[224:227], a[0:3], a[52:55], 0
  s_add_u32 m0, s55, 4096
  s_add_u32 s56, s53, 1048576
  buffer_load_dwordx4 v9, s[24:27], s56 offen lds
  v_mfma_f32_16x16x32_bf16 v[228:231], a[4:7], a[52:55], 0
  v_mfma_f32_16x16x32_bf16 v[232:235], a[8:11], a[52:55], 0
  s_add_u32 m0, s55, 5120
  s_add_u32 s56, s53, 1179648
  buffer_load_dwordx4 v9, s[24:27], s56 offen lds
  v_mfma_f32_16x16x32_bf16 v[236:239], a[12:15], a[52:55], 0
  v_mfma_f32_16x16x32_bf16 v[240:243], a[16:19], a[52:55], 0
  v_mfma_f32_16x16x32_bf16 v[244:247], a[20:23], a[52:55], 0
  v_mfma_f32_16x16x32_bf16 v[248:251], a[24:27], a[52:55], 0
  v_mfma_f32_16x16x32_bf16 v[252:255], a[28:31], a[52:55], 0
  s_waitcnt vmcnt(16) lgkmcnt(0)
  s_barrier
  v_mfma_f32_16x16x32_bf16 v[64:67], a[88:91], a[56:59], v[64:67]
  ds_read_b128 a[0:3], v11 offset:0
  v_mfma_f32_16x16x32_bf16 v[68:71], a[88:91], a[60:63], v[68:71]
  v_mfma_f32_16x16x32_bf16 v[72:75], a[88:91], a[64:67], v[72:75]
  ds_read_b64_tr_b16 a[32:33], v13 offset:0
  ds_read_b64_tr_b16 a[34:35], v13 offset:256
  v_mfma_f32_16x16x32_bf16 v[76:79], a[88:91], a[68:71], v[76:79]
  v_mfma_f32_16x16x32_bf16 v[80:83], a[88:91], a[72:75], v[80:83]
  ds_read_b128 a[4:7], v11 offset:1024
  v_mfma_f32_16x16x32_bf16 v[84:87], a[88:91], a[76:79], v[84:87]
  v_mfma_f32_16x16x32_bf16 v[88:91], a[88:91], a[80:83], v[88:91]
  ds_read_b64_tr_b16 a[36:37], v15 offset:0
  ds_read_b64_tr_b16 a[38:39], v15 offset:256
  v_mfma_f32_16x16x32_bf16 v[92:95], a[88:91], a[84:87], v[92:95]
  v_mfma_f32_16x16x32_bf16 v[96:99], a[92:95], a[56:59], v[96:99]
  ds_read_b128 a[8:11], v11 offset:2048
  v_mfma_f32_16x16x32_bf16 v[100:103], a[92:95], a[60:63], v[100:103]
  v_mfma_f32_16x16x32_bf16 v[104:107], a[92:95], a[64:67], v[104:107]
  ds_read_b64_tr_b16 a[40:41], v13 offset:2048
  ds_read_b64_tr_b16 a[42:43], v13 offset:2304
  v_mfma_f32_16x16x32_bf16 v[108:111], a[92:95], a[68:71], v[108:111]
  v_mfma_f32_16x16x32_bf16 v[112:115], a[92:95], a[72:75], v[112:115]
  ds_read_b128 a[12:15], v11 offset:3072
  v_mfma_f32_16x16x32_bf16 v[116:119], a[92:95], a[76:79], v[116:119]
  v_mfma_f32_16x16x32_bf16 v[120:123], a[92:95], a[80:83], v[120:123]
  ds_read_b64_tr_b16 a[44:45], v15 offset:2048
  ds_read_b64_tr_b16 a[46:47], v15 offset:2304
  v_mfma_f32_16x16x32_bf16 v[124:127], a[92:95], a[84:87], v[124:127]
  v_mfma_f32_16x16x32_bf16 v[128:131], a[96:99], a[56:59], v[128:131]
  ds_read_b128 a[16:19], v11 offset:4096
  v_mfma_f32_16x16x32_bf16 v[132:135], a[96:99], a[60:63], v[132:135]
  v_mfma_f32_16x16x32_bf16 v[136:139], a[96:99], a[64:67], v[136:139]
  ds_read_b64_tr_b16 a[48:49], v13 offset:4096
  ds_read_b64_tr_b16 a[50:51], v13 offset:4352
  v_mfma_f32_16x16x32_bf16 v[140:143], a[96:99], a[68:71], v[140:143]
  v_mfma_f32_16x16x32_bf16 v[144:147], a[96:99], a[72:75], v[144:147]
  ds_read_b128 a[20:23], v11 offset:5120
  v_mfma_f32_16x16x32_bf16 v[148:151], a[96:99], a[76:79], v[148:151]
  v_mfma_f32_16x16x32_bf16 v[152:155], a[96:99], a[80:83], v[152:155]
  ds_read_b64_tr_b16 a[52:53], v15 offset:4096
  ds_read_b64_tr_b16 a[54:55], v15 offset:4352
  v_mfma_f32_16x16x32_bf16 v[156:159], a[96:99], a[84:87], v[156:159]
  v_mfma_f32_16x16x32_bf16 v[160:163], a[100:103], a[56:59], v[160:163]
  ds_read_b128 a[24:27], v11 offset:6144
  v_mfma_f32_16x16x32_bf16 v[164:167], a[100:103], a[60:63], v[164:167]
  v_mfma_f32_16x16x32_bf16 v[168:171], a[100:103], a[64:67], v[168:171]
  ds_read_b128 a[28:31], v11 offset:7168
  v_mfma_f32_16x16x32_bf16 v[172:175], a[100:103], a[68:71], v[172:175]
  v_mfma_f32_16x16x32_bf16 v[176:179], a[100:103], a[72:75], v[176:179]
  s_add_u32 m0, s54, 32768
  s_add_u32 s56, s52, 320
  buffer_load_dwordx4 v8, s[8:11], s56 offen lds
  v_mfma_f32_16x16x32_bf16 v[180:183], a[100:103], a[76:79], v[180:183]
  v_mfma_f32_16x16x32_bf16 v[184:187], a[100:103], a[80:83], v[184:187]
  s_add_u32 m0, s54, 33792
  s_add_u32 s56, s52, 20800
  buffer_load_dwordx4 v8, s[8:11], s56 offen lds
  v_mfma_f32_16x16x32_bf16 v[188:191], a[100:103], a[84:87], v[188:191]
  v_mfma_f32_16x16x32_bf16 v[192:195], a[56:59], a[104:107], v[192:195]
  s_add_u32 m0, s55, 32768
  s_add_u32 s56, s53, 1310720
  buffer_load_dwordx4 v9, s[16:19], s56 offen lds
  v_mfma_f32_16x16x32_bf16 v[196:199], a[60:63], a[104:107], v[196:199]
  v_mfma_f32_16x16x32_bf16 v[200:203], a[64:67], a[104:107], v[200:203]
  s_add_u32 m0, s55, 33792
  s_add_u32 s56, s53, 1441792
  buffer_load_dwordx4 v9, s[16:19], s56 offen lds
  v_mfma_f32_16x16x32_bf16 v[204:207], a[68:71], a[104:107], v[204:207]
  v_mfma_f32_16x16x32_bf16 v[208:211], a[72:75], a[104:107], v[208:211]
  s_add_u32 m0, s55, 34816
  s_add_u32 s56, s53, 1310720
  buffer_load_dwordx4 v9, s[20:23], s56 offen lds
  v_mfma_f32_16x16x32_bf16 v[212:215], a[76:79], a[104:107], v[212:215]
  v_mfma_f32_16x16x32_bf16 v[216:219], a[80:83], a[104:107], v[216:219]
  s_add_u32 m0, s55, 35840
  s_add_u32 s56, s53, 1441792
  buffer_load_dwordx4 v9, s[20:23], s56 offen lds
  v_mfma_f32_16x16x32_bf16 v[220:223], a[84:87], a[104:107], v[220:223]
  v_mfma_f32_16x16x32_bf16 v[224:227], a[56:59], a[108:111], v[224:227]
  s_add_u32 m0, s55, 36864
  s_add_u32 s56, s53, 1310720
  buffer_load_dwordx4 v9, s[24:27], s56 offen lds
  v_mfma_f32_16x16x32_bf16 v[228:231], a[60:63], a[108:111], v[228:231]
  v_mfma_f32_16x16x32_bf16 v[232:235], a[64:67], a[108:111], v[232:235]
  s_add_u32 m0, s55, 37888
  s_add_u32 s56, s53, 1441792
  buffer_load_dwordx4 v9, s[24:27], s56 offen lds
  v_mfma_f32_16x16x32_bf16 v[236:239], a[68:71], a[108:111], v[236:239]
  v_mfma_f32_16x16x32_bf16 v[240:243], a[72:75], a[108:111], v[240:243]
  v_mfma_f32_16x16x32_bf16 v[244:247], a[76:79], a[108:111], v[244:247]
  v_mfma_f32_16x16x32_bf16 v[248:251], a[80:83], a[108:111], v[248:251]
  v_mfma_f32_16x16x32_bf16 v[252:255], a[84:87], a[108:111], v[252:255]
  s_waitcnt vmcnt(16) lgkmcnt(0)
  s_barrier
  v_mfma_f32_16x16x32_bf16 v[64:67], a[32:35], a[0:3], v[64:67]
  ds_read_b128 a[56:59], v11 offset:32768
  v_mfma_f32_16x16x32_bf16 v[68:71], a[32:35], a[4:7], v[68:71]
  v_mfma_f32_16x16x32_bf16 v[72:75], a[32:35], a[8:11], v[72:75]
  ds_read_b64_tr_b16 a[88:89], v13 offset:32768
  ds_read_b64_tr_b16 a[90:91], v13 offset:33024
  v_mfma_f32_16x16x32_bf16 v[76:79], a[32:35], a[12:15], v[76:79]
  v_mfma_f32_16x16x32_bf16 v[80:83], a[32:35], a[16:19], v[80:83]
  ds_read_b128 a[60:63], v11 offset:33792
  v_mfma_f32_16x16x32_bf16 v[84:87], a[32:35], a[20:23], v[84:87]
  v_mfma_f32_16x16x32_bf16 v[88:91], a[32:35], a[24:27], v[88:91]
  ds_read_b64_tr_b16 a[92:93], v15 offset:32768
  ds_read_b64_tr_b16 a[94:95], v15 offset:33024
  v_mfma_f32_16x16x32_bf16 v[92:95], a[32:35], a[28:31], v[92:95]
  v_mfma_f32_16x16x32_bf16 v[96:99], a[36:39], a[0:3], v[96:99]
  ds_read_b128 a[64:67], v11 offset:34816
  v_mfma_f32_16x16x32_bf16 v[100:103], a[36:39], a[4:7], v[100:103]
  v_mfma_f32_16x16x32_bf16 v[104:107], a[36:39], a[8:11], v[104:107]
  ds_read_b64_tr_b16 a[96:97], v13 offset:34816
  ds_read_b64_tr_b16 a[98:99], v13 offset:35072
  v_mfma_f32_16x16x32_bf16 v[108:111], a[36:39], a[12:15], v[108:111]
  v_mfma_f32_16x16x32_bf16 v[112:115], a[36:39], a[16:19], v[112:115]
  ds_read_b128 a[68:71], v11 offset:35840
  v_mfma_f32_16x16x32_bf16 v[116:119], a[36:39], a[20:23], v[116:119]
  v_mfma_f32_16x16x32_bf16 v[120:123], a[36:39], a[24:27], v[120:123]
  ds_read_b64_tr_b16 a[100:101], v15 offset:34816
  ds_read_b64_tr_b16 a[102:103], v15 offset:35072
  v_mfma_f32_16x16x32_bf16 v[124:127], a[36:39], a[28:31], v[124:127]
  v_mfma_f32_16x16x32_bf16 v[128:131], a[40:43], a[0:3], v[128:131]
  ds_read_b128 a[72:75], v11 offset:36864
  v_mfma_f32_16x16x32_bf16 v[132:135], a[40:43], a[4:7], v[132:135]
  v_mfma_f32_16x16x32_bf16 v[136:139], a[40:43], a[8:11], v[136:139]
  ds_read_b64_tr_b16 a[104:105], v13 offset:36864
  ds_read_b64_tr_b16 a[106:107], v13 offset:37120
  v_mfma_f32_16x16x32_bf16 v[140:143], a[40:43], a[12:15], v[140:143]
  v_mfma_f32_16x16x32_bf16 v[144:147], a[40:43], a[16:19], v[144:147]
  ds_read_b128 a[76:79], v11 offset:37888
  v_mfma_f32_16x16x32_bf16 v[148:151], a[40:43], a[20:23], v[148:151]
  v_mfma_f32_16x16x32_bf16 v[152:155], a[40:43], a[24:27], v[152:155]
  ds_read_b64_tr_b16 a[108:109], v15 offset:36864
  ds_read_b64_tr_b16 a[110:111], v15 offset:37120
  v_mfma_f32_16x16x32_bf16 v[156:159], a[40:43], a[28:31], v[156:159]
  v_mfma_f32_16x16x32_bf16 v[160:163], a[44:47], a[0:3], v[160:163]
  ds_read_b128 a[80:83], v11 offset:38912
  v_mfma_f32_16x16x32_bf16 v[164:167], a[44:47], a[4:7], v[164:167]
  v_mfma_f32_16x16x32_bf16 v[168:171], a[44:47], a[8:11], v[168:171]
  ds_read_b128 a[84:87], v11 offset:39936
  v_mfma_f32_16x16x32_bf16 v[172:175], a[44:47], a[12:15], v[172:175]
  v_mfma_f32_16x16x32_bf16 v[176:179], a[44:47], a[16:19], v[176:179]
  s_add_u32 m0, s54, 65536
  s_add_u32 s56, s52, 384
  buffer_load_dwordx4 v8, s[8:11], s56 offen lds
  v_mfma_f32_16x16x32_bf16 v[180:183], a[44:47], a[20:23], v[180:183]
  v_mfma_f32_16x16x32_bf16 v[184:187], a[44:47], a[24:27], v[184:187]
  s_add_u32 m0, s54, 66560
  s_add_u32 s56, s52, 20864
  buffer_load_dwordx4 v8, s[8:11], s56 offen lds
  v_mfma_f32_16x16x32_bf16 v[188:191], a[44:47], a[28:31], v[188:191]
  v_mfma_f32_16x16x32_bf16 v[192:195], a[0:3], a[48:51], v[192:195]
  s_add_u32 m0, s55, 65536
  s_add_u32 s56, s53, 1572864
  buffer_load_dwordx4 v9, s[16:19], s56 offen lds
  v_mfma_f32_16x16x32_bf16 v[196:199], a[4:7], a[48:51], v[196:199]
  v_mfma_f32_16x16x32_bf16 v[200:203], a[8:11], a[48:51], v[200:203]
  s_add_u32 m0, s55, 66560
  s_add_u32 s56, s53, 1703936
  buffer_load_dwordx4 v9, s[16:19], s56 offen lds
  v_mfma_f32_16x16x32_bf16 v[204:207], a[12:15], a[48:51], v[204:207]
  v_mfma_f32_16x16x32_bf16 v[208:211], a[16:19], a[48:51], v[208:211]
  s_add_u32 m0, s55, 67584
  s_add_u32 s56, s53, 1572864
  buffer_load_dwordx4 v9, s[20:23], s56 offen lds
  v_mfma_f32_16x16x32_bf16 v[212:215], a[20:23], a[48:51], v[212:215]
  v_mfma_f32_16x16x32_bf16 v[216:219], a[24:27], a[48:51], v[216:219]
  s_add_u32 m0, s55, 68608
  s_add_u32 s56, s53, 1703936
  buffer_load_dwordx4 v9, s[20:23], s56 offen lds
  v_mfma_f32_16x16x32_bf16 v[220:223], a[28:31], a[48:51], v[220:223]
  v_mfma_f32_16x16x32_bf16 v[224:227], a[0:3], a[52:55], v[224:227]
  s_add_u32 m0, s55, 69632
  s_add_u32 s56, s53, 1572864
  buffer_load_dwordx4 v9, s[24:27], s56 offen lds
  v_mfma_f32_16x16x32_bf16 v[228:231], a[4:7], a[52:55], v[228:231]
  v_mfma_f32_16x16x32_bf16 v[232:235], a[8:11], a[52:55], v[232:235]
  s_add_u32 m0, s55, 70656
  s_add_u32 s56, s53, 1703936
  buffer_load_dwordx4 v9, s[24:27], s56 offen lds
  v_mfma_f32_16x16x32_bf16 v[236:239], a[12:15], a[52:55], v[236:239]
  v_mfma_f32_16x16x32_bf16 v[240:243], a[16:19], a[52:55], v[240:243]
  v_mfma_f32_16x16x32_bf16 v[244:247], a[20:23], a[52:55], v[244:247]
  v_mfma_f32_16x16x32_bf16 v[248:251], a[24:27], a[52:55], v[248:251]
  v_mfma_f32_16x16x32_bf16 v[252:255], a[28:31], a[52:55], v[252:255]
  s_waitcnt vmcnt(16) lgkmcnt(0)
  s_barrier
  v_mfma_f32_16x16x32_bf16 v[64:67], a[88:91], a[56:59], v[64:67]
  ds_read_b128 a[0:3], v10 offset:0
  v_mfma_f32_16x16x32_bf16 v[68:71], a[88:91], a[60:63], v[68:71]
  v_mfma_f32_16x16x32_bf16 v[72:75], a[88:91], a[64:67], v[72:75]
  ds_read_b64_tr_b16 a[32:33], v12 offset:0
  ds_read_b64_tr_b16 a[34:35], v12 offset:256
  v_mfma_f32_16x16x32_bf16 v[76:79], a[88:91], a[68:71], v[76:79]
  v_mfma_f32_16x16x32_bf16 v[80:83], a[88:91], a[72:75], v[80:83]
  ds_read_b128 a[4:7], v10 offset:1024
  v_mfma_f32_16x16x32_bf16 v[84:87], a[88:91], a[76:79], v[84:87]
  v_mfma_f32_16x16x32_bf16 v[88:91], a[88:91], a[80:83], v[88:91]
  ds_read_b64_tr_b16 a[36:37], v14 offset:0
  ds_read_b64_tr_b16 a[38:39], v14 offset:256
  v_mfma_f32_16x16x32_bf16 v[92:95], a[88:91], a[84:87], v[92:95]
  v_mfma_f32_16x16x32_bf16 v[96:99], a[92:95], a[56:59], v[96:99]
  ds_read_b128 a[8:11], v10 offset:2048
  v_mfma_f32_16x16x32_bf16 v[100:103], a[92:95], a[60:63], v[100:103]
  v_mfma_f32_16x16x32_bf16 v[104:107], a[92:95], a[64:67], v[104:107]
  ds_read_b64_tr_b16 a[40:41], v12 offset:2048
  ds_read_b64_tr_b16 a[42:43], v12 offset:2304
  v_mfma_f32_16x16x32_bf16 v[108:111], a[92:95], a[68:71], v[108:111]
  v_mfma_f32_16x16x32_bf16 v[112:115], a[92:95], a[72:75], v[112:115]
  ds_read_b128 a[12:15], v10 offset:3072
  v_mfma_f32_16x16x32_bf16 v[116:119], a[92:95], a[76:79], v[116:119]
  v_mfma_f32_16x16x32_bf16 v[120:123], a[92:95], a[80:83], v[120:123]
  ds_read_b64_tr_b16 a[44:45], v14 offset:2048
  ds_read_b64_tr_b16 a[46:47], v14 offset:2304
  v_mfma_f32_16x16x32_bf16 v[124:127], a[92:95], a[84:87], v[124:127]
  v_mfma_f32_16x16x32_bf16 v[128:131], a[96:99], a[56:59], v[128:131]
  ds_read_b128 a[16:19], v10 offset:4096
  v_mfma_f32_16x16x32_bf16 v[132:135], a[96:99], a[60:63], v[132:135]
  v_mfma_f32_16x16x32_bf16 v[136:139], a[96:99], a[64:67], v[136:139]
  ds_read_b64_tr_b16 a[48:49], v12 offset:4096
  ds_read_b64_tr_b16 a[50:51], v12 offset:4352
  v_mfma_f32_16x16x32_bf16 v[140:143], a[96:99], a[68:71], v[140:143]
  v_mfma_f32_16x16x32_bf16 v[144:147], a[96:99], a[72:75], v[144:147]
  ds_read_b128 a[20:23], v10 offset:5120
  v_mfma_f32_16x16x32_bf16 v[148:151], a[96:99], a[76:79], v[148:151]
  v_mfma_f32_16x16x32_bf16 v[152:155], a[96:99], a[80:83], v[152:155]
  ds_read_b64_tr_b16 a[52:53], v14 offset:4096
  ds_read_b64_tr_b16 a[54:55], v14 offset:4352
  v_mfma_f32_16x16x32_bf16 v[156:159], a[96:99], a[84:87], v[156:159]
  v_mfma_f32_16x16x32_bf16 v[160:163], a[100:103], a[56:59], v[160:163]
  ds_read_b128 a[24:27], v10 offset:6144
  v_mfma_f32_16x16x32_bf16 v[164:167], a[100:103], a[60:63], v[164:167]
  v_mfma_f32_16x16x32_bf16 v[168:171], a[100:103], a[64:67], v[168:171]
  ds_read_b128 a[28:31], v10 offset:7168
  v_mfma_f32_16x16x32_bf16 v[172:175], a[100:103], a[68:71], v[172:175]
  v_mfma_f32_16x16x32_bf16 v[176:179], a[100:103], a[72:75], v[176:179]
  s_add_u32 m0, s54, 98304
  s_add_u32 s56, s52, 448
  buffer_load_dwordx4 v8, s[8:11], s56 offen lds
  v_mfma_f32_16x16x32_bf16 v[180:183], a[100:103], a[76:79], v[180:183]
  v_mfma_f32_16x16x32_bf16 v[184:187], a[100:103], a[80:83], v[184:187]
  s_add_u32 m0, s54, 99328
  s_add_u32 s56, s52, 20928
  buffer_load_dwordx4 v8, s[8:11], s56 offen lds
  v_mfma_f32_16x16x32_bf16 v[188:191], a[100:103], a[84:87], v[188:191]
  v_mfma_f32_16x16x32_bf16 v[192:195], a[56:59], a[104:107], v[192:195]
  s_add_u32 m0, s55, 98304
  s_add_u32 s56, s53, 1835008
  buffer_load_dwordx4 v9, s[16:19], s56 offen lds
  v_mfma_f32_16x16x32_bf16 v[196:199], a[60:63], a[104:107], v[196:199]
  v_mfma_f32_16x16x32_bf16 v[200:203], a[64:67], a[104:107], v[200:203]
  s_add_u32 m0, s55, 99328
  s_add_u32 s56, s53, 1966080
  buffer_load_dwordx4 v9, s[16:19], s56 offen lds
  v_mfma_f32_16x16x32_bf16 v[204:207], a[68:71], a[104:107], v[204:207]
  v_mfma_f32_16x16x32_bf16 v[208:211], a[72:75], a[104:107], v[208:211]
  s_add_u32 m0, s55, 100352
  s_add_u32 s56, s53, 1835008
  buffer_load_dwordx4 v9, s[20:23], s56 offen lds
  v_mfma_f32_16x16x32_bf16 v[212:215], a[76:79], a[104:107], v[212:215]
  v_mfma_f32_16x16x32_bf16 v[216:219], a[80:83], a[104:107], v[216:219]
  s_add_u32 m0, s55, 101376
  s_add_u32 s56, s53, 1966080
  buffer_load_dwordx4 v9, s[20:23], s56 offen lds
  v_mfma_f32_16x16x32_bf16 v[220:223], a[84:87], a[104:107], v[220:223]
  v_mfma_f32_16x16x32_bf16 v[224:227], a[56:59], a[108:111], v[224:227]
  s_add_u32 m0, s55, 102400
  s_add_u32 s56, s53, 1835008
  buffer_load_dwordx4 v9, s[24:27], s56 offen lds
  v_mfma_f32_16x16x32_bf16 v[228:231], a[60:63], a[108:111], v[228:231]
  v_mfma_f32_16x16x32_bf16 v[232:235], a[64:67], a[108:111], v[232:235]
  s_add_u32 m0, s55, 103424
  s_add_u32 s56, s53, 1966080
  buffer_load_dwordx4 v9, s[24:27], s56 offen lds
  v_mfma_f32_16x16x32_bf16 v[236:239], a[68:71], a[108:111], v[236:239]
  v_mfma_f32_16x16x32_bf16 v[240:243], a[72:75], a[108:111], v[240:243]
  v_mfma_f32_16x16x32_bf16 v[244:247], a[76:79], a[108:111], v[244:247]
  v_mfma_f32_16x16x32_bf16 v[248:251], a[80:83], a[108:111], v[248:251]
  v_mfma_f32_16x16x32_bf16 v[252:255], a[84:87], a[108:111], v[252:255]
  s_waitcnt vmcnt(16) lgkmcnt(0)
  s_barrier
  v_mfma_f32_16x16x32_bf16 v[64:67], a[32:35], a[0:3], v[64:67]
  ds_read_b128 a[56:59], v10 offset:32768
  v_mfma_f32_16x16x32_bf16 v[68:71], a[32:35], a[4:7], v[68:71]
  v_mfma_f32_16x16x32_bf16 v[72:75], a[32:35], a[8:11], v[72:75]
  ds_read_b64_tr_b16 a[88:89], v12 offset:32768
  ds_read_b64_tr_b16 a[90:91], v12 offset:33024
  v_mfma_f32_16x16x32_bf16 v[76:79], a[32:35], a[12:15], v[76:79]
  v_mfma_f32_16x16x32_bf16 v[80:83], a[32:35], a[16:19], v[80:83]
  ds_read_b128 a[60:63], v10 offset:33792
  v_mfma_f32_16x16x32_bf16 v[84:87], a[32:35], a[20:23], v[84:87]
  v_mfma_f32_16x16x32_bf16 v[88:91], a[32:35], a[24:27], v[88:91]
  ds_read_b64_tr_b16 a[92:93], v14 offset:32768
  ds_read_b64_tr_b16 a[94:95], v14 offset:33024
  v_mfma_f32_16x16x32_bf16 v[92:95], a[32:35], a[28:31], v[92:95]
  v_mfma_f32_16x16x32_bf16 v[96:99], a[36:39], a[0:3], v[96:99]
  ds_read_b128 a[64:67], v10 offset:34816
  v_mfma_f32_16x16x32_bf16 v[100:103], a[36:39], a[4:7], v[100:103]
  v_mfma_f32_16x16x32_bf16 v[104:107], a[36:39], a[8:11], v[104:107]
  ds_read_b64_tr_b16 a[96:97], v12 offset:34816
  ds_read_b64_tr_b16 a[98:99], v12 offset:35072
  v_mfma_f32_16x16x32_bf16 v[108:111], a[36:39], a[12:15], v[108:111]
  v_mfma_f32_16x16x32_bf16 v[112:115], a[36:39], a[16:19], v[112:115]
  ds_read_b128 a[68:71], v10 offset:35840
  v_mfma_f32_16x16x32_bf16 v[116:119], a[36:39], a[20:23], v[116:119]
  v_mfma_f32_16x16x32_bf16 v[120:123], a[36:39], a[24:27], v[120:123]
  ds_read_b64_tr_b16 a[100:101], v14 offset:34816
  ds_read_b64_tr_b16 a[102:103], v14 offset:35072
  v_mfma_f32_16x16x32_bf16 v[124:127], a[36:39], a[28:31], v[124:127]
  v_mfma_f32_16x16x32_bf16 v[128:131], a[40:43], a[0:3], v[128:131]
  ds_read_b128 a[72:75], v10 offset:36864
  v_mfma_f32_16x16x32_bf16 v[132:135], a[40:43], a[4:7], v[132:135]
  v_mfma_f32_16x16x32_bf16 v[136:139], a[40:43], a[8:11], v[136:139]
  ds_read_b64_tr_b16 a[104:105], v12 offset:36864
  ds_read_b64_tr_b16 a[106:107], v12 offset:37120
  v_mfma_f32_16x16x32_bf16 v[140:143], a[40:43], a[12:15], v[140:143]
  v_mfma_f32_16x16x32_bf16 v[144:147], a[40:43], a[16:19], v[144:147]
  ds_read_b128 a[76:79], v10 offset:37888
  v_mfma_f32_16x16x32_bf16 v[148:151], a[40:43], a[20:23], v[148:151]
  v_mfma_f32_16x16x32_bf16 v[152:155], a[40:43], a[24:27], v[152:155]
  ds_read_b64_tr_b16 a[108:109], v14 offset:36864
  ds_read_b64_tr_b16 a[110:111], v14 offset:37120
  v_mfma_f32_16x16x32_bf16 v[156:159], a[40:43], a[28:31], v[156:159]
  v_mfma_f32_16x16x32_bf16 v[160:163], a[44:47], a[0:3], v[160:163]
  ds_read_b128 a[80:83], v10 offset:38912
  v_mfma_f32_16x16x32_bf16 v[164:167], a[44:47], a[4:7], v[164:167]
  v_mfma_f32_16x16x32_bf16 v[168:171], a[44:47], a[8:11], v[168:171]
  ds_read_b128 a[84:87], v10 offset:39936
  v_mfma_f32_16x16x32_bf16 v[172:175], a[44:47], a[12:15], v[172:175]
  v_mfma_f32_16x16x32_bf16 v[176:179], a[44:47], a[16:19], v[176:179]
  s_add_u32 m0, s54, 0
  s_add_u32 s56, s52, 512
  buffer_load_dwordx4 v8, s[8:11], s56 offen lds
  v_mfma_f32_16x16x32_bf16 v[180:183], a[44:47], a[20:23], v[180:183]
  v_mfma_f32_16x16x32_bf16 v[184:187], a[44:47], a[24:27], v[184:187]
  s_add_u32 m0, s54, 1024
  s_add_u32 s56, s52, 20992
  buffer_load_dwordx4 v8, s[8:11], s56 offen lds
  v_mfma_f32_16x16x32_bf16 v[188:191], a[44:47], a[28:31], v[188:191]
  v_mfma_f32_16x16x32_bf16 v[192:195], a[0:3], a[48:51], v[192:195]
  s_add_u32 m0, s55, 0
  s_add_u32 s56, s53, 2097152
  buffer_load_dwordx4 v9, s[16:19], s56 offen lds
  v_mfma_f32_16x16x32_bf16 v[196:199], a[4:7], a[48:51], v[196:199]
  v_mfma_f32_16x16x32_bf16 v[200:203], a[8:11], a[48:51], v[200:203]
  s_add_u32 m0, s55, 1024
  s_add_u32 s56, s53, 2228224
  buffer_load_dwordx4 v9, s[16:19], s56 offen lds
  v_mfma_f32_16x16x32_bf16 v[204:207], a[12:15], a[48:51], v[204:207]
  v_mfma_f32_16x16x32_bf16 v[208:211], a[16:19], a[48:51], v[208:211]
  s_add_u32 m0, s55, 2048
  s_add_u32 s56, s53, 2097152
  buffer_load_dwordx4 v9, s[20:23], s56 offen lds
  v_mfma_f32_16x16x32_bf16 v[212:215], a[20:23], a[48:51], v[212:215]
  v_mfma_f32_16x16x32_bf16 v[216:219], a[24:27], a[48:51], v[216:219]
  s_add_u32 m0, s55, 3072
  s_add_u32 s56, s53, 2228224
  buffer_load_dwordx4 v9, s[20:23], s56 offen lds
  v_mfma_f32_16x16x32_bf16 v[220:223], a[28:31], a[48:51], v[220:223]
  v_mfma_f32_16x16x32_bf16 v[224:227], a[0:3], a[52:55], v[224:227]
  s_add_u32 m0, s55, 4096
  s_add_u32 s56, s53, 2097152
  buffer_load_dwordx4 v9, s[24:27], s56 offen lds
  v_mfma_f32_16x16x32_bf16 v[228:231], a[4:7], a[52:55], v[228:231]
  v_mfma_f32_16x16x32_bf16 v[232:235], a[8:11], a[52:55], v[232:235]
  s_add_u32 m0, s55, 5120
  s_add_u32 s56, s53, 2228224
  buffer_load_dwordx4 v9, s[24:27], s56 offen lds
  v_mfma_f32_16x16x32_bf16 v[236:239], a[12:15], a[52:55], v[236:239]
  v_mfma_f32_16x16x32_bf16 v[240:243], a[16:19], a[52:55], v[240:243]
  v_mfma_f32_16x16x32_bf16 v[244:247], a[20:23], a[52:55], v[244:247]
  v_mfma_f32_16x16x32_bf16 v[248:251], a[24:27], a[52:55], v[248:251]
  v_mfma_f32_16x16x32_bf16 v[252:255], a[28:31], a[52:55], v[252:255]
  s_waitcnt vmcnt(16) lgkmcnt(0)
  s_barrier
  v_mfma_f32_16x16x32_bf16 v[64:67], a[88:91], a[56:59], v[64:67]
  ds_read_b128 a[0:3], v11 offset:0
  v_mfma_f32_16x16x32_bf16 v[68:71], a[88:91], a[60:63], v[68:71]
  v_mfma_f32_16x16x32_bf16 v[72:75], a[88:91], a[64:67], v[72:75]
  ds_read_b64_tr_b16 a[32:33], v13 offset:0
  ds_read_b64_tr_b16 a[34:35], v13 offset:256
  v_mfma_f32_16x16x32_bf16 v[76:79], a[88:91], a[68:71], v[76:79]
  v_mfma_f32_16x16x32_bf16 v[80:83], a[88:91], a[72:75], v[80:83]
  ds_read_b128 a[4:7], v11 offset:1024
  v_mfma_f32_16x16x32_bf16 v[84:87], a[88:91], a[76:79], v[84:87]
  v_mfma_f32_16x16x32_bf16 v[88:91], a[88:91], a[80:83], v[88:91]
  ds_read_b64_tr_b16 a[36:37], v15 offset:0
  ds_read_b64_tr_b16 a[38:39], v15 offset:256
  v_mfma_f32_16x16x32_bf16 v[92:95], a[88:91], a[84:87], v[92:95]
  v_mfma_f32_16x16x32_bf16 v[96:99], a[92:95], a[56:59], v[96:99]
  ds_read_b128 a[8:11], v11 offset:2048
  v_mfma_f32_16x16x32_bf16 v[100:103], a[92:95], a[60:63], v[100:103]
  v_mfma_f32_16x16x32_bf16 v[104:107], a[92:95], a[64:67], v[104:107]
  ds_read_b64_tr_b16 a[40:41], v13 offset:2048
  ds_read_b64_tr_b16 a[42:43], v13 offset:2304
  v_mfma_f32_16x16x32_bf16 v[108:111], a[92:95], a[68:71], v[108:111]
  v_mfma_f32_16x16x32_bf16 v[112:115], a[92:95], a[72:75], v[112:115]
  ds_read_b128 a[12:15], v11 offset:3072
  v_mfma_f32_16x16x32_bf16 v[116:119], a[92:95], a[76:79], v[116:119]
  v_mfma_f32_16x16x32_bf16 v[120:123], a[92:95], a[80:83], v[120:123]
  ds_read_b64_tr_b16 a[44:45], v15 offset:2048
  ds_read_b64_tr_b16 a[46:47], v15 offset:2304
  v_mfma_f32_16x16x32_bf16 v[124:127], a[92:95], a[84:87], v[124:127]
  v_mfma_f32_16x16x32_bf16 v[128:131], a[96:99], a[56:59], v[128:131]
  ds_read_b128 a[16:19], v11 offset:4096
  v_mfma_f32_16x16x32_bf16 v[132:135], a[96:99], a[60:63], v[132:135]
  v_mfma_f32_16x16x32_bf16 v[136:139], a[96:99], a[64:67], v[136:139]
  ds_read_b64_tr_b16 a[48:49], v13 offset:4096
  ds_read_b64_tr_b16 a[50:51], v13 offset:4352
  v_mfma_f32_16x16x32_bf16 v[140:143], a[96:99], a[68:71], v[140:143]
  v_mfma_f32_16x16x32_bf16 v[144:147], a[96:99], a[72:75], v[144:147]
  ds_read_b128 a[20:23], v11 offset:5120
  v_mfma_f32_16x16x32_bf16 v[148:151], a[96:99], a[76:79], v[148:151]
  v_mfma_f32_16x16x32_bf16 v[152:155], a[96:99], a[80:83], v[152:155]
  ds_read_b64_tr_b16 a[52:53], v15 offset:4096
  ds_read_b64_tr_b16 a[54:55], v15 offset:4352
  v_mfma_f32_16x16x32_bf16 v[156:159], a[96:99], a[84:87], v[156:159]
  v_mfma_f32_16x16x32_bf16 v[160:163], a[100:103], a[56:59], v[160:163]
  ds_read_b128 a[24:27], v11 offset:6144
  v_mfma_f32_16x16x32_bf16 v[164:167], a[100:103], a[60:63], v[164:167]
  v_mfma_f32_16x16x32_bf16 v[168:171], a[100:103], a[64:67], v[168:171]
  ds_read_b128 a[28:31], v11 offset:7168
  v_mfma_f32_16x16x32_bf16 v[172:175], a[100:103], a[68:71], v[172:175]
  v_mfma_f32_16x16x32_bf16 v[176:179], a[100:103], a[72:75], v[176:179]
  s_add_u32 m0, s54, 32768
  s_add_u32 s56, s52, 576
  buffer_load_dwordx4 v8, s[8:11], s56 offen lds
  v_mfma_f32_16x16x32_bf16 v[180:183], a[100:103], a[76:79], v[180:183]
  v_mfma_f32_16x16x32_bf16 v[184:187], a[100:103], a[80:83], v[184:187]
  s_add_u32 m0, s54, 33792
  s_add_u32 s56, s52, 21056
  buffer_load_dwordx4 v8, s[8:11], s56 offen lds
  v_mfma_f32_16x16x32_bf16 v[188:191], a[100:103], a[84:87], v[188:191]
  v_mfma_f32_16x16x32_bf16 v[192:195], a[56:59], a[104:107], v[192:195]
  s_add_u32 m0, s55, 32768
  s_add_u32 s56, s53, 2359296
  buffer_load_dwordx4 v9, s[16:19], s56 offen lds
  v_mfma_f32_16x16x32_bf16 v[196:199], a[60:63], a[104:107], v[196:199]
  v_mfma_f32_16x16x32_bf16 v[200:203], a[64:67], a[104:107], v[200:203]
  s_add_u32 m0, s55, 33792
  s_add_u32 s56, s53, 2490368
  buffer_load_dwordx4 v9, s[16:19], s56 offen lds
  v_mfma_f32_16x16x32_bf16 v[204:207], a[68:71], a[104:107], v[204:207]
  v_mfma_f32_16x16x32_bf16 v[208:211], a[72:75], a[104:107], v[208:211]
  s_add_u32 m0, s55, 34816
  s_add_u32 s56, s53, 2359296
  buffer_load_dwordx4 v9, s[20:23], s56 offen lds
  v_mfma_f32_16x16x32_bf16 v[212:215], a[76:79], a[104:107], v[212:215]
  v_mfma_f32_16x16x32_bf16 v[216:219], a[80:83], a[104:107], v[216:219]
  s_add_u32 m0, s55, 35840
  s_add_u32 s56, s53, 2490368
  buffer_load_dwordx4 v9, s[20:23], s56 offen lds
  v_mfma_f32_16x16x32_bf16 v[220:223], a[84:87], a[104:107], v[220:223]
  v_mfma_f32_16x16x32_bf16 v[224:227], a[56:59], a[108:111], v[224:227]
  s_add_u32 m0, s55, 36864
  s_add_u32 s56, s53, 2359296
  buffer_load_dwordx4 v9, s[24:27], s56 offen lds
  v_mfma_f32_16x16x32_bf16 v[228:231], a[60:63], a[108:111], v[228:231]
  v_mfma_f32_16x16x32_bf16 v[232:235], a[64:67], a[108:111], v[232:235]
  s_add_u32 m0, s55, 37888
  s_add_u32 s56, s53, 2490368
  buffer_load_dwordx4 v9, s[24:27], s56 offen lds
  v_mfma_f32_16x16x32_bf16 v[236:239], a[68:71], a[108:111], v[236:239]
  v_mfma_f32_16x16x32_bf16 v[240:243], a[72:75], a[108:111], v[240:243]
  v_mfma_f32_16x16x32_bf16 v[244:247], a[76:79], a[108:111], v[244:247]
  v_mfma_f32_16x16x32_bf16 v[248:251], a[80:83], a[108:111], v[248:251]
  v_mfma_f32_16x16x32_bf16 v[252:255], a[84:87], a[108:111], v[252:255]
  s_waitcnt vmcnt(16) lgkmcnt(0)
  s_barrier
  v_mfma_f32_16x16x32_bf16 v[64:67], a[32:35], a[0:3], v[64:67]
  ds_read_b128 a[56:59], v11 offset:32768
  v_mfma_f32_16x16x32_bf16 v[68:71], a[32:35], a[4:7], v[68:71]
  v_mfma_f32_16x16x32_bf16 v[72:75], a[32:35], a[8:11], v[72:75]
  ds_read_b64_tr_b16 a[88:89], v13 offset:32768
  ds_read_b64_tr_b16 a[90:91], v13 offset:33024
  v_mfma_f32_16x16x32_bf16 v[76:79], a[32:35], a[12:15], v[76:79]
  v_mfma_f32_16x16x32_bf16 v[80:83], a[32:35], a[16:19], v[80:83]
  ds_read_b128 a[60:63], v11 offset:33792
  v_mfma_f32_16x16x32_bf16 v[84:87], a[32:35], a[20:23], v[84:87]
  v_mfma_f32_16x16x32_bf16 v[88:91], a[32:35], a[24:27], v[88:91]
  ds_read_b64_tr_b16 a[92:93], v15 offset:32768
  ds_read_b64_tr_b16 a[94:95], v15 offset:33024
  v_mfma_f32_16x16x32_bf16 v[92:95], a[32:35], a[28:31], v[92:95]
  v_mfma_f32_16x16x32_bf16 v[96:99], a[36:39], a[0:3], v[96:99]
  ds_read_b128 a[64:67], v11 offset:34816
  v_mfma_f32_16x16x32_bf16 v[100:103], a[36:39], a[4:7], v[100:103]
  v_mfma_f32_16x16x32_bf16 v[104:107], a[36:39], a[8:11], v[104:107]
  ds_read_b64_tr_b16 a[96:97], v13 offset:34816
  ds_read_b64_tr_b16 a[98:99], v13 offset:35072
  v_mfma_f32_16x16x32_bf16 v[108:111], a[36:39], a[12:15], v[108:111]
  v_mfma_f32_16x16x32_bf16 v[112:115], a[36:39], a[16:19], v[112:115]
  ds_read_b128 a[68:71], v11 offset:35840
  v_mfma_f32_16x16x32_bf16 v[116:119], a[36:39], a[20:23], v[116:119]
  v_mfma_f32_16x16x32_bf16 v[120:123], a[36:39], a[24:27], v[120:123]
  ds_read_b64_tr_b16 a[100:101], v15 offset:34816
  ds_read_b64_tr_b16 a[102:103], v15 offset:35072
  v_mfma_f32_16x16x32_bf16 v[124:127], a[36:39], a[28:31], v[124:127]
  v_mfma_f32_16x16x32_bf16 v[128:131], a[40:43], a[0:3], v[128:131]
  ds_read_b128 a[72:75], v11 offset:36864
  v_mfma_f32_16x16x32_bf16 v[132:135], a[40:43], a[4:7], v[132:135]
  v_mfma_f32_16x16x32_bf16 v[136:139], a[40:43], a[8:11], v[136:139]
  ds_read_b64_tr_b16 a[104:105], v13 offset:36864
  ds_read_b64_tr_b16 a[106:107], v13 offset:37120
  v_mfma_f32_16x16x32_bf16 v[140:143], a[40:43], a[12:15], v[140:143]
  v_mfma_f32_16x16x32_bf16 v[144:147], a[40:43], a[16:19], v[144:147]
  ds_read_b128 a[76:79], v11 offset:37888
  v_mfma_f32_16x16x32_bf16 v[148:151], a[40:43], a[20:23], v[148:151]
  v_mfma_f32_16x16x32_bf16 v[152:155], a[40:43], a[24:27], v[152:155]
  ds_read_b64_tr_b16 a[108:109], v15 offset:36864
  ds_read_b64_tr_b16 a[110:111], v15 offset:37120
  v_mfma_f32_16x16x32_bf16 v[156:159], a[40:43], a[28:31], v[156:159]
  v_mfma_f32_16x16x32_bf16 v[160:163], a[44:47], a[0:3], v[160:163]
  ds_read_b128 a[80:83], v11 offset:38912
  v_mfma_f32_16x16x32_bf16 v[164:167], a[44:47], a[4:7], v[164:167]
  v_mfma_f32_16x16x32_bf16 v[168:171], a[44:47], a[8:11], v[168:171]
  ds_read_b128 a[84:87], v11 offset:39936
  v_mfma_f32_16x16x32_bf16 v[172:175], a[44:47], a[12:15], v[172:175]
  v_mfma_f32_16x16x32_bf16 v[176:179], a[44:47], a[16:19], v[176:179]
  s_add_u32 m0, s54, 65536
  s_add_u32 s56, s52, 640
  buffer_load_dwordx4 v8, s[8:11], s56 offen lds
  v_mfma_f32_16x16x32_bf16 v[180:183], a[44:47], a[20:23], v[180:183]
  v_mfma_f32_16x16x32_bf16 v[184:187], a[44:47], a[24:27], v[184:187]
  s_add_u32 m0, s54, 66560
  s_add_u32 s56, s52, 21120
  buffer_load_dwordx4 v8, s[8:11], s56 offen lds
  v_mfma_f32_16x16x32_bf16 v[188:191], a[44:47], a[28:31], v[188:191]
  v_mfma_f32_16x16x32_bf16 v[192:195], a[0:3], a[48:51], v[192:195]
  s_add_u32 m0, s55, 65536
  s_add_u32 s56, s53, 2621440
  buffer_load_dwordx4 v9, s[16:19], s56 offen lds
  v_mfma_f32_16x16x32_bf16 v[196:199], a[4:7], a[48:51], v[196:199]
  v_mfma_f32_16x16x32_bf16 v[200:203], a[8:11], a[48:51], v[200:203]
  s_add_u32 m0, s55, 66560
  s_add_u32 s56, s53, 2752512
  buffer_load_dwordx4 v9, s[16:19], s56 offen lds
  v_mfma_f32_16x16x32_bf16 v[204:207], a[12:15], a[48:51], v[204:207]
  v_mfma_f32_16x16x32_bf16 v[208:211], a[16:19], a[48:51], v[208:211]
  s_add_u32 m0, s55, 67584
  s_add_u32 s56, s53, 2621440
  buffer_load_dwordx4 v9, s[20:23], s56 offen lds
  v_mfma_f32_16x16x32_bf16 v[212:215], a[20:23], a[48:51], v[212:215]
  v_mfma_f32_16x16x32_bf16 v[216:219], a[24:27], a[48:51], v[216:219]
  s_add_u32 m0, s55, 68608
  s_add_u32 s56, s53, 2752512
  buffer_load_dwordx4 v9, s[20:23], s56 offen lds
  v_mfma_f32_16x16x32_bf16 v[220:223], a[28:31], a[48:51], v[220:223]
  v_mfma_f32_16x16x32_bf16 v[224:227], a[0:3], a[52:55], v[224:227]
  s_add_u32 m0, s55, 69632
  s_add_u32 s56, s53, 2621440
  buffer_load_dwordx4 v9, s[24:27], s56 offen lds
  v_mfma_f32_16x16x32_bf16 v[228:231], a[4:7], a[52:55], v[228:231]
  v_mfma_f32_16x16x32_bf16 v[232:235], a[8:11], a[52:55], v[232:235]
  s_add_u32 m0, s55, 70656
  s_add_u32 s56, s53, 2752512
  buffer_load_dwordx4 v9, s[24:27], s56 offen lds
  v_mfma_f32_16x16x32_bf16 v[236:239], a[12:15], a[52:55], v[236:239]
  v_mfma_f32_16x16x32_bf16 v[240:243], a[16:19], a[52:55], v[240:243]
  v_mfma_f32_16x16x32_bf16 v[244:247], a[20:23], a[52:55], v[244:247]
  v_mfma_f32_16x16x32_bf16 v[248:251], a[24:27], a[52:55], v[248:251]
  v_mfma_f32_16x16x32_bf16 v[252:255], a[28:31], a[52:55], v[252:255]
  s_waitcnt vmcnt(16) lgkmcnt(0)
  s_barrier
  v_mfma_f32_16x16x32_bf16 v[64:67], a[88:91], a[56:59], v[64:67]
  ds_read_b128 a[0:3], v10 offset:0
  v_mfma_f32_16x16x32_bf16 v[68:71], a[88:91], a[60:63], v[68:71]
  v_mfma_f32_16x16x32_bf16 v[72:75], a[88:91], a[64:67], v[72:75]
  ds_read_b64_tr_b16 a[32:33], v12 offset:0
  ds_read_b64_tr_b16 a[34:35], v12 offset:256
  v_mfma_f32_16x16x32_bf16 v[76:79], a[88:91], a[68:71], v[76:79]
  v_mfma_f32_16x16x32_bf16 v[80:83], a[88:91], a[72:75], v[80:83]
  ds_read_b128 a[4:7], v10 offset:1024
  v_mfma_f32_16x16x32_bf16 v[84:87], a[88:91], a[76:79], v[84:87]
  v_mfma_f32_16x16x32_bf16 v[88:91], a[88:91], a[80:83], v[88:91]
  ds_read_b64_tr_b16 a[36:37], v14 offset:0
  ds_read_b64_tr_b16 a[38:39], v14 offset:256
  v_mfma_f32_16x16x32_bf16 v[92:95], a[88:91], a[84:87], v[92:95]
  v_mfma_f32_16x16x32_bf16 v[96:99], a[92:95], a[56:59], v[96:99]
  ds_read_b128 a[8:11], v10 offset:2048
  v_mfma_f32_16x16x32_bf16 v[100:103], a[92:95], a[60:63], v[100:103]
  v_mfma_f32_16x16x32_bf16 v[104:107], a[92:95], a[64:67], v[104:107]
  ds_read_b64_tr_b16 a[40:41], v12 offset:2048
  ds_read_b64_tr_b16 a[42:43], v12 offset:2304
  v_mfma_f32_16x16x32_bf16 v[108:111], a[92:95], a[68:71], v[108:111]
  v_mfma_f32_16x16x32_bf16 v[112:115], a[92:95], a[72:75], v[112:115]
  ds_read_b128 a[12:15], v10 offset:3072
  v_mfma_f32_16x16x32_bf16 v[116:119], a[92:95], a[76:79], v[116:119]
  v_mfma_f32_16x16x32_bf16 v[120:123], a[92:95], a[80:83], v[120:123]
  ds_read_b64_tr_b16 a[44:45], v14 offset:2048
  ds_read_b64_tr_b16 a[46:47], v14 offset:2304
  v_mfma_f32_16x16x32_bf16 v[124:127], a[92:95], a[84:87], v[124:127]
  v_mfma_f32_16x16x32_bf16 v[128:131], a[96:99], a[56:59], v[128:131]
  ds_read_b128 a[16:19], v10 offset:4096
  v_mfma_f32_16x16x32_bf16 v[132:135], a[96:99], a[60:63], v[132:135]
  v_mfma_f32_16x16x32_bf16 v[136:139], a[96:99], a[64:67], v[136:139]
  ds_read_b64_tr_b16 a[48:49], v12 offset:4096
  ds_read_b64_tr_b16 a[50:51], v12 offset:4352
  v_mfma_f32_16x16x32_bf16 v[140:143], a[96:99], a[68:71], v[140:143]
  v_mfma_f32_16x16x32_bf16 v[144:147], a[96:99], a[72:75], v[144:147]
  ds_read_b128 a[20:23], v10 offset:5120
  v_mfma_f32_16x16x32_bf16 v[148:151], a[96:99], a[76:79], v[148:151]
  v_mfma_f32_16x16x32_bf16 v[152:155], a[96:99], a[80:83], v[152:155]
  ds_read_b64_tr_b16 a[52:53], v14 offset:4096
  ds_read_b64_tr_b16 a[54:55], v14 offset:4352
  v_mfma_f32_16x16x32_bf16 v[156:159], a[96:99], a[84:87], v[156:159]
  v_mfma_f32_16x16x32_bf16 v[160:163], a[100:103], a[56:59], v[160:163]
  ds_read_b128 a[24:27], v10 offset:6144
  v_mfma_f32_16x16x32_bf16 v[164:167], a[100:103], a[60:63], v[164:167]
  v_mfma_f32_16x16x32_bf16 v[168:171], a[100:103], a[64:67], v[168:171]
  ds_read_b128 a[28:31], v10 offset:7168
  v_mfma_f32_16x16x32_bf16 v[172:175], a[100:103], a[68:71], v[172:175]
  v_mfma_f32_16x16x32_bf16 v[176:179], a[100:103], a[72:75], v[176:179]
  s_add_u32 m0, s54, 98304
  s_add_u32 s56, s52, 704
  buffer_load_dwordx4 v8, s[8:11], s56 offen lds
  v_mfma_f32_16x16x32_bf16 v[180:183], a[100:103], a[76:79], v[180:183]
  v_mfma_f32_16x16x32_bf16 v[184:187], a[100:103], a[80:83], v[184:187]
  s_add_u32 m0, s54, 99328
  s_add_u32 s56, s52, 21184
  buffer_load_dwordx4 v8, s[8:11], s56 offen lds
  v_mfma_f32_16x16x32_bf16 v[188:191], a[100:103], a[84:87], v[188:191]
  v_mfma_f32_16x16x32_bf16 v[192:195], a[56:59], a[104:107], v[192:195]
  s_add_u32 m0, s55, 98304
  s_add_u32 s56, s53, 2883584
  buffer_load_dwordx4 v9, s[16:19], s56 offen lds
  v_mfma_f32_16x16x32_bf16 v[196:199], a[60:63], a[104:107], v[196:199]
  v_mfma_f32_16x16x32_bf16 v[200:203], a[64:67], a[104:107], v[200:203]
  s_add_u32 m0, s55, 99328
  s_add_u32 s56, s53, 3014656
  buffer_load_dwordx4 v9, s[16:19], s56 offen lds
  v_mfma_f32_16x16x32_bf16 v[204:207], a[68:71], a[104:107], v[204:207]
  v_mfma_f32_16x16x32_bf16 v[208:211], a[72:75], a[104:107], v[208:211]
  s_add_u32 m0, s55, 100352
  s_add_u32 s56, s53, 2883584
  buffer_load_dwordx4 v9, s[20:23], s56 offen lds
  v_mfma_f32_16x16x32_bf16 v[212:215], a[76:79], a[104:107], v[212:215]
  v_mfma_f32_16x16x32_bf16 v[216:219], a[80:83], a[104:107], v[216:219]
  s_add_u32 m0, s55, 101376
  s_add_u32 s56, s53, 3014656
  buffer_load_dwordx4 v9, s[20:23], s56 offen lds
  v_mfma_f32_16x16x32_bf16 v[220:223], a[84:87], a[104:107], v[220:223]
  v_mfma_f32_16x16x32_bf16 v[224:227], a[56:59], a[108:111], v[224:227]
  s_add_u32 m0, s55, 102400
  s_add_u32 s56, s53, 2883584
  buffer_load_dwordx4 v9, s[24:27], s56 offen lds
  v_mfma_f32_16x16x32_bf16 v[228:231], a[60:63], a[108:111], v[228:231]
  v_mfma_f32_16x16x32_bf16 v[232:235], a[64:67], a[108:111], v[232:235]
  s_add_u32 m0, s55, 103424
  s_add_u32 s56, s53, 3014656
  buffer_load_dwordx4 v9, s[24:27], s56 offen lds
  v_mfma_f32_16x16x32_bf16 v[236:239], a[68:71], a[108:111], v[236:239]
  v_mfma_f32_16x16x32_bf16 v[240:243], a[72:75], a[108:111], v[240:243]
  v_mfma_f32_16x16x32_bf16 v[244:247], a[76:79], a[108:111], v[244:247]
  v_mfma_f32_16x16x32_bf16 v[248:251], a[80:83], a[108:111], v[248:251]
  v_mfma_f32_16x16x32_bf16 v[252:255], a[84:87], a[108:111], v[252:255]
  s_waitcnt vmcnt(16) lgkmcnt(0)
  s_barrier
  v_mfma_f32_16x16x32_bf16 v[64:67], a[32:35], a[0:3], v[64:67]
  ds_read_b128 a[56:59], v10 offset:32768
  v_mfma_f32_16x16x32_bf16 v[68:71], a[32:35], a[4:7], v[68:71]
  v_mfma_f32_16x16x32_bf16 v[72:75], a[32:35], a[8:11], v[72:75]
  ds_read_b64_tr_b16 a[88:89], v12 offset:32768
  ds_read_b64_tr_b16 a[90:91], v12 offset:33024
  v_mfma_f32_16x16x32_bf16 v[76:79], a[32:35], a[12:15], v[76:79]
  v_mfma_f32_16x16x32_bf16 v[80:83], a[32:35], a[16:19], v[80:83]
  ds_read_b128 a[60:63], v10 offset:33792
  v_mfma_f32_16x16x32_bf16 v[84:87], a[32:35], a[20:23], v[84:87]
  v_mfma_f32_16x16x32_bf16 v[88:91], a[32:35], a[24:27], v[88:91]
  ds_read_b64_tr_b16 a[92:93], v14 offset:32768
  ds_read_b64_tr_b16 a[94:95], v14 offset:33024
  v_mfma_f32_16x16x32_bf16 v[92:95], a[32:35], a[28:31], v[92:95]
  v_mfma_f32_16x16x32_bf16 v[96:99], a[36:39], a[0:3], v[96:99]
  ds_read_b128 a[64:67], v10 offset:34816
  v_mfma_f32_16x16x32_bf16 v[100:103], a[36:39], a[4:7], v[100:103]
  v_mfma_f32_16x16x32_bf16 v[104:107], a[36:39], a[8:11], v[104:107]
  ds_read_b64_tr_b16 a[96:97], v12 offset:34816
  ds_read_b64_tr_b16 a[98:99], v12 offset:35072
  v_mfma_f32_16x16x32_bf16 v[108:111], a[36:39], a[12:15], v[108:111]
  v_mfma_f32_16x16x32_bf16 v[112:115], a[36:39], a[16:19], v[112:115]
  ds_read_b128 a[68:71], v10 offset:35840
  v_mfma_f32_16x16x32_bf16 v[116:119], a[36:39], a[20:23], v[116:119]
  v_mfma_f32_16x16x32_bf16 v[120:123], a[36:39], a[24:27], v[120:123]
  ds_read_b64_tr_b16 a[100:101], v14 offset:34816
  ds_read_b64_tr_b16 a[102:103], v14 offset:35072
  v_mfma_f32_16x16x32_bf16 v[124:127], a[36:39], a[28:31], v[124:127]
  v_mfma_f32_16x16x32_bf16 v[128:131], a[40:43], a[0:3], v[128:131]
  ds_read_b128 a[72:75], v10 offset:36864
  v_mfma_f32_16x16x32_bf16 v[132:135], a[40:43], a[4:7], v[132:135]
  v_mfma_f32_16x16x32_bf16 v[136:139], a[40:43], a[8:11], v[136:139]
  ds_read_b64_tr_b16 a[104:105], v12 offset:36864
  ds_read_b64_tr_b16 a[106:107], v12 offset:37120
  v_mfma_f32_16x16x32_bf16 v[140:143], a[40:43], a[12:15], v[140:143]
  v_mfma_f32_16x16x32_bf16 v[144:147], a[40:43], a[16:19], v[144:147]
  ds_read_b128 a[76:79], v10 offset:37888
  v_mfma_f32_16x16x32_bf16 v[148:151], a[40:43], a[20:23], v[148:151]
  v_mfma_f32_16x16x32_bf16 v[152:155], a[40:43], a[24:27], v[152:155]
  ds_read_b64_tr_b16 a[108:109], v14 offset:36864
  ds_read_b64_tr_b16 a[110:111], v14 offset:37120
  v_mfma_f32_16x16x32_bf16 v[156:159], a[40:43], a[28:31], v[156:159]
  v_mfma_f32_16x16x32_bf16 v[160:163], a[44:47], a[0:3], v[160:163]
  ds_read_b128 a[80:83], v10 offset:38912
  v_mfma_f32_16x16x32_bf16 v[164:167], a[44:47], a[4:7], v[164:167]
  v_mfma_f32_16x16x32_bf16 v[168:171], a[44:47], a[8:11], v[168:171]
  ds_read_b128 a[84:87], v10 offset:39936
  v_mfma_f32_16x16x32_bf16 v[172:175], a[44:47], a[12:15], v[172:175]
  v_mfma_f32_16x16x32_bf16 v[176:179], a[44:47], a[16:19], v[176:179]
  s_add_u32 m0, s54, 0
  s_add_u32 s56, s52, 768
  buffer_load_dwordx4 v8, s[8:11], s56 offen lds
  v_mfma_f32_16x16x32_bf16 v[180:183], a[44:47], a[20:23], v[180:183]
  v_mfma_f32_16x16x32_bf16 v[184:187], a[44:47], a[24:27], v[184:187]
  s_add_u32 m0, s54, 1024
  s_add_u32 s56, s52, 21248
  buffer_load_dwordx4 v8, s[8:11], s56 offen lds
  v_mfma_f32_16x16x32_bf16 v[188:191], a[44:47], a[28:31], v[188:191]
  v_mfma_f32_16x16x32_bf16 v[192:195], a[0:3], a[48:51], v[192:195]
  s_add_u32 m0, s55, 0
  s_add_u32 s56, s53, 3145728
  buffer_load_dwordx4 v9, s[16:19], s56 offen lds
  v_mfma_f32_16x16x32_bf16 v[196:199], a[4:7], a[48:51], v[196:199]
  v_mfma_f32_16x16x32_bf16 v[200:203], a[8:11], a[48:51], v[200:203]
  s_add_u32 m0, s55, 1024
  s_add_u32 s56, s53, 3276800
  buffer_load_dwordx4 v9, s[16:19], s56 offen lds
  v_mfma_f32_16x16x32_bf16 v[204:207], a[12:15], a[48:51], v[204:207]
  v_mfma_f32_16x16x32_bf16 v[208:211], a[16:19], a[48:51], v[208:211]
  s_add_u32 m0, s55, 2048
  s_add_u32 s56, s53, 3145728
  buffer_load_dwordx4 v9, s[20:23], s56 offen lds
  v_mfma_f32_16x16x32_bf16 v[212:215], a[20:23], a[48:51], v[212:215]
  v_mfma_f32_16x16x32_bf16 v[216:219], a[24:27], a[48:51], v[216:219]
  s_add_u32 m0, s55, 3072
  s_add_u32 s56, s53, 3276800
  buffer_load_dwordx4 v9, s[20:23], s56 offen lds
  v_mfma_f32_16x16x32_bf16 v[220:223], a[28:31], a[48:51], v[220:223]
  v_mfma_f32_16x16x32_bf16 v[224:227], a[0:3], a[52:55], v[224:227]
  s_add_u32 m0, s55, 4096
  s_add_u32 s56, s53, 3145728
  buffer_load_dwordx4 v9, s[24:27], s56 offen lds
  v_mfma_f32_16x16x32_bf16 v[228:231], a[4:7], a[52:55], v[228:231]
  v_mfma_f32_16x16x32_bf16 v[232:235], a[8:11], a[52:55], v[232:235]
  s_add_u32 m0, s55, 5120
  s_add_u32 s56, s53, 3276800
  buffer_load_dwordx4 v9, s[24:27], s56 offen lds
  v_mfma_f32_16x16x32_bf16 v[236:239], a[12:15], a[52:55], v[236:239]
  v_mfma_f32_16x16x32_bf16 v[240:243], a[16:19], a[52:55], v[240:243]
  v_mfma_f32_16x16x32_bf16 v[244:247], a[20:23], a[52:55], v[244:247]
  v_mfma_f32_16x16x32_bf16 v[248:251], a[24:27], a[52:55], v[248:251]
  v_mfma_f32_16x16x32_bf16 v[252:255], a[28:31], a[52:55], v[252:255]
  s_waitcnt vmcnt(16) lgkmcnt(0)
  s_barrier
  v_mfma_f32_16x16x32_bf16 v[64:67], a[88:91], a[56:59], v[64:67]
  ds_read_b128 a[0:3], v11 offset:0
  v_mfma_f32_16x16x32_bf16 v[68:71], a[88:91], a[60:63], v[68:71]
  v_mfma_f32_16x16x32_bf16 v[72:75], a[88:91], a[64:67], v[72:75]
  ds_read_b64_tr_b16 a[32:33], v13 offset:0
  ds_read_b64_tr_b16 a[34:35], v13 offset:256
  v_mfma_f32_16x16x32_bf16 v[76:79], a[88:91], a[68:71], v[76:79]
  v_mfma_f32_16x16x32_bf16 v[80:83], a[88:91], a[72:75], v[80:83]
  ds_read_b128 a[4:7], v11 offset:1024
  v_mfma_f32_16x16x32_bf16 v[84:87], a[88:91], a[76:79], v[84:87]
  v_mfma_f32_16x16x32_bf16 v[88:91], a[88:91], a[80:83], v[88:91]
  ds_read_b64_tr_b16 a[36:37], v15 offset:0
  ds_read_b64_tr_b16 a[38:39], v15 offset:256
  v_mfma_f32_16x16x32_bf16 v[92:95], a[88:91], a[84:87], v[92:95]
  v_mfma_f32_16x16x32_bf16 v[96:99], a[92:95], a[56:59], v[96:99]
  ds_read_b128 a[8:11], v11 offset:2048
  v_mfma_f32_16x16x32_bf16 v[100:103], a[92:95], a[60:63], v[100:103]
  v_mfma_f32_16x16x32_bf16 v[104:107], a[92:95], a[64:67], v[104:107]
  ds_read_b64_tr_b16 a[40:41], v13 offset:2048
  ds_read_b64_tr_b16 a[42:43], v13 offset:2304
  v_mfma_f32_16x16x32_bf16 v[108:111], a[92:95], a[68:71], v[108:111]
  v_mfma_f32_16x16x32_bf16 v[112:115], a[92:95], a[72:75], v[112:115]
  ds_read_b128 a[12:15], v11 offset:3072
  v_mfma_f32_16x16x32_bf16 v[116:119], a[92:95], a[76:79], v[116:119]
  v_mfma_f32_16x16x32_bf16 v[120:123], a[92:95], a[80:83], v[120:123]
  ds_read_b64_tr_b16 a[44:45], v15 offset:2048
  ds_read_b64_tr_b16 a[46:47], v15 offset:2304
  v_mfma_f32_16x16x32_bf16 v[124:127], a[92:95], a[84:87], v[124:127]
  v_mfma_f32_16x16x32_bf16 v[128:131], a[96:99], a[56:59], v[128:131]
  ds_read_b128 a[16:19], v11 offset:4096
  v_mfma_f32_16x16x32_bf16 v[132:135], a[96:99], a[60:63], v[132:135]
  v_mfma_f32_16x16x32_bf16 v[136:139], a[96:99], a[64:67], v[136:139]
  ds_read_b64_tr_b16 a[48:49], v13 offset:4096
  ds_read_b64_tr_b16 a[50:51], v13 offset:4352
  v_mfma_f32_16x16x32_bf16 v[140:143], a[96:99], a[68:71], v[140:143]
  v_mfma_f32_16x16x32_bf16 v[144:147], a[96:99], a[72:75], v[144:147]
  ds_read_b128 a[20:23], v11 offset:5120
  v_mfma_f32_16x16x32_bf16 v[148:151], a[96:99], a[76:79], v[148:151]
  v_mfma_f32_16x16x32_bf16 v[152:155], a[96:99], a[80:83], v[152:155]
  ds_read_b64_tr_b16 a[52:53], v15 offset:4096
  ds_read_b64_tr_b16 a[54:55], v15 offset:4352
  v_mfma_f32_16x16x32_bf16 v[156:159], a[96:99], a[84:87], v[156:159]
  v_mfma_f32_16x16x32_bf16 v[160:163], a[100:103], a[56:59], v[160:163]
  ds_read_b128 a[24:27], v11 offset:6144
  v_mfma_f32_16x16x32_bf16 v[164:167], a[100:103], a[60:63], v[164:167]
  v_mfma_f32_16x16x32_bf16 v[168:171], a[100:103], a[64:67], v[168:171]
  ds_read_b128 a[28:31], v11 offset:7168
  v_mfma_f32_16x16x32_bf16 v[172:175], a[100:103], a[68:71], v[172:175]
  v_mfma_f32_16x16x32_bf16 v[176:179], a[100:103], a[72:75], v[176:179]
  s_add_u32 m0, s54, 32768
  s_add_u32 s56, s52, 832
  buffer_load_dwordx4 v8, s[8:11], s56 offen lds
  v_mfma_f32_16x16x32_bf16 v[180:183], a[100:103], a[76:79], v[180:183]
  v_mfma_f32_16x16x32_bf16 v[184:187], a[100:103], a[80:83], v[184:187]
  s_add_u32 m0, s54, 33792
  s_add_u32 s56, s52, 21312
  buffer_load_dwordx4 v8, s[8:11], s56 offen lds
  v_mfma_f32_16x16x32_bf16 v[188:191], a[100:103], a[84:87], v[188:191]
  v_mfma_f32_16x16x32_bf16 v[192:195], a[56:59], a[104:107], v[192:195]
  s_add_u32 m0, s55, 32768
  s_add_u32 s56, s53, 3407872
  buffer_load_dwordx4 v9, s[16:19], s56 offen lds
  v_mfma_f32_16x16x32_bf16 v[196:199], a[60:63], a[104:107], v[196:199]
  v_mfma_f32_16x16x32_bf16 v[200:203], a[64:67], a[104:107], v[200:203]
  s_add_u32 m0, s55, 33792
  s_add_u32 s56, s53, 3538944
  buffer_load_dwordx4 v9, s[16:19], s56 offen lds
  v_mfma_f32_16x16x32_bf16 v[204:207], a[68:71], a[104:107], v[204:207]
  v_mfma_f32_16x16x32_bf16 v[208:211], a[72:75], a[104:107], v[208:211]
  s_add_u32 m0, s55, 34816
  s_add_u32 s56, s53, 3407872
  buffer_load_dwordx4 v9, s[20:23], s56 offen lds
  v_mfma_f32_16x16x32_bf16 v[212:215], a[76:79], a[104:107], v[212:215]
  v_mfma_f32_16x16x32_bf16 v[216:219], a[80:83], a[104:107], v[216:219]
  s_add_u32 m0, s55, 35840
  s_add_u32 s56, s53, 3538944
  buffer_load_dwordx4 v9, s[20:23], s56 offen lds
  v_mfma_f32_16x16x32_bf16 v[220:223], a[84:87], a[104:107], v[220:223]
  v_mfma_f32_16x16x32_bf16 v[224:227], a[56:59], a[108:111], v[224:227]
  s_add_u32 m0, s55, 36864
  s_add_u32 s56, s53, 3407872
  buffer_load_dwordx4 v9, s[24:27], s56 offen lds
  v_mfma_f32_16x16x32_bf16 v[228:231], a[60:63], a[108:111], v[228:231]
  v_mfma_f32_16x16x32_bf16 v[232:235], a[64:67], a[108:111], v[232:235]
  s_add_u32 m0, s55, 37888
  s_add_u32 s56, s53, 3538944
  buffer_load_dwordx4 v9, s[24:27], s56 offen lds
  v_mfma_f32_16x16x32_bf16 v[236:239], a[68:71], a[108:111], v[236:239]
  v_mfma_f32_16x16x32_bf16 v[240:243], a[72:75], a[108:111], v[240:243]
  v_mfma_f32_16x16x32_bf16 v[244:247], a[76:79], a[108:111], v[244:247]
  v_mfma_f32_16x16x32_bf16 v[248:251], a[80:83], a[108:111], v[248:251]
  v_mfma_f32_16x16x32_bf16 v[252:255], a[84:87], a[108:111], v[252:255]
  s_waitcnt vmcnt(16) lgkmcnt(0)
  s_barrier
  v_mfma_f32_16x16x32_bf16 v[64:67], a[32:35], a[0:3], v[64:67]
  ds_read_b128 a[56:59], v11 offset:32768
  v_mfma_f32_16x16x32_bf16 v[68:71], a[32:35], a[4:7], v[68:71]
  v_mfma_f32_16x16x32_bf16 v[72:75], a[32:35], a[8:11], v[72:75]
  ds_read_b64_tr_b16 a[88:89], v13 offset:32768
  ds_read_b64_tr_b16 a[90:91], v13 offset:33024
  v_mfma_f32_16x16x32_bf16 v[76:79], a[32:35], a[12:15], v[76:79]
  v_mfma_f32_16x16x32_bf16 v[80:83], a[32:35], a[16:19], v[80:83]
  ds_read_b128 a[60:63], v11 offset:33792
  v_mfma_f32_16x16x32_bf16 v[84:87], a[32:35], a[20:23], v[84:87]
  v_mfma_f32_16x16x32_bf16 v[88:91], a[32:35], a[24:27], v[88:91]
  ds_read_b64_tr_b16 a[92:93], v15 offset:32768
  ds_read_b64_tr_b16 a[94:95], v15 offset:33024
  v_mfma_f32_16x16x32_bf16 v[92:95], a[32:35], a[28:31], v[92:95]
  v_mfma_f32_16x16x32_bf16 v[96:99], a[36:39], a[0:3], v[96:99]
  ds_read_b128 a[64:67], v11 offset:34816
  v_mfma_f32_16x16x32_bf16 v[100:103], a[36:39], a[4:7], v[100:103]
  v_mfma_f32_16x16x32_bf16 v[104:107], a[36:39], a[8:11], v[104:107]
  ds_read_b64_tr_b16 a[96:97], v13 offset:34816
  ds_read_b64_tr_b16 a[98:99], v13 offset:35072
  v_mfma_f32_16x16x32_bf16 v[108:111], a[36:39], a[12:15], v[108:111]
  v_mfma_f32_16x16x32_bf16 v[112:115], a[36:39], a[16:19], v[112:115]
  ds_read_b128 a[68:71], v11 offset:35840
  v_mfma_f32_16x16x32_bf16 v[116:119], a[36:39], a[20:23], v[116:119]
  v_mfma_f32_16x16x32_bf16 v[120:123], a[36:39], a[24:27], v[120:123]
  ds_read_b64_tr_b16 a[100:101], v15 offset:34816
  ds_read_b64_tr_b16 a[102:103], v15 offset:35072
  v_mfma_f32_16x16x32_bf16 v[124:127], a[36:39], a[28:31], v[124:127]
  v_mfma_f32_16x16x32_bf16 v[128:131], a[40:43], a[0:3], v[128:131]
  ds_read_b128 a[72:75], v11 offset:36864
  v_mfma_f32_16x16x32_bf16 v[132:135], a[40:43], a[4:7], v[132:135]
  v_mfma_f32_16x16x32_bf16 v[136:139], a[40:43], a[8:11], v[136:139]
  ds_read_b64_tr_b16 a[104:105], v13 offset:36864
  ds_read_b64_tr_b16 a[106:107], v13 offset:37120
  v_mfma_f32_16x16x32_bf16 v[140:143], a[40:43], a[12:15], v[140:143]
  v_mfma_f32_16x16x32_bf16 v[144:147], a[40:43], a[16:19], v[144:147]
  ds_read_b128 a[76:79], v11 offset:37888
  v_mfma_f32_16x16x32_bf16 v[148:151], a[40:43], a[20:23], v[148:151]
  v_mfma_f32_16x16x32_bf16 v[152:155], a[40:43], a[24:27], v[152:155]
  ds_read_b64_tr_b16 a[108:109], v15 offset:36864
  ds_read_b64_tr_b16 a[110:111], v15 offset:37120
  v_mfma_f32_16x16x32_bf16 v[156:159], a[40:43], a[28:31], v[156:159]
  v_mfma_f32_16x16x32_bf16 v[160:163], a[44:47], a[0:3], v[160:163]
  ds_read_b128 a[80:83], v11 offset:38912
  v_mfma_f32_16x16x32_bf16 v[164:167], a[44:47], a[4:7], v[164:167]
  v_mfma_f32_16x16x32_bf16 v[168:171], a[44:47], a[8:11], v[168:171]
  ds_read_b128 a[84:87], v11 offset:39936
  v_mfma_f32_16x16x32_bf16 v[172:175], a[44:47], a[12:15], v[172:175]
  v_mfma_f32_16x16x32_bf16 v[176:179], a[44:47], a[16:19], v[176:179]
  s_add_u32 m0, s54, 65536
  s_add_u32 s56, s52, 896
  buffer_load_dwordx4 v8, s[8:11], s56 offen lds
  v_mfma_f32_16x16x32_bf16 v[180:183], a[44:47], a[20:23], v[180:183]
  v_mfma_f32_16x16x32_bf16 v[184:187], a[44:47], a[24:27], v[184:187]
  s_add_u32 m0, s54, 66560
  s_add_u32 s56, s52, 21376
  buffer_load_dwordx4 v8, s[8:11], s56 offen lds
  v_mfma_f32_16x16x32_bf16 v[188:191], a[44:47], a[28:31], v[188:191]
  v_mfma_f32_16x16x32_bf16 v[192:195], a[0:3], a[48:51], v[192:195]
  s_add_u32 m0, s55, 65536
  s_add_u32 s56, s53, 3670016
  buffer_load_dwordx4 v9, s[16:19], s56 offen lds
  v_mfma_f32_16x16x32_bf16 v[196:199], a[4:7], a[48:51], v[196:199]
  v_mfma_f32_16x16x32_bf16 v[200:203], a[8:11], a[48:51], v[200:203]
  s_add_u32 m0, s55, 66560
  s_add_u32 s56, s53, 3801088
  buffer_load_dwordx4 v9, s[16:19], s56 offen lds
  v_mfma_f32_16x16x32_bf16 v[204:207], a[12:15], a[48:51], v[204:207]
  v_mfma_f32_16x16x32_bf16 v[208:211], a[16:19], a[48:51], v[208:211]
  s_add_u32 m0, s55, 67584
  s_add_u32 s56, s53, 3670016
  buffer_load_dwordx4 v9, s[20:23], s56 offen lds
  v_mfma_f32_16x16x32_bf16 v[212:215], a[20:23], a[48:51], v[212:215]
  v_mfma_f32_16x16x32_bf16 v[216:219], a[24:27], a[48:51], v[216:219]
  s_add_u32 m0, s55, 68608
  s_add_u32 s56, s53, 3801088
  buffer_load_dwordx4 v9, s[20:23], s56 offen lds
  v_mfma_f32_16x16x32_bf16 v[220:223], a[28:31], a[48:51], v[220:223]
  v_mfma_f32_16x16x32_bf16 v[224:227], a[0:3], a[52:55], v[224:227]
  s_add_u32 m0, s55, 69632
  s_add_u32 s56, s53, 3670016
  buffer_load_dwordx4 v9, s[24:27], s56 offen lds
  v_mfma_f32_16x16x32_bf16 v[228:231], a[4:7], a[52:55], v[228:231]
  v_mfma_f32_16x16x32_bf16 v[232:235], a[8:11], a[52:55], v[232:235]
  s_add_u32 m0, s55, 70656
  s_add_u32 s56, s53, 3801088
  buffer_load_dwordx4 v9, s[24:27], s56 offen lds
  v_mfma_f32_16x16x32_bf16 v[236:239], a[12:15], a[52:55], v[236:239]
  v_mfma_f32_16x16x32_bf16 v[240:243], a[16:19], a[52:55], v[240:243]
  v_mfma_f32_16x16x32_bf16 v[244:247], a[20:23], a[52:55], v[244:247]
  v_mfma_f32_16x16x32_bf16 v[248:251], a[24:27], a[52:55], v[248:251]
  v_mfma_f32_16x16x32_bf16 v[252:255], a[28:31], a[52:55], v[252:255]
  s_waitcnt vmcnt(16) lgkmcnt(0)
  s_barrier
  v_mfma_f32_16x16x32_bf16 v[64:67], a[88:91], a[56:59], v[64:67]
  ds_read_b128 a[0:3], v10 offset:0
  v_mfma_f32_16x16x32_bf16 v[68:71], a[88:91], a[60:63], v[68:71]
  v_mfma_f32_16x16x32_bf16 v[72:75], a[88:91], a[64:67], v[72:75]
  ds_read_b64_tr_b16 a[32:33], v12 offset:0
  ds_read_b64_tr_b16 a[34:35], v12 offset:256
  v_mfma_f32_16x16x32_bf16 v[76:79], a[88:91], a[68:71], v[76:79]
  v_mfma_f32_16x16x32_bf16 v[80:83], a[88:91], a[72:75], v[80:83]
  ds_read_b128 a[4:7], v10 offset:1024
  v_mfma_f32_16x16x32_bf16 v[84:87], a[88:91], a[76:79], v[84:87]
  v_mfma_f32_16x16x32_bf16 v[88:91], a[88:91], a[80:83], v[88:91]
  ds_read_b64_tr_b16 a[36:37], v14 offset:0
  ds_read_b64_tr_b16 a[38:39], v14 offset:256
  v_mfma_f32_16x16x32_bf16 v[92:95], a[88:91], a[84:87], v[92:95]
  v_mfma_f32_16x16x32_bf16 v[96:99], a[92:95], a[56:59], v[96:99]
  ds_read_b128 a[8:11], v10 offset:2048
  v_mfma_f32_16x16x32_bf16 v[100:103], a[92:95], a[60:63], v[100:103]
  v_mfma_f32_16x16x32_bf16 v[104:107], a[92:95], a[64:67], v[104:107]
  ds_read_b64_tr_b16 a[40:41], v12 offset:2048
  ds_read_b64_tr_b16 a[42:43], v12 offset:2304
  v_mfma_f32_16x16x32_bf16 v[108:111], a[92:95], a[68:71], v[108:111]
  v_mfma_f32_16x16x32_bf16 v[112:115], a[92:95], a[72:75], v[112:115]
  ds_read_b128 a[12:15], v10 offset:3072
  v_mfma_f32_16x16x32_bf16 v[116:119], a[92:95], a[76:79], v[116:119]
  v_mfma_f32_16x16x32_bf16 v[120:123], a[92:95], a[80:83], v[120:123]
  ds_read_b64_tr_b16 a[44:45], v14 offset:2048
  ds_read_b64_tr_b16 a[46:47], v14 offset:2304
  v_mfma_f32_16x16x32_bf16 v[124:127], a[92:95], a[84:87], v[124:127]
  v_mfma_f32_16x16x32_bf16 v[128:131], a[96:99], a[56:59], v[128:131]
  ds_read_b128 a[16:19], v10 offset:4096
  v_mfma_f32_16x16x32_bf16 v[132:135], a[96:99], a[60:63], v[132:135]
  v_mfma_f32_16x16x32_bf16 v[136:139], a[96:99], a[64:67], v[136:139]
  ds_read_b64_tr_b16 a[48:49], v12 offset:4096
  ds_read_b64_tr_b16 a[50:51], v12 offset:4352
  v_mfma_f32_16x16x32_bf16 v[140:143], a[96:99], a[68:71], v[140:143]
  v_mfma_f32_16x16x32_bf16 v[144:147], a[96:99], a[72:75], v[144:147]
  ds_read_b128 a[20:23], v10 offset:5120
  v_mfma_f32_16x16x32_bf16 v[148:151], a[96:99], a[76:79], v[148:151]
  v_mfma_f32_16x16x32_bf16 v[152:155], a[96:99], a[80:83], v[152:155]
  ds_read_b64_tr_b16 a[52:53], v14 offset:4096
  ds_read_b64_tr_b16 a[54:55], v14 offset:4352
  v_mfma_f32_16x16x32_bf16 v[156:159], a[96:99], a[84:87], v[156:159]
  v_mfma_f32_16x16x32_bf16 v[160:163], a[100:103], a[56:59], v[160:163]
  ds_read_b128 a[24:27], v10 offset:6144
  v_mfma_f32_16x16x32_bf16 v[164:167], a[100:103], a[60:63], v[164:167]
  v_mfma_f32_16x16x32_bf16 v[168:171], a[100:103], a[64:67], v[168:171]
  ds_read_b128 a[28:31], v10 offset:7168
  v_mfma_f32_16x16x32_bf16 v[172:175], a[100:103], a[68:71], v[172:175]
  v_mfma_f32_16x16x32_bf16 v[176:179], a[100:103], a[72:75], v[176:179]
  s_add_u32 m0, s54, 98304
  s_add_u32 s56, s52, 960
  buffer_load_dwordx4 v8, s[8:11], s56 offen lds
  v_mfma_f32_16x16x32_bf16 v[180:183], a[100:103], a[76:79], v[180:183]
  v_mfma_f32_16x16x32_bf16 v[184:187], a[100:103], a[80:83], v[184:187]
  s_add_u32 m0, s54, 99328
  s_add_u32 s56, s52, 21440
  buffer_load_dwordx4 v8, s[8:11], s56 offen lds
  v_mfma_f32_16x16x32_bf16 v[188:191], a[100:103], a[84:87], v[188:191]
  v_mfma_f32_16x16x32_bf16 v[192:195], a[56:59], a[104:107], v[192:195]
  s_add_u32 m0, s55, 98304
  s_add_u32 s56, s53, 3932160
  buffer_load_dwordx4 v9, s[16:19], s56 offen lds
  v_mfma_f32_16x16x32_bf16 v[196:199], a[60:63], a[104:107], v[196:199]
  v_mfma_f32_16x16x32_bf16 v[200:203], a[64:67], a[104:107], v[200:203]
  s_add_u32 m0, s55, 99328
  s_add_u32 s56, s53, 4063232
  buffer_load_dwordx4 v9, s[16:19], s56 offen lds
  v_mfma_f32_16x16x32_bf16 v[204:207], a[68:71], a[104:107], v[204:207]
  v_mfma_f32_16x16x32_bf16 v[208:211], a[72:75], a[104:107], v[208:211]
  s_add_u32 m0, s55, 100352
  s_add_u32 s56, s53, 3932160
  buffer_load_dwordx4 v9, s[20:23], s56 offen lds
  v_mfma_f32_16x16x32_bf16 v[212:215], a[76:79], a[104:107], v[212:215]
  v_mfma_f32_16x16x32_bf16 v[216:219], a[80:83], a[104:107], v[216:219]
  s_add_u32 m0, s55, 101376
  s_add_u32 s56, s53, 4063232
  buffer_load_dwordx4 v9, s[20:23], s56 offen lds
  v_mfma_f32_16x16x32_bf16 v[220:223], a[84:87], a[104:107], v[220:223]
  v_mfma_f32_16x16x32_bf16 v[224:227], a[56:59], a[108:111], v[224:227]
  s_add_u32 m0, s55, 102400
  s_add_u32 s56, s53, 3932160
  buffer_load_dwordx4 v9, s[24:27], s56 offen lds
  v_mfma_f32_16x16x32_bf16 v[228:231], a[60:63], a[108:111], v[228:231]
  v_mfma_f32_16x16x32_bf16 v[232:235], a[64:67], a[108:111], v[232:235]
  s_add_u32 m0, s55, 103424
  s_add_u32 s56, s53, 4063232
  buffer_load_dwordx4 v9, s[24:27], s56 offen lds
  v_mfma_f32_16x16x32_bf16 v[236:239], a[68:71], a[108:111], v[236:239]
  v_mfma_f32_16x16x32_bf16 v[240:243], a[72:75], a[108:111], v[240:243]
  v_mfma_f32_16x16x32_bf16 v[244:247], a[76:79], a[108:111], v[244:247]
  v_mfma_f32_16x16x32_bf16 v[248:251], a[80:83], a[108:111], v[248:251]
  v_mfma_f32_16x16x32_bf16 v[252:255], a[84:87], a[108:111], v[252:255]
  s_waitcnt vmcnt(16) lgkmcnt(0)
  s_barrier
  v_mfma_f32_16x16x32_bf16 v[64:67], a[32:35], a[0:3], v[64:67]
  ds_read_b128 a[56:59], v10 offset:32768
  v_mfma_f32_16x16x32_bf16 v[68:71], a[32:35], a[4:7], v[68:71]
  v_mfma_f32_16x16x32_bf16 v[72:75], a[32:35], a[8:11], v[72:75]
  ds_read_b64_tr_b16 a[88:89], v12 offset:32768
  ds_read_b64_tr_b16 a[90:91], v12 offset:33024
  v_mfma_f32_16x16x32_bf16 v[76:79], a[32:35], a[12:15], v[76:79]
  v_mfma_f32_16x16x32_bf16 v[80:83], a[32:35], a[16:19], v[80:83]
  ds_read_b128 a[60:63], v10 offset:33792
  v_mfma_f32_16x16x32_bf16 v[84:87], a[32:35], a[20:23], v[84:87]
  v_mfma_f32_16x16x32_bf16 v[88:91], a[32:35], a[24:27], v[88:91]
  ds_read_b64_tr_b16 a[92:93], v14 offset:32768
  ds_read_b64_tr_b16 a[94:95], v14 offset:33024
  v_mfma_f32_16x16x32_bf16 v[92:95], a[32:35], a[28:31], v[92:95]
  v_mfma_f32_16x16x32_bf16 v[96:99], a[36:39], a[0:3], v[96:99]
  ds_read_b128 a[64:67], v10 offset:34816
  v_mfma_f32_16x16x32_bf16 v[100:103], a[36:39], a[4:7], v[100:103]
  v_mfma_f32_16x16x32_bf16 v[104:107], a[36:39], a[8:11], v[104:107]
  ds_read_b64_tr_b16 a[96:97], v12 offset:34816
  ds_read_b64_tr_b16 a[98:99], v12 offset:35072
  v_mfma_f32_16x16x32_bf16 v[108:111], a[36:39], a[12:15], v[108:111]
  v_mfma_f32_16x16x32_bf16 v[112:115], a[36:39], a[16:19], v[112:115]
  ds_read_b128 a[68:71], v10 offset:35840
  v_mfma_f32_16x16x32_bf16 v[116:119], a[36:39], a[20:23], v[116:119]
  v_mfma_f32_16x16x32_bf16 v[120:123], a[36:39], a[24:27], v[120:123]
  ds_read_b64_tr_b16 a[100:101], v14 offset:34816
  ds_read_b64_tr_b16 a[102:103], v14 offset:35072
  v_mfma_f32_16x16x32_bf16 v[124:127], a[36:39], a[28:31], v[124:127]
  v_mfma_f32_16x16x32_bf16 v[128:131], a[40:43], a[0:3], v[128:131]
  ds_read_b128 a[72:75], v10 offset:36864
  v_mfma_f32_16x16x32_bf16 v[132:135], a[40:43], a[4:7], v[132:135]
  v_mfma_f32_16x16x32_bf16 v[136:139], a[40:43], a[8:11], v[136:139]
  ds_read_b64_tr_b16 a[104:105], v12 offset:36864
  ds_read_b64_tr_b16 a[106:107], v12 offset:37120
  v_mfma_f32_16x16x32_bf16 v[140:143], a[40:43], a[12:15], v[140:143]
  v_mfma_f32_16x16x32_bf16 v[144:147], a[40:43], a[16:19], v[144:147]
  ds_read_b128 a[76:79], v10 offset:37888
  v_mfma_f32_16x16x32_bf16 v[148:151], a[40:43], a[20:23], v[148:151]
  v_mfma_f32_16x16x32_bf16 v[152:155], a[40:43], a[24:27], v[152:155]
  ds_read_b64_tr_b16 a[108:109], v14 offset:36864
  ds_read_b64_tr_b16 a[110:111], v14 offset:37120
  v_mfma_f32_16x16x32_bf16 v[156:159], a[40:43], a[28:31], v[156:159]
  v_mfma_f32_16x16x32_bf16 v[160:163], a[44:47], a[0:3], v[160:163]
  ds_read_b128 a[80:83], v10 offset:38912
  v_mfma_f32_16x16x32_bf16 v[164:167], a[44:47], a[4:7], v[164:167]
  v_mfma_f32_16x16x32_bf16 v[168:171], a[44:47], a[8:11], v[168:171]
  ds_read_b128 a[84:87], v10 offset:39936
  v_mfma_f32_16x16x32_bf16 v[172:175], a[44:47], a[12:15], v[172:175]
  v_mfma_f32_16x16x32_bf16 v[176:179], a[44:47], a[16:19], v[176:179]
  s_add_u32 m0, s54, 0
  s_add_u32 s56, s52, 1024
  buffer_load_dwordx4 v8, s[8:11], s56 offen lds
  v_mfma_f32_16x16x32_bf16 v[180:183], a[44:47], a[20:23], v[180:183]
  v_mfma_f32_16x16x32_bf16 v[184:187], a[44:47], a[24:27], v[184:187]
  s_add_u32 m0, s54, 1024
  s_add_u32 s56, s52, 21504
  buffer_load_dwordx4 v8, s[8:11], s56 offen lds
  v_mfma_f32_16x16x32_bf16 v[188:191], a[44:47], a[28:31], v[188:191]
  v_mfma_f32_16x16x32_bf16 v[192:195], a[0:3], a[48:51], v[192:195]
  s_add_u32 m0, s55, 0
  s_add_u32 s56, s53, 4194304
  buffer_load_dwordx4 v9, s[16:19], s56 offen lds
  v_mfma_f32_16x16x32_bf16 v[196:199], a[4:7], a[48:51], v[196:199]
  v_mfma_f32_16x16x32_bf16 v[200:203], a[8:11], a[48:51], v[200:203]
  s_add_u32 m0, s55, 1024
  s_add_u32 s56, s53, 4325376
  buffer_load_dwordx4 v9, s[16:19], s56 offen lds
  v_mfma_f32_16x16x32_bf16 v[204:207], a[12:15], a[48:51], v[204:207]
  v_mfma_f32_16x16x32_bf16 v[208:211], a[16:19], a[48:51], v[208:211]
  s_add_u32 m0, s55, 2048
  s_add_u32 s56, s53, 4194304
  buffer_load_dwordx4 v9, s[20:23], s56 offen lds
  v_mfma_f32_16x16x32_bf16 v[212:215], a[20:23], a[48:51], v[212:215]
  v_mfma_f32_16x16x32_bf16 v[216:219], a[24:27], a[48:51], v[216:219]
  s_add_u32 m0, s55, 3072
  s_add_u32 s56, s53, 4325376
  buffer_load_dwordx4 v9, s[20:23], s56 offen lds
  v_mfma_f32_16x16x32_bf16 v[220:223], a[28:31], a[48:51], v[220:223]
  v_mfma_f32_16x16x32_bf16 v[224:227], a[0:3], a[52:55], v[224:227]
  s_add_u32 m0, s55, 4096
  s_add_u32 s56, s53, 4194304
  buffer_load_dwordx4 v9, s[24:27], s56 offen lds
  v_mfma_f32_16x16x32_bf16 v[228:231], a[4:7], a[52:55], v[228:231]
  v_mfma_f32_16x16x32_bf16 v[232:235], a[8:11], a[52:55], v[232:235]
  s_add_u32 m0, s55, 5120
  s_add_u32 s56, s53, 4325376
  buffer_load_dwordx4 v9, s[24:27], s56 offen lds
  v_mfma_f32_16x16x32_bf16 v[236:239], a[12:15], a[52:55], v[236:239]
  v_mfma_f32_16x16x32_bf16 v[240:243], a[16:19], a[52:55], v[240:243]
  v_mfma_f32_16x16x32_bf16 v[244:247], a[20:23], a[52:55], v[244:247]
  v_mfma_f32_16x16x32_bf16 v[248:251], a[24:27], a[52:55], v[248:251]
  v_mfma_f32_16x16x32_bf16 v[252:255], a[28:31], a[52:55], v[252:255]
  s_waitcnt vmcnt(16) lgkmcnt(0)
  s_barrier
  v_mfma_f32_16x16x32_bf16 v[64:67], a[88:91], a[56:59], v[64:67]
  ds_read_b128 a[0:3], v11 offset:0
  v_mfma_f32_16x16x32_bf16 v[68:71], a[88:91], a[60:63], v[68:71]
  v_mfma_f32_16x16x32_bf16 v[72:75], a[88:91], a[64:67], v[72:75]
  ds_read_b64_tr_b16 a[32:33], v13 offset:0
  ds_read_b64_tr_b16 a[34:35], v13 offset:256
  v_mfma_f32_16x16x32_bf16 v[76:79], a[88:91], a[68:71], v[76:79]
  v_mfma_f32_16x16x32_bf16 v[80:83], a[88:91], a[72:75], v[80:83]
  ds_read_b128 a[4:7], v11 offset:1024
  v_mfma_f32_16x16x32_bf16 v[84:87], a[88:91], a[76:79], v[84:87]
  v_mfma_f32_16x16x32_bf16 v[88:91], a[88:91], a[80:83], v[88:91]
  ds_read_b64_tr_b16 a[36:37], v15 offset:0
  ds_read_b64_tr_b16 a[38:39], v15 offset:256
  v_mfma_f32_16x16x32_bf16 v[92:95], a[88:91], a[84:87], v[92:95]
  v_mfma_f32_16x16x32_bf16 v[96:99], a[92:95], a[56:59], v[96:99]
  ds_read_b128 a[8:11], v11 offset:2048
  v_mfma_f32_16x16x32_bf16 v[100:103], a[92:95], a[60:63], v[100:103]
  v_mfma_f32_16x16x32_bf16 v[104:107], a[92:95], a[64:67], v[104:107]
  ds_read_b64_tr_b16 a[40:41], v13 offset:2048
  ds_read_b64_tr_b16 a[42:43], v13 offset:2304
  v_mfma_f32_16x16x32_bf16 v[108:111], a[92:95], a[68:71], v[108:111]
  v_mfma_f32_16x16x32_bf16 v[112:115], a[92:95], a[72:75], v[112:115]
  ds_read_b128 a[12:15], v11 offset:3072
  v_mfma_f32_16x16x32_bf16 v[116:119], a[92:95], a[76:79], v[116:119]
  v_mfma_f32_16x16x32_bf16 v[120:123], a[92:95], a[80:83], v[120:123]
  ds_read_b64_tr_b16 a[44:45], v15 offset:2048
  ds_read_b64_tr_b16 a[46:47], v15 offset:2304
  v_mfma_f32_16x16x32_bf16 v[124:127], a[92:95], a[84:87], v[124:127]
  v_mfma_f32_16x16x32_bf16 v[128:131], a[96:99], a[56:59], v[128:131]
  ds_read_b128 a[16:19], v11 offset:4096
  v_mfma_f32_16x16x32_bf16 v[132:135], a[96:99], a[60:63], v[132:135]
  v_mfma_f32_16x16x32_bf16 v[136:139], a[96:99], a[64:67], v[136:139]
  ds_read_b64_tr_b16 a[48:49], v13 offset:4096
  ds_read_b64_tr_b16 a[50:51], v13 offset:4352
  v_mfma_f32_16x16x32_bf16 v[140:143], a[96:99], a[68:71], v[140:143]
  v_mfma_f32_16x16x32_bf16 v[144:147], a[96:99], a[72:75], v[144:147]
  ds_read_b128 a[20:23], v11 offset:5120
  v_mfma_f32_16x16x32_bf16 v[148:151], a[96:99], a[76:79], v[148:151]
  v_mfma_f32_16x16x32_bf16 v[152:155], a[96:99], a[80:83], v[152:155]
  ds_read_b64_tr_b16 a[52:53], v15 offset:4096
  ds_read_b64_tr_b16 a[54:55], v15 offset:4352
  v_mfma_f32_16x16x32_bf16 v[156:159], a[96:99], a[84:87], v[156:159]
  v_mfma_f32_16x16x32_bf16 v[160:163], a[100:103], a[56:59], v[160:163]
  ds_read_b128 a[24:27], v11 offset:6144
  v_mfma_f32_16x16x32_bf16 v[164:167], a[100:103], a[60:63], v[164:167]
  v_mfma_f32_16x16x32_bf16 v[168:171], a[100:103], a[64:67], v[168:171]
  ds_read_b128 a[28:31], v11 offset:7168
  v_mfma_f32_16x16x32_bf16 v[172:175], a[100:103], a[68:71], v[172:175]
  v_mfma_f32_16x16x32_bf16 v[176:179], a[100:103], a[72:75], v[176:179]
  s_add_u32 m0, s54, 32768
  s_add_u32 s56, s52, 1088
  buffer_load_dwordx4 v8, s[8:11], s56 offen lds
  v_mfma_f32_16x16x32_bf16 v[180:183], a[100:103], a[76:79], v[180:183]
  v_mfma_f32_16x16x32_bf16 v[184:187], a[100:103], a[80:83], v[184:187]
  s_add_u32 m0, s54, 33792
  s_add_u32 s56, s52, 21568
  buffer_load_dwordx4 v8, s[8:11], s56 offen lds
  v_mfma_f32_16x16x32_bf16 v[188:191], a[100:103], a[84:87], v[188:191]
  v_mfma_f32_16x16x32_bf16 v[192:195], a[56:59], a[104:107], v[192:195]
  s_add_u32 m0, s55, 32768
  s_add_u32 s56, s53, 4456448
  buffer_load_dwordx4 v9, s[16:19], s56 offen lds
  v_mfma_f32_16x16x32_bf16 v[196:199], a[60:63], a[104:107], v[196:199]
  v_mfma_f32_16x16x32_bf16 v[200:203], a[64:67], a[104:107], v[200:203]
  s_add_u32 m0, s55, 33792
  s_add_u32 s56, s53, 4587520
  buffer_load_dwordx4 v9, s[16:19], s56 offen lds
  v_mfma_f32_16x16x32_bf16 v[204:207], a[68:71], a[104:107], v[204:207]
  v_mfma_f32_16x16x32_bf16 v[208:211], a[72:75], a[104:107], v[208:211]
  s_add_u32 m0, s55, 34816
  s_add_u32 s56, s53, 4456448
  buffer_load_dwordx4 v9, s[20:23], s56 offen lds
  v_mfma_f32_16x16x32_bf16 v[212:215], a[76:79], a[104:107], v[212:215]
  v_mfma_f32_16x16x32_bf16 v[216:219], a[80:83], a[104:107], v[216:219]
  s_add_u32 m0, s55, 35840
  s_add_u32 s56, s53, 4587520
  buffer_load_dwordx4 v9, s[20:23], s56 offen lds
  v_mfma_f32_16x16x32_bf16 v[220:223], a[84:87], a[104:107], v[220:223]
  v_mfma_f32_16x16x32_bf16 v[224:227], a[56:59], a[108:111], v[224:227]
  s_add_u32 m0, s55, 36864
  s_add_u32 s56, s53, 4456448
  buffer_load_dwordx4 v9, s[24:27], s56 offen lds
  v_mfma_f32_16x16x32_bf16 v[228:231], a[60:63], a[108:111], v[228:231]
  v_mfma_f32_16x16x32_bf16 v[232:235], a[64:67], a[108:111], v[232:235]
  s_add_u32 m0, s55, 37888
  s_add_u32 s56, s53, 4587520
  buffer_load_dwordx4 v9, s[24:27], s56 offen lds
  v_mfma_f32_16x16x32_bf16 v[236:239], a[68:71], a[108:111], v[236:239]
  v_mfma_f32_16x16x32_bf16 v[240:243], a[72:75], a[108:111], v[240:243]
  v_mfma_f32_16x16x32_bf16 v[244:247], a[76:79], a[108:111], v[244:247]
  v_mfma_f32_16x16x32_bf16 v[248:251], a[80:83], a[108:111], v[248:251]
  v_mfma_f32_16x16x32_bf16 v[252:255], a[84:87], a[108:111], v[252:255]
  s_waitcnt vmcnt(16) lgkmcnt(0)
  s_barrier
  v_mfma_f32_16x16x32_bf16 v[64:67], a[32:35], a[0:3], v[64:67]
  ds_read_b128 a[56:59], v11 offset:32768
  v_mfma_f32_16x16x32_bf16 v[68:71], a[32:35], a[4:7], v[68:71]
  v_mfma_f32_16x16x32_bf16 v[72:75], a[32:35], a[8:11], v[72:75]
  ds_read_b64_tr_b16 a[88:89], v13 offset:32768
  ds_read_b64_tr_b16 a[90:91], v13 offset:33024
  v_mfma_f32_16x16x32_bf16 v[76:79], a[32:35], a[12:15], v[76:79]
  v_mfma_f32_16x16x32_bf16 v[80:83], a[32:35], a[16:19], v[80:83]
  ds_read_b128 a[60:63], v11 offset:33792
  v_mfma_f32_16x16x32_bf16 v[84:87], a[32:35], a[20:23], v[84:87]
  v_mfma_f32_16x16x32_bf16 v[88:91], a[32:35], a[24:27], v[88:91]
  ds_read_b64_tr_b16 a[92:93], v15 offset:32768
  ds_read_b64_tr_b16 a[94:95], v15 offset:33024
  v_mfma_f32_16x16x32_bf16 v[92:95], a[32:35], a[28:31], v[92:95]
  v_mfma_f32_16x16x32_bf16 v[96:99], a[36:39], a[0:3], v[96:99]
  ds_read_b128 a[64:67], v11 offset:34816
  v_mfma_f32_16x16x32_bf16 v[100:103], a[36:39], a[4:7], v[100:103]
  v_mfma_f32_16x16x32_bf16 v[104:107], a[36:39], a[8:11], v[104:107]
  ds_read_b64_tr_b16 a[96:97], v13 offset:34816
  ds_read_b64_tr_b16 a[98:99], v13 offset:35072
  v_mfma_f32_16x16x32_bf16 v[108:111], a[36:39], a[12:15], v[108:111]
  v_mfma_f32_16x16x32_bf16 v[112:115], a[36:39], a[16:19], v[112:115]
  ds_read_b128 a[68:71], v11 offset:35840
  v_mfma_f32_16x16x32_bf16 v[116:119], a[36:39], a[20:23], v[116:119]
  v_mfma_f32_16x16x32_bf16 v[120:123], a[36:39], a[24:27], v[120:123]
  ds_read_b64_tr_b16 a[100:101], v15 offset:34816
  ds_read_b64_tr_b16 a[102:103], v15 offset:35072
  v_mfma_f32_16x16x32_bf16 v[124:127], a[36:39], a[28:31], v[124:127]
  v_mfma_f32_16x16x32_bf16 v[128:131], a[40:43], a[0:3], v[128:131]
  ds_read_b128 a[72:75], v11 offset:36864
  v_mfma_f32_16x16x32_bf16 v[132:135], a[40:43], a[4:7], v[132:135]
  v_mfma_f32_16x16x32_bf16 v[136:139], a[40:43], a[8:11], v[136:139]
  ds_read_b64_tr_b16 a[104:105], v13 offset:36864
  ds_read_b64_tr_b16 a[106:107], v13 offset:37120
  v_mfma_f32_16x16x32_bf16 v[140:143], a[40:43], a[12:15], v[140:143]
  v_mfma_f32_16x16x32_bf16 v[144:147], a[40:43], a[16:19], v[144:147]
  ds_read_b128 a[76:79], v11 offset:37888
  v_mfma_f32_16x16x32_bf16 v[148:151], a[40:43], a[20:23], v[148:151]
  v_mfma_f32_16x16x32_bf16 v[152:155], a[40:43], a[24:27], v[152:155]
  ds_read_b64_tr_b16 a[108:109], v15 offset:36864
  ds_read_b64_tr_b16 a[110:111], v15 offset:37120
  v_mfma_f32_16x16x32_bf16 v[156:159], a[40:43], a[28:31], v[156:159]
  v_mfma_f32_16x16x32_bf16 v[160:163], a[44:47], a[0:3], v[160:163]
  ds_read_b128 a[80:83], v11 offset:38912
  v_mfma_f32_16x16x32_bf16 v[164:167], a[44:47], a[4:7], v[164:167]
  v_mfma_f32_16x16x32_bf16 v[168:171], a[44:47], a[8:11], v[168:171]
  ds_read_b128 a[84:87], v11 offset:39936
  v_mfma_f32_16x16x32_bf16 v[172:175], a[44:47], a[12:15], v[172:175]
  v_mfma_f32_16x16x32_bf16 v[176:179], a[44:47], a[16:19], v[176:179]
  s_add_u32 m0, s54, 65536
  s_add_u32 s56, s52, 1152
  buffer_load_dwordx4 v8, s[8:11], s56 offen lds
  v_mfma_f32_16x16x32_bf16 v[180:183], a[44:47], a[20:23], v[180:183]
  v_mfma_f32_16x16x32_bf16 v[184:187], a[44:47], a[24:27], v[184:187]
  s_add_u32 m0, s54, 66560
  s_add_u32 s56, s52, 21632
  buffer_load_dwordx4 v8, s[8:11], s56 offen lds
  v_mfma_f32_16x16x32_bf16 v[188:191], a[44:47], a[28:31], v[188:191]
  v_mfma_f32_16x16x32_bf16 v[192:195], a[0:3], a[48:51], v[192:195]
  s_add_u32 m0, s55, 65536
  s_add_u32 s56, s53, 4718592
  buffer_load_dwordx4 v9, s[16:19], s56 offen lds
  v_mfma_f32_16x16x32_bf16 v[196:199], a[4:7], a[48:51], v[196:199]
  v_mfma_f32_16x16x32_bf16 v[200:203], a[8:11], a[48:51], v[200:203]
  s_add_u32 m0, s55, 66560
  s_add_u32 s56, s53, 4849664
  buffer_load_dwordx4 v9, s[16:19], s56 offen lds
  v_mfma_f32_16x16x32_bf16 v[204:207], a[12:15], a[48:51], v[204:207]
  v_mfma_f32_16x16x32_bf16 v[208:211], a[16:19], a[48:51], v[208:211]
  s_add_u32 m0, s55, 67584
  s_add_u32 s56, s53, 4718592
  buffer_load_dwordx4 v9, s[20:23], s56 offen lds
  v_mfma_f32_16x16x32_bf16 v[212:215], a[20:23], a[48:51], v[212:215]
  v_mfma_f32_16x16x32_bf16 v[216:219], a[24:27], a[48:51], v[216:219]
  s_add_u32 m0, s55, 68608
  s_add_u32 s56, s53, 4849664
  buffer_load_dwordx4 v9, s[20:23], s56 offen lds
  v_mfma_f32_16x16x32_bf16 v[220:223], a[28:31], a[48:51], v[220:223]
  v_mfma_f32_16x16x32_bf16 v[224:227], a[0:3], a[52:55], v[224:227]
  s_add_u32 m0, s55, 69632
  s_add_u32 s56, s53, 4718592
  buffer_load_dwordx4 v9, s[24:27], s56 offen lds
  v_mfma_f32_16x16x32_bf16 v[228:231], a[4:7], a[52:55], v[228:231]
  v_mfma_f32_16x16x32_bf16 v[232:235], a[8:11], a[52:55], v[232:235]
  s_add_u32 m0, s55, 70656
  s_add_u32 s56, s53, 4849664
  buffer_load_dwordx4 v9, s[24:27], s56 offen lds
  v_mfma_f32_16x16x32_bf16 v[236:239], a[12:15], a[52:55], v[236:239]
  v_mfma_f32_16x16x32_bf16 v[240:243], a[16:19], a[52:55], v[240:243]
  v_mfma_f32_16x16x32_bf16 v[244:247], a[20:23], a[52:55], v[244:247]
  v_mfma_f32_16x16x32_bf16 v[248:251], a[24:27], a[52:55], v[248:251]
  v_mfma_f32_16x16x32_bf16 v[252:255], a[28:31], a[52:55], v[252:255]
  s_waitcnt vmcnt(16) lgkmcnt(0)
  s_barrier
  v_mfma_f32_16x16x32_bf16 v[64:67], a[88:91], a[56:59], v[64:67]
  ds_read_b128 a[0:3], v10 offset:0
  v_mfma_f32_16x16x32_bf16 v[68:71], a[88:91], a[60:63], v[68:71]
  v_mfma_f32_16x16x32_bf16 v[72:75], a[88:91], a[64:67], v[72:75]
  ds_read_b64_tr_b16 a[32:33], v12 offset:0
  ds_read_b64_tr_b16 a[34:35], v12 offset:256
  v_mfma_f32_16x16x32_bf16 v[76:79], a[88:91], a[68:71], v[76:79]
  v_mfma_f32_16x16x32_bf16 v[80:83], a[88:91], a[72:75], v[80:83]
  ds_read_b128 a[4:7], v10 offset:1024
  v_mfma_f32_16x16x32_bf16 v[84:87], a[88:91], a[76:79], v[84:87]
  v_mfma_f32_16x16x32_bf16 v[88:91], a[88:91], a[80:83], v[88:91]
  ds_read_b64_tr_b16 a[36:37], v14 offset:0
  ds_read_b64_tr_b16 a[38:39], v14 offset:256
  v_mfma_f32_16x16x32_bf16 v[92:95], a[88:91], a[84:87], v[92:95]
  v_mfma_f32_16x16x32_bf16 v[96:99], a[92:95], a[56:59], v[96:99]
  ds_read_b128 a[8:11], v10 offset:2048
  v_mfma_f32_16x16x32_bf16 v[100:103], a[92:95], a[60:63], v[100:103]
  v_mfma_f32_16x16x32_bf16 v[104:107], a[92:95], a[64:67], v[104:107]
  ds_read_b64_tr_b16 a[40:41], v12 offset:2048
  ds_read_b64_tr_b16 a[42:43], v12 offset:2304
  v_mfma_f32_16x16x32_bf16 v[108:111], a[92:95], a[68:71], v[108:111]
  v_mfma_f32_16x16x32_bf16 v[112:115], a[92:95], a[72:75], v[112:115]
  ds_read_b128 a[12:15], v10 offset:3072
  v_mfma_f32_16x16x32_bf16 v[116:119], a[92:95], a[76:79], v[116:119]
  v_mfma_f32_16x16x32_bf16 v[120:123], a[92:95], a[80:83], v[120:123]
  ds_read_b64_tr_b16 a[44:45], v14 offset:2048
  ds_read_b64_tr_b16 a[46:47], v14 offset:2304
  v_mfma_f32_16x16x32_bf16 v[124:127], a[92:95], a[84:87], v[124:127]
  v_mfma_f32_16x16x32_bf16 v[128:131], a[96:99], a[56:59], v[128:131]
  ds_read_b128 a[16:19], v10 offset:4096
  v_mfma_f32_16x16x32_bf16 v[132:135], a[96:99], a[60:63], v[132:135]
  v_mfma_f32_16x16x32_bf16 v[136:139], a[96:99], a[64:67], v[136:139]
  ds_read_b64_tr_b16 a[48:49], v12 offset:4096
  ds_read_b64_tr_b16 a[50:51], v12 offset:4352
  v_mfma_f32_16x16x32_bf16 v[140:143], a[96:99], a[68:71], v[140:143]
  v_mfma_f32_16x16x32_bf16 v[144:147], a[96:99], a[72:75], v[144:147]
  ds_read_b128 a[20:23], v10 offset:5120
  v_mfma_f32_16x16x32_bf16 v[148:151], a[96:99], a[76:79], v[148:151]
  v_mfma_f32_16x16x32_bf16 v[152:155], a[96:99], a[80:83], v[152:155]
  ds_read_b64_tr_b16 a[52:53], v14 offset:4096
  ds_read_b64_tr_b16 a[54:55], v14 offset:4352
  v_mfma_f32_16x16x32_bf16 v[156:159], a[96:99], a[84:87], v[156:159]
  v_mfma_f32_16x16x32_bf16 v[160:163], a[100:103], a[56:59], v[160:163]
  ds_read_b128 a[24:27], v10 offset:6144
  v_mfma_f32_16x16x32_bf16 v[164:167], a[100:103], a[60:63], v[164:167]
  v_mfma_f32_16x16x32_bf16 v[168:171], a[100:103], a[64:67], v[168:171]
  ds_read_b128 a[28:31], v10 offset:7168
  v_mfma_f32_16x16x32_bf16 v[172:175], a[100:103], a[68:71], v[172:175]
  v_mfma_f32_16x16x32_bf16 v[176:179], a[100:103], a[72:75], v[176:179]
  s_add_u32 m0, s54, 98304
  s_add_u32 s56, s52, 1216
  buffer_load_dwordx4 v8, s[8:11], s56 offen lds
  v_mfma_f32_16x16x32_bf16 v[180:183], a[100:103], a[76:79], v[180:183]
  v_mfma_f32_16x16x32_bf16 v[184:187], a[100:103], a[80:83], v[184:187]
  s_add_u32 m0, s54, 99328
  s_add_u32 s56, s52, 21696
  buffer_load_dwordx4 v8, s[8:11], s56 offen lds
  v_mfma_f32_16x16x32_bf16 v[188:191], a[100:103], a[84:87], v[188:191]
  v_mfma_f32_16x16x32_bf16 v[192:195], a[56:59], a[104:107], v[192:195]
  s_add_u32 m0, s55, 98304
  s_add_u32 s56, s53, 4980736
  buffer_load_dwordx4 v9, s[16:19], s56 offen lds
  v_mfma_f32_16x16x32_bf16 v[196:199], a[60:63], a[104:107], v[196:199]
  v_mfma_f32_16x16x32_bf16 v[200:203], a[64:67], a[104:107], v[200:203]
  s_add_u32 m0, s55, 99328
  s_add_u32 s56, s53, 5111808
  buffer_load_dwordx4 v9, s[16:19], s56 offen lds
  v_mfma_f32_16x16x32_bf16 v[204:207], a[68:71], a[104:107], v[204:207]
  v_mfma_f32_16x16x32_bf16 v[208:211], a[72:75], a[104:107], v[208:211]
  s_add_u32 m0, s55, 100352
  s_add_u32 s56, s53, 4980736
  buffer_load_dwordx4 v9, s[20:23], s56 offen lds
  v_mfma_f32_16x16x32_bf16 v[212:215], a[76:79], a[104:107], v[212:215]
  v_mfma_f32_16x16x32_bf16 v[216:219], a[80:83], a[104:107], v[216:219]
  s_add_u32 m0, s55, 101376
  s_add_u32 s56, s53, 5111808
  buffer_load_dwordx4 v9, s[20:23], s56 offen lds
  v_mfma_f32_16x16x32_bf16 v[220:223], a[84:87], a[104:107], v[220:223]
  v_mfma_f32_16x16x32_bf16 v[224:227], a[56:59], a[108:111], v[224:227]
  s_add_u32 m0, s55, 102400
  s_add_u32 s56, s53, 4980736
  buffer_load_dwordx4 v9, s[24:27], s56 offen lds
  v_mfma_f32_16x16x32_bf16 v[228:231], a[60:63], a[108:111], v[228:231]
  v_mfma_f32_16x16x32_bf16 v[232:235], a[64:67], a[108:111], v[232:235]
  s_add_u32 m0, s55, 103424
  s_add_u32 s56, s53, 5111808
  buffer_load_dwordx4 v9, s[24:27], s56 offen lds
  v_mfma_f32_16x16x32_bf16 v[236:239], a[68:71], a[108:111], v[236:239]
  v_mfma_f32_16x16x32_bf16 v[240:243], a[72:75], a[108:111], v[240:243]
  v_mfma_f32_16x16x32_bf16 v[244:247], a[76:79], a[108:111], v[244:247]
  v_mfma_f32_16x16x32_bf16 v[248:251], a[80:83], a[108:111], v[248:251]
  v_mfma_f32_16x16x32_bf16 v[252:255], a[84:87], a[108:111], v[252:255]
  s_waitcnt vmcnt(16) lgkmcnt(0)
  s_barrier
  v_mfma_f32_16x16x32_bf16 v[64:67], a[32:35], a[0:3], v[64:67]
  ds_read_b128 a[56:59], v10 offset:32768
  v_mfma_f32_16x16x32_bf16 v[68:71], a[32:35], a[4:7], v[68:71]
  v_mfma_f32_16x16x32_bf16 v[72:75], a[32:35], a[8:11], v[72:75]
  ds_read_b64_tr_b16 a[88:89], v12 offset:32768
  ds_read_b64_tr_b16 a[90:91], v12 offset:33024
  v_mfma_f32_16x16x32_bf16 v[76:79], a[32:35], a[12:15], v[76:79]
  v_mfma_f32_16x16x32_bf16 v[80:83], a[32:35], a[16:19], v[80:83]
  ds_read_b128 a[60:63], v10 offset:33792
  v_mfma_f32_16x16x32_bf16 v[84:87], a[32:35], a[20:23], v[84:87]
  v_mfma_f32_16x16x32_bf16 v[88:91], a[32:35], a[24:27], v[88:91]
  ds_read_b64_tr_b16 a[92:93], v14 offset:32768
  ds_read_b64_tr_b16 a[94:95], v14 offset:33024
  v_mfma_f32_16x16x32_bf16 v[92:95], a[32:35], a[28:31], v[92:95]
  v_mfma_f32_16x16x32_bf16 v[96:99], a[36:39], a[0:3], v[96:99]
  ds_read_b128 a[64:67], v10 offset:34816
  v_mfma_f32_16x16x32_bf16 v[100:103], a[36:39], a[4:7], v[100:103]
  v_mfma_f32_16x16x32_bf16 v[104:107], a[36:39], a[8:11], v[104:107]
  ds_read_b64_tr_b16 a[96:97], v12 offset:34816
  ds_read_b64_tr_b16 a[98:99], v12 offset:35072
  v_mfma_f32_16x16x32_bf16 v[108:111], a[36:39], a[12:15], v[108:111]
  v_mfma_f32_16x16x32_bf16 v[112:115], a[36:39], a[16:19], v[112:115]
  ds_read_b128 a[68:71], v10 offset:35840
  v_mfma_f32_16x16x32_bf16 v[116:119], a[36:39], a[20:23], v[116:119]
  v_mfma_f32_16x16x32_bf16 v[120:123], a[36:39], a[24:27], v[120:123]
  ds_read_b64_tr_b16 a[100:101], v14 offset:34816
  ds_read_b64_tr_b16 a[102:103], v14 offset:35072
  v_mfma_f32_16x16x32_bf16 v[124:127], a[36:39], a[28:31], v[124:127]
  v_mfma_f32_16x16x32_bf16 v[128:131], a[40:43], a[0:3], v[128:131]
  ds_read_b128 a[72:75], v10 offset:36864
  v_mfma_f32_16x16x32_bf16 v[132:135], a[40:43], a[4:7], v[132:135]
  v_mfma_f32_16x16x32_bf16 v[136:139], a[40:43], a[8:11], v[136:139]
  ds_read_b64_tr_b16 a[104:105], v12 offset:36864
  ds_read_b64_tr_b16 a[106:107], v12 offset:37120
  v_mfma_f32_16x16x32_bf16 v[140:143], a[40:43], a[12:15], v[140:143]
  v_mfma_f32_16x16x32_bf16 v[144:147], a[40:43], a[16:19], v[144:147]
  ds_read_b128 a[76:79], v10 offset:37888
  v_mfma_f32_16x16x32_bf16 v[148:151], a[40:43], a[20:23], v[148:151]
  v_mfma_f32_16x16x32_bf16 v[152:155], a[40:43], a[24:27], v[152:155]
  ds_read_b64_tr_b16 a[108:109], v14 offset:36864
  ds_read_b64_tr_b16 a[110:111], v14 offset:37120
  v_mfma_f32_16x16x32_bf16 v[156:159], a[40:43], a[28:31], v[156:159]
  v_mfma_f32_16x16x32_bf16 v[160:163], a[44:47], a[0:3], v[160:163]
  ds_read_b128 a[80:83], v10 offset:38912
  v_mfma_f32_16x16x32_bf16 v[164:167], a[44:47], a[4:7], v[164:167]
  v_mfma_f32_16x16x32_bf16 v[168:171], a[44:47], a[8:11], v[168:171]
  ds_read_b128 a[84:87], v10 offset:39936
  v_mfma_f32_16x16x32_bf16 v[172:175], a[44:47], a[12:15], v[172:175]
  v_mfma_f32_16x16x32_bf16 v[176:179], a[44:47], a[16:19], v[176:179]
  v_mfma_f32_16x16x32_bf16 v[180:183], a[44:47], a[20:23], v[180:183]
  v_mfma_f32_16x16x32_bf16 v[184:187], a[44:47], a[24:27], v[184:187]
  v_mfma_f32_16x16x32_bf16 v[188:191], a[44:47], a[28:31], v[188:191]
  v_mfma_f32_16x16x32_bf16 v[192:195], a[0:3], a[48:51], v[192:195]
  v_mfma_f32_16x16x32_bf16 v[196:199], a[4:7], a[48:51], v[196:199]
  v_mfma_f32_16x16x32_bf16 v[200:203], a[8:11], a[48:51], v[200:203]
  v_mfma_f32_16x16x32_bf16 v[204:207], a[12:15], a[48:51], v[204:207]
  v_mfma_f32_16x16x32_bf16 v[208:211], a[16:19], a[48:51], v[208:211]
  v_mfma_f32_16x16x32_bf16 v[212:215], a[20:23], a[48:51], v[212:215]
  v_mfma_f32_16x16x32_bf16 v[216:219], a[24:27], a[48:51], v[216:219]
  v_mfma_f32_16x16x32_bf16 v[220:223], a[28:31], a[48:51], v[220:223]
  v_mfma_f32_16x16x32_bf16 v[224:227], a[0:3], a[52:55], v[224:227]
  v_mfma_f32_16x16x32_bf16 v[228:231], a[4:7], a[52:55], v[228:231]
  v_mfma_f32_16x16x32_bf16 v[232:235], a[8:11], a[52:55], v[232:235]
  v_mfma_f32_16x16x32_bf16 v[236:239], a[12:15], a[52:55], v[236:239]
  v_mfma_f32_16x16x32_bf16 v[240:243], a[16:19], a[52:55], v[240:243]
  v_mfma_f32_16x16x32_bf16 v[244:247], a[20:23], a[52:55], v[244:247]
  v_mfma_f32_16x16x32_bf16 v[248:251], a[24:27], a[52:55], v[248:251]
  v_mfma_f32_16x16x32_bf16 v[252:255], a[28:31], a[52:55], v[252:255]
  s_waitcnt vmcnt(8) lgkmcnt(0)
  s_barrier
  v_mfma_f32_16x16x32_bf16 v[64:67], a[88:91], a[56:59], v[64:67]
  ds_read_b128 a[0:3], v11 offset:0
  v_mfma_f32_16x16x32_bf16 v[68:71], a[88:91], a[60:63], v[68:71]
  v_mfma_f32_16x16x32_bf16 v[72:75], a[88:91], a[64:67], v[72:75]
  ds_read_b64_tr_b16 a[32:33], v13 offset:0
  ds_read_b64_tr_b16 a[34:35], v13 offset:256
  v_mfma_f32_16x16x32_bf16 v[76:79], a[88:91], a[68:71], v[76:79]
  v_mfma_f32_16x16x32_bf16 v[80:83], a[88:91], a[72:75], v[80:83]
  ds_read_b128 a[4:7], v11 offset:1024
  v_mfma_f32_16x16x32_bf16 v[84:87], a[88:91], a[76:79], v[84:87]
  v_mfma_f32_16x16x32_bf16 v[88:91], a[88:91], a[80:83], v[88:91]
  ds_read_b64_tr_b16 a[36:37], v15 offset:0
  ds_read_b64_tr_b16 a[38:39], v15 offset:256
  v_mfma_f32_16x16x32_bf16 v[92:95], a[88:91], a[84:87], v[92:95]
  v_mfma_f32_16x16x32_bf16 v[96:99], a[92:95], a[56:59], v[96:99]
  ds_read_b128 a[8:11], v11 offset:2048
  v_mfma_f32_16x16x32_bf16 v[100:103], a[92:95], a[60:63], v[100:103]
  v_mfma_f32_16x16x32_bf16 v[104:107], a[92:95], a[64:67], v[104:107]
  ds_read_b64_tr_b16 a[40:41], v13 offset:2048
  ds_read_b64_tr_b16 a[42:43], v13 offset:2304
  v_mfma_f32_16x16x32_bf16 v[108:111], a[92:95], a[68:71], v[108:111]
  v_mfma_f32_16x16x32_bf16 v[112:115], a[92:95], a[72:75], v[112:115]
  ds_read_b128 a[12:15], v11 offset:3072
  v_mfma_f32_16x16x32_bf16 v[116:119], a[92:95], a[76:79], v[116:119]
  v_mfma_f32_16x16x32_bf16 v[120:123], a[92:95], a[80:83], v[120:123]
  ds_read_b64_tr_b16 a[44:45], v15 offset:2048
  ds_read_b64_tr_b16 a[46:47], v15 offset:2304
  v_mfma_f32_16x16x32_bf16 v[124:127], a[92:95], a[84:87], v[124:127]
  v_mfma_f32_16x16x32_bf16 v[128:131], a[96:99], a[56:59], v[128:131]
  ds_read_b128 a[16:19], v11 offset:4096
  v_mfma_f32_16x16x32_bf16 v[132:135], a[96:99], a[60:63], v[132:135]
  v_mfma_f32_16x16x32_bf16 v[136:139], a[96:99], a[64:67], v[136:139]
  ds_read_b64_tr_b16 a[48:49], v13 offset:4096
  ds_read_b64_tr_b16 a[50:51], v13 offset:4352
  v_mfma_f32_16x16x32_bf16 v[140:143], a[96:99], a[68:71], v[140:143]
  v_mfma_f32_16x16x32_bf16 v[144:147], a[96:99], a[72:75], v[144:147]
  ds_read_b128 a[20:23], v11 offset:5120
  v_mfma_f32_16x16x32_bf16 v[148:151], a[96:99], a[76:79], v[148:151]
  v_mfma_f32_16x16x32_bf16 v[152:155], a[96:99], a[80:83], v[152:155]
  ds_read_b64_tr_b16 a[52:53], v15 offset:4096
  ds_read_b64_tr_b16 a[54:55], v15 offset:4352
  v_mfma_f32_16x16x32_bf16 v[156:159], a[96:99], a[84:87], v[156:159]
  v_mfma_f32_16x16x32_bf16 v[160:163], a[100:103], a[56:59], v[160:163]
  ds_read_b128 a[24:27], v11 offset:6144
  v_mfma_f32_16x16x32_bf16 v[164:167], a[100:103], a[60:63], v[164:167]
  v_mfma_f32_16x16x32_bf16 v[168:171], a[100:103], a[64:67], v[168:171]
  ds_read_b128 a[28:31], v11 offset:7168
  v_mfma_f32_16x16x32_bf16 v[172:175], a[100:103], a[68:71], v[172:175]
  v_mfma_f32_16x16x32_bf16 v[176:179], a[100:103], a[72:75], v[176:179]
  v_mfma_f32_16x16x32_bf16 v[180:183], a[100:103], a[76:79], v[180:183]
  v_mfma_f32_16x16x32_bf16 v[184:187], a[100:103], a[80:83], v[184:187]
  v_mfma_f32_16x16x32_bf16 v[188:191], a[100:103], a[84:87], v[188:191]
  v_mfma_f32_16x16x32_bf16 v[192:195], a[56:59], a[104:107], v[192:195]
  v_mfma_f32_16x16x32_bf16 v[196:199], a[60:63], a[104:107], v[196:199]
  v_mfma_f32_16x16x32_bf16 v[200:203], a[64:67], a[104:107], v[200:203]
  v_mfma_f32_16x16x32_bf16 v[204:207], a[68:71], a[104:107], v[204:207]
  v_mfma_f32_16x16x32_bf16 v[208:211], a[72:75], a[104:107], v[208:211]
  v_mfma_f32_16x16x32_bf16 v[212:215], a[76:79], a[104:107], v[212:215]
  v_mfma_f32_16x16x32_bf16 v[216:219], a[80:83], a[104:107], v[216:219]
  v_mfma_f32_16x16x32_bf16 v[220:223], a[84:87], a[104:107], v[220:223]
  v_mfma_f32_16x16x32_bf16 v[224:227], a[56:59], a[108:111], v[224:227]
  v_mfma_f32_16x16x32_bf16 v[228:231], a[60:63], a[108:111], v[228:231]
  v_mfma_f32_16x16x32_bf16 v[232:235], a[64:67], a[108:111], v[232:235]
  v_mfma_f32_16x16x32_bf16 v[236:239], a[68:71], a[108:111], v[236:239]
  v_mfma_f32_16x16x32_bf16 v[240:243], a[72:75], a[108:111], v[240:243]
  v_mfma_f32_16x16x32_bf16 v[244:247], a[76:79], a[108:111], v[244:247]
  v_mfma_f32_16x16x32_bf16 v[248:251], a[80:83], a[108:111], v[248:251]
  v_mfma_f32_16x16x32_bf16 v[252:255], a[84:87], a[108:111], v[252:255]
  s_waitcnt vmcnt(0) lgkmcnt(0)
  s_barrier
  v_mfma_f32_16x16x32_bf16 v[64:67], a[32:35], a[0:3], v[64:67]
  ds_read_b128 a[56:59], v11 offset:32768
  v_mfma_f32_16x16x32_bf16 v[68:71], a[32:35], a[4:7], v[68:71]
  v_mfma_f32_16x16x32_bf16 v[72:75], a[32:35], a[8:11], v[72:75]
  ds_read_b64_tr_b16 a[88:89], v13 offset:32768
  ds_read_b64_tr_b16 a[90:91], v13 offset:33024
  v_mfma_f32_16x16x32_bf16 v[76:79], a[32:35], a[12:15], v[76:79]
  v_mfma_f32_16x16x32_bf16 v[80:83], a[32:35], a[16:19], v[80:83]
  ds_read_b128 a[60:63], v11 offset:33792
  v_mfma_f32_16x16x32_bf16 v[84:87], a[32:35], a[20:23], v[84:87]
  v_mfma_f32_16x16x32_bf16 v[88:91], a[32:35], a[24:27], v[88:91]
  ds_read_b64_tr_b16 a[92:93], v15 offset:32768
  ds_read_b64_tr_b16 a[94:95], v15 offset:33024
  v_mfma_f32_16x16x32_bf16 v[92:95], a[32:35], a[28:31], v[92:95]
  v_mfma_f32_16x16x32_bf16 v[96:99], a[36:39], a[0:3], v[96:99]
  ds_read_b128 a[64:67], v11 offset:34816
  v_mfma_f32_16x16x32_bf16 v[100:103], a[36:39], a[4:7], v[100:103]
  v_mfma_f32_16x16x32_bf16 v[104:107], a[36:39], a[8:11], v[104:107]
  ds_read_b64_tr_b16 a[96:97], v13 offset:34816
  ds_read_b64_tr_b16 a[98:99], v13 offset:35072
  v_mfma_f32_16x16x32_bf16 v[108:111], a[36:39], a[12:15], v[108:111]
  v_mfma_f32_16x16x32_bf16 v[112:115], a[36:39], a[16:19], v[112:115]
  ds_read_b128 a[68:71], v11 offset:35840
  v_mfma_f32_16x16x32_bf16 v[116:119], a[36:39], a[20:23], v[116:119]
  v_mfma_f32_16x16x32_bf16 v[120:123], a[36:39], a[24:27], v[120:123]
  ds_read_b64_tr_b16 a[100:101], v15 offset:34816
  ds_read_b64_tr_b16 a[102:103], v15 offset:35072
  v_mfma_f32_16x16x32_bf16 v[124:127], a[36:39], a[28:31], v[124:127]
  v_mfma_f32_16x16x32_bf16 v[128:131], a[40:43], a[0:3], v[128:131]
  ds_read_b128 a[72:75], v11 offset:36864
  v_mfma_f32_16x16x32_bf16 v[132:135], a[40:43], a[4:7], v[132:135]
  v_mfma_f32_16x16x32_bf16 v[136:139], a[40:43], a[8:11], v[136:139]
  ds_read_b64_tr_b16 a[104:105], v13 offset:36864
  ds_read_b64_tr_b16 a[106:107], v13 offset:37120
  v_mfma_f32_16x16x32_bf16 v[140:143], a[40:43], a[12:15], v[140:143]
  v_mfma_f32_16x16x32_bf16 v[144:147], a[40:43], a[16:19], v[144:147]
  ds_read_b128 a[76:79], v11 offset:37888
  v_mfma_f32_16x16x32_bf16 v[148:151], a[40:43], a[20:23], v[148:151]
  v_mfma_f32_16x16x32_bf16 v[152:155], a[40:43], a[24:27], v[152:155]
  ds_read_b64_tr_b16 a[108:109], v15 offset:36864
  ds_read_b64_tr_b16 a[110:111], v15 offset:37120
  v_mfma_f32_16x16x32_bf16 v[156:159], a[40:43], a[28:31], v[156:159]
  v_mfma_f32_16x16x32_bf16 v[160:163], a[44:47], a[0:3], v[160:163]
  ds_read_b128 a[80:83], v11 offset:38912
  v_mfma_f32_16x16x32_bf16 v[164:167], a[44:47], a[4:7], v[164:167]
  v_mfma_f32_16x16x32_bf16 v[168:171], a[44:47], a[8:11], v[168:171]
  ds_read_b128 a[84:87], v11 offset:39936
  v_mfma_f32_16x16x32_bf16 v[172:175], a[44:47], a[12:15], v[172:175]
  v_mfma_f32_16x16x32_bf16 v[176:179], a[44:47], a[16:19], v[176:179]
  v_mfma_f32_16x16x32_bf16 v[180:183], a[44:47], a[20:23], v[180:183]
  v_mfma_f32_16x16x32_bf16 v[184:187], a[44:47], a[24:27], v[184:187]
  v_mfma_f32_16x16x32_bf16 v[188:191], a[44:47], a[28:31], v[188:191]
  v_mfma_f32_16x16x32_bf16 v[192:195], a[0:3], a[48:51], v[192:195]
  v_mfma_f32_16x16x32_bf16 v[196:199], a[4:7], a[48:51], v[196:199]
  v_mfma_f32_16x16x32_bf16 v[200:203], a[8:11], a[48:51], v[200:203]
  v_mfma_f32_16x16x32_bf16 v[204:207], a[12:15], a[48:51], v[204:207]
  v_mfma_f32_16x16x32_bf16 v[208:211], a[16:19], a[48:51], v[208:211]
  v_mfma_f32_16x16x32_bf16 v[212:215], a[20:23], a[48:51], v[212:215]
  v_mfma_f32_16x16x32_bf16 v[216:219], a[24:27], a[48:51], v[216:219]
  v_mfma_f32_16x16x32_bf16 v[220:223], a[28:31], a[48:51], v[220:223]
  v_mfma_f32_16x16x32_bf16 v[224:227], a[0:3], a[52:55], v[224:227]
  v_mfma_f32_16x16x32_bf16 v[228:231], a[4:7], a[52:55], v[228:231]
  v_mfma_f32_16x16x32_bf16 v[232:235], a[8:11], a[52:55], v[232:235]
  v_mfma_f32_16x16x32_bf16 v[236:239], a[12:15], a[52:55], v[236:239]
  v_mfma_f32_16x16x32_bf16 v[240:243], a[16:19], a[52:55], v[240:243]
  v_mfma_f32_16x16x32_bf16 v[244:247], a[20:23], a[52:55], v[244:247]
  v_mfma_f32_16x16x32_bf16 v[248:251], a[24:27], a[52:55], v[248:251]
  v_mfma_f32_16x16x32_bf16 v[252:255], a[28:31], a[52:55], v[252:255]
  s_waitcnt lgkmcnt(0)
  v_mfma_f32_16x16x32_bf16 v[64:67], a[88:91], a[56:59], v[64:67]
  v_mfma_f32_16x16x32_bf16 v[68:71], a[88:91], a[60:63], v[68:71]
  v_mfma_f32_16x16x32_bf16 v[72:75], a[88:91], a[64:67], v[72:75]
  v_mfma_f32_16x16x32_bf16 v[76:79], a[88:91], a[68:71], v[76:79]
  v_mfma_f32_16x16x32_bf16 v[80:83], a[88:91], a[72:75], v[80:83]
  v_mfma_f32_16x16x32_bf16 v[84:87], a[88:91], a[76:79], v[84:87]
  v_mfma_f32_16x16x32_bf16 v[88:91], a[88:91], a[80:83], v[88:91]
  v_mfma_f32_16x16x32_bf16 v[92:95], a[88:91], a[84:87], v[92:95]
  v_mfma_f32_16x16x32_bf16 v[96:99], a[92:95], a[56:59], v[96:99]
  v_mfma_f32_16x16x32_bf16 v[100:103], a[92:95], a[60:63], v[100:103]
  v_mfma_f32_16x16x32_bf16 v[104:107], a[92:95], a[64:67], v[104:107]
  v_mfma_f32_16x16x32_bf16 v[108:111], a[92:95], a[68:71], v[108:111]
  v_mfma_f32_16x16x32_bf16 v[112:115], a[92:95], a[72:75], v[112:115]
  v_mfma_f32_16x16x32_bf16 v[116:119], a[92:95], a[76:79], v[116:119]
  v_mfma_f32_16x16x32_bf16 v[120:123], a[92:95], a[80:83], v[120:123]
  v_mfma_f32_16x16x32_bf16 v[124:127], a[92:95], a[84:87], v[124:127]
  v_mfma_f32_16x16x32_bf16 v[128:131], a[96:99], a[56:59], v[128:131]
  v_mfma_f32_16x16x32_bf16 v[132:135], a[96:99], a[60:63], v[132:135]
  v_mfma_f32_16x16x32_bf16 v[136:139], a[96:99], a[64:67], v[136:139]
  v_mfma_f32_16x16x32_bf16 v[140:143], a[96:99], a[68:71], v[140:143]
  v_mfma_f32_16x16x32_bf16 v[144:147], a[96:99], a[72:75], v[144:147]
  v_mfma_f32_16x16x32_bf16 v[148:151], a[96:99], a[76:79], v[148:151]
  v_mfma_f32_16x16x32_bf16 v[152:155], a[96:99], a[80:83], v[152:155]
  v_mfma_f32_16x16x32_bf16 v[156:159], a[96:99], a[84:87], v[156:159]
  v_mfma_f32_16x16x32_bf16 v[160:163], a[100:103], a[56:59], v[160:163]
  v_mfma_f32_16x16x32_bf16 v[164:167], a[100:103], a[60:63], v[164:167]
  v_mfma_f32_16x16x32_bf16 v[168:171], a[100:103], a[64:67], v[168:171]
  v_mfma_f32_16x16x32_bf16 v[172:175], a[100:103], a[68:71], v[172:175]
  v_mfma_f32_16x16x32_bf16 v[176:179], a[100:103], a[72:75], v[176:179]
  v_mfma_f32_16x16x32_bf16 v[180:183], a[100:103], a[76:79], v[180:183]
  v_mfma_f32_16x16x32_bf16 v[184:187], a[100:103], a[80:83], v[184:187]
  v_mfma_f32_16x16x32_bf16 v[188:191], a[100:103], a[84:87], v[188:191]
  v_mfma_f32_16x16x32_bf16 v[192:195], a[56:59], a[104:107], v[192:195]
  v_mfma_f32_16x16x32_bf16 v[196:199], a[60:63], a[104:107], v[196:199]
  v_mfma_f32_16x16x32_bf16 v[200:203], a[64:67], a[104:107], v[200:203]
  v_mfma_f32_16x16x32_bf16 v[204:207], a[68:71], a[104:107], v[204:207]
  v_mfma_f32_16x16x32_bf16 v[208:211], a[72:75], a[104:107], v[208:211]
  v_mfma_f32_16x16x32_bf16 v[212:215], a[76:79], a[104:107], v[212:215]
  v_mfma_f32_16x16x32_bf16 v[216:219], a[80:83], a[104:107], v[216:219]
  v_mfma_f32_16x16x32_bf16 v[220:223], a[84:87], a[104:107], v[220:223]
  v_mfma_f32_16x16x32_bf16 v[224:227], a[56:59], a[108:111], v[224:227]
  v_mfma_f32_16x16x32_bf16 v[228:231], a[60:63], a[108:111], v[228:231]
  v_mfma_f32_16x16x32_bf16 v[232:235], a[64:67], a[108:111], v[232:235]
  v_mfma_f32_16x16x32_bf16 v[236:239], a[68:71], a[108:111], v[236:239]
  v_mfma_f32_16x16x32_bf16 v[240:243], a[72:75], a[108:111], v[240:243]
  v_mfma_f32_16x16x32_bf16 v[244:247], a[76:79], a[108:111], v[244:247]
  v_mfma_f32_16x16x32_bf16 v[248:251], a[80:83], a[108:111], v[248:251]
  v_mfma_f32_16x16x32_bf16 v[252:255], a[84:87], a[108:111], v[252:255]
  s_lshl_b32 s46, s50, 7
  s_add_u32 s46, s46, s51
  s_lshl_b32 s58, s46, 14
  s_lshl_b32 s59, s46, 13
  s_add_u32 s59, s59, 33554432
  s_lshl_b32 s46, s44, 10
  s_add_u32 s59, s59, s46
  s_add_u32 s60, s58, s46
  s_lshl_b32 s46, s44, 11
  s_add_u32 s61, s58, s46
  s_add_u32 s61, s61, 8192
  v_cvt_pk_bf16_f32 v20, v128, v129
  v_cvt_pk_bf16_f32 v21, v130, v131
  v_cvt_pk_bf16_f32 v22, v160, v161
  v_cvt_pk_bf16_f32 v23, v162, v163
  s_add_u32 s56, s60, 0
  buffer_store_dwordx4 v[20:23], v16, s[40:43], s56 offen sc1
  v_cvt_pk_bf16_f32 v24, v132, v133
  v_cvt_pk_bf16_f32 v25, v134, v135
  v_cvt_pk_bf16_f32 v26, v164, v165
  v_cvt_pk_bf16_f32 v27, v166, v167
  s_add_u32 s56, s60, 4096
  buffer_store_dwordx4 v[24:27], v16, s[40:43], s56 offen sc1
  v_cvt_pk_bf16_f32 v28, v136, v137
  v_cvt_pk_bf16_f32 v29, v138, v139
  v_cvt_pk_bf16_f32 v30, v168, v169
  v_cvt_pk_bf16_f32 v31, v170, v171
  s_add_u32 s56, s60, 524288
  buffer_store_dwordx4 v[28:31], v16, s[40:43], s56 offen sc1
  v_cvt_pk_bf16_f32 v32, v140, v141
  v_cvt_pk_bf16_f32 v33, v142, v143
  v_cvt_pk_bf16_f32 v34, v172, v173
  v_cvt_pk_bf16_f32 v35, v174, v175
  s_add_u32 s56, s60, 528384
  buffer_store_dwordx4 v[32:35], v16, s[40:43], s56 offen sc1
  v_cvt_pk_bf16_f32 v36, v144, v145
  v_cvt_pk_bf16_f32 v37, v146, v147
  v_cvt_pk_bf16_f32 v38, v176, v177
  v_cvt_pk_bf16_f32 v39, v178, v179
  s_add_u32 s56, s60, 1048576
  buffer_store_dwordx4 v[36:39], v16, s[40:43], s56 offen sc1
  v_cvt_pk_bf16_f32 v40, v148, v149
  v_cvt_pk_bf16_f32 v41, v150, v151
  v_cvt_pk_bf16_f32 v42, v180, v181
  v_cvt_pk_bf16_f32 v43, v182, v183
  s_add_u32 s56, s60, 1052672
  buffer_store_dwordx4 v[40:43], v16, s[40:43], s56 offen sc1
  v_cvt_pk_bf16_f32 v44, v152, v153
  v_cvt_pk_bf16_f32 v45, v154, v155
  v_cvt_pk_bf16_f32 v46, v184, v185
  v_cvt_pk_bf16_f32 v47, v186, v187
  s_add_u32 s56, s60, 1572864
  buffer_store_dwordx4 v[44:47], v16, s[40:43], s56 offen sc1
  v_cvt_pk_bf16_f32 v48, v156, v157
  v_cvt_pk_bf16_f32 v49, v158, v159
  v_cvt_pk_bf16_f32 v50, v188, v189
  v_cvt_pk_bf16_f32 v51, v190, v191
  s_add_u32 s56, s60, 1576960
  buffer_store_dwordx4 v[48:51], v16, s[40:43], s56 offen sc1
  v_cvt_pk_bf16_f32 v20, v192, v193
  v_cvt_pk_bf16_f32 v21, v194, v195
  v_cvt_pk_bf16_f32 v22, v196, v197
  v_cvt_pk_bf16_f32 v23, v198, v199
  s_add_u32 s56, s61, 0
  buffer_store_dwordx4 v[20:23], v16, s[40:43], s56 offen sc1
  v_cvt_pk_bf16_f32 v24, v224, v225
  v_cvt_pk_bf16_f32 v25, v226, v227
  v_cvt_pk_bf16_f32 v26, v228, v229
  v_cvt_pk_bf16_f32 v27, v230, v231
  s_add_u32 s56, s61, 1024
  buffer_store_dwordx4 v[24:27], v16, s[40:43], s56 offen sc1
  v_cvt_pk_bf16_f32 v28, v200, v201
  v_cvt_pk_bf16_f32 v29, v202, v203
  v_cvt_pk_bf16_f32 v30, v204, v205
  v_cvt_pk_bf16_f32 v31, v206, v207
  s_add_u32 s56, s61, 524288
  buffer_store_dwordx4 v[28:31], v16, s[40:43], s56 offen sc1
  v_cvt_pk_bf16_f32 v32, v232, v233
  v_cvt_pk_bf16_f32 v33, v234, v235
  v_cvt_pk_bf16_f32 v34, v236, v237
  v_cvt_pk_bf16_f32 v35, v238, v239
  s_add_u32 s56, s61, 525312
  buffer_store_dwordx4 v[32:35], v16, s[40:43], s56 offen sc1
  v_cvt_pk_bf16_f32 v36, v208, v209
  v_cvt_pk_bf16_f32 v37, v210, v211
  v_cvt_pk_bf16_f32 v38, v212, v213
  v_cvt_pk_bf16_f32 v39, v214, v215
  s_add_u32 s56, s61, 1048576
  buffer_store_dwordx4 v[36:39], v16, s[40:43], s56 offen sc1
  v_cvt_pk_bf16_f32 v40, v240, v241
  v_cvt_pk_bf16_f32 v41, v242, v243
  v_cvt_pk_bf16_f32 v42, v244, v245
  v_cvt_pk_bf16_f32 v43, v246, v247
  s_add_u32 s56, s61, 1049600
  buffer_store_dwordx4 v[40:43], v16, s[40:43], s56 offen sc1
  v_cvt_pk_bf16_f32 v44, v216, v217
  v_cvt_pk_bf16_f32 v45, v218, v219
  v_cvt_pk_bf16_f32 v46, v220, v221
  v_cvt_pk_bf16_f32 v47, v222, v223
  s_add_u32 s56, s61, 1572864
  buffer_store_dwordx4 v[44:47], v16, s[40:43], s56 offen sc1
  v_cvt_pk_bf16_f32 v48, v248, v249
  v_cvt_pk_bf16_f32 v49, v250, v251
  v_cvt_pk_bf16_f32 v50, v252, v253
  v_cvt_pk_bf16_f32 v51, v254, v255
  s_add_u32 s56, s61, 1573888
  buffer_store_dwordx4 v[48:51], v16, s[40:43], s56 offen sc1
  v_cvt_pk_bf16_f32 v20, v64, v65
  v_cvt_pk_bf16_f32 v21, v66, v67
  v_cvt_pk_bf16_f32 v22, v96, v97
  v_cvt_pk_bf16_f32 v23, v98, v99
  s_add_u32 s56, s59, 0
  buffer_store_dwordx4 v[20:23], v16, s[40:43], s56 offen sc1
  v_cvt_pk_bf16_f32 v24, v68, v69
  v_cvt_pk_bf16_f32 v25, v70, v71
  v_cvt_pk_bf16_f32 v26, v100, v101
  v_cvt_pk_bf16_f32 v27, v102, v103
  s_add_u32 s56, s59, 4096
  buffer_store_dwordx4 v[24:27], v16, s[40:43], s56 offen sc1
  v_cvt_pk_bf16_f32 v28, v72, v73
  v_cvt_pk_bf16_f32 v29, v74, v75
  v_cvt_pk_bf16_f32 v30, v104, v105
  v_cvt_pk_bf16_f32 v31, v106, v107
  s_add_u32 s56, s59, 262144
  buffer_store_dwordx4 v[28:31], v16, s[40:43], s56 offen sc1
  v_cvt_pk_bf16_f32 v32, v76, v77
  v_cvt_pk_bf16_f32 v33, v78, v79
  v_cvt_pk_bf16_f32 v34, v108, v109
  v_cvt_pk_bf16_f32 v35, v110, v111
  s_add_u32 s56, s59, 266240
  buffer_store_dwordx4 v[32:35], v16, s[40:43], s56 offen sc1
  v_cvt_pk_bf16_f32 v36, v80, v81
  v_cvt_pk_bf16_f32 v37, v82, v83
  v_cvt_pk_bf16_f32 v38, v112, v113
  v_cvt_pk_bf16_f32 v39, v114, v115
  s_add_u32 s56, s59, 524288
  buffer_store_dwordx4 v[36:39], v16, s[40:43], s56 offen sc1
  v_cvt_pk_bf16_f32 v40, v84, v85
  v_cvt_pk_bf16_f32 v41, v86, v87
  v_cvt_pk_bf16_f32 v42, v116, v117
  v_cvt_pk_bf16_f32 v43, v118, v119
  s_add_u32 s56, s59, 528384
  buffer_store_dwordx4 v[40:43], v16, s[40:43], s56 offen sc1
  v_cvt_pk_bf16_f32 v44, v88, v89
  v_cvt_pk_bf16_f32 v45, v90, v91
  v_cvt_pk_bf16_f32 v46, v120, v121
  v_cvt_pk_bf16_f32 v47, v122, v123
  s_add_u32 s56, s59, 786432
  buffer_store_dwordx4 v[44:47], v16, s[40:43], s56 offen sc1
  v_cvt_pk_bf16_f32 v48, v92, v93
  v_cvt_pk_bf16_f32 v49, v94, v95
  v_cvt_pk_bf16_f32 v50, v124, v125
  v_cvt_pk_bf16_f32 v51, v126, v127
  s_add_u32 s56, s59, 790528
  buffer_store_dwordx4 v[48:51], v16, s[40:43], s56 offen sc1
  s_waitcnt vmcnt(0)
  s_barrier
  s_cmp_lg_u32 s44, 0
  s_cbranch_scc1 L_gemm_next
  s_cmp_lg_u32 s57, 0
  s_cbranch_scc1 L_gemm_flag
  s_mov_b32 s47, 262144
L_wdbg_3:
  buffer_load_dword v4, v3, s[36:39], 0 offen offset:40 sc1
  s_waitcnt vmcnt(0)
  s_sub_u32 s47, s47, 1
  s_cbranch_scc1 L_abort
  v_cmp_gt_u32 vcc, 64, v4
  s_cbranch_vccnz L_wdbg_3
  s_mov_b32 s57, 1
L_gemm_flag:
  s_lshl_b32 s46, s49, 2
  s_add_u32 s46, s46, 78643200
  v_mov_b32 v4, 1
  v_mov_b32 v5, 1
  v_mov_b32 v6, 1
  v_mov_b32 v7, 1
  s_mov_b64 exec, 1
  buffer_store_dword v4, v3, s[40:43], s46 offen sc1
  s_lshl_b32 s46, s49, 4
  s_add_u32 s46, s46, 78725120
  buffer_store_dwordx4 v[4:7], v3, s[40:43], s46 offen sc1
  s_mov_b64 exec, -1
L_gemm_next:
  s_add_u32 s62, s62, 3
  s_cmp_lt_u32 s62, 8
  s_cbranch_scc1 L_gemm_task
L_phaseB:
  s_lshr_b32 s46, s48, 6
  s_cmp_lg_u32 s46, 1
  s_cbranch_scc1 L_outproj
  s_and_b32 s48, s48, 63
  v_and_b32 v4, 15, v1
  v_lshrrev_b32 v5, 4, v1
  v_lshrrev_b32 v6, 2, v4
  v_and_b32 v7, 3, v1
  v_lshlrev_b32 v8, 4, v1
  v_mov_b32 v9, 0x4444
  v_mov_b32 v18, 0xeeee
  v_cmp_lt_u32 vcc, 7, v4
  s_nop 1
  v_cndmask_b32 v9, v9, v18, vcc
  s_lshr_b32 s49, s48, 3
  s_and_b32 s50, s48, 7
  s_lshl_b32 s50, s50, 2
  s_add_u32 s50, s50, s44
  s_mov_b32 s56, 1040356334
  s_mov_b32 s57, 3187839982
  v_and_b32 v18, 7, v1
  v_or_b32 v9, 4, v18
  v_lshlrev_b32 v9, 2, v9
  v_lshl_add_u32 v10, v5, 3, v18
  v_lshlrev_b32 v10, 4, v10
  v_and_b32 v19, 1, v5
  v_lshl_add_u32 v11, v19, 4, v4
  v_lshlrev_b32 v11, 4, v11
  v_mov_b32 v19, 4261412864
  v_cmp_lt_u32 vcc, 1, v5
  s_nop 1
  v_cndmask_b32 v184, v3, v19, vcc
  v_mov_b32 v185, v184
  v_mov_b32 v186, v184
  v_mov_b32 v187, v184
  v_mov_b32 v22, 0
  v_mov_b32 v23, 0
  v_lshl_add_u32 v18, v5, 2, 0
  v_cmp_gt_u32 vcc, v18, v4
  s_nop 1
  v_cndmask_b32 v180, v3, v19, vcc
  v_lshl_add_u32 v18, v5, 2, 1
  v_cmp_gt_u32 vcc, v18, v4
  s_nop 1
  v_cndmask_b32 v181, v3, v19, vcc
  v_lshl_add_u32 v18, v5, 2, 2
  v_cmp_gt_u32 vcc, v18, v4
  s_nop 1
  v_cndmask_b32 v182, v3, v19, vcc
  v_lshl_add_u32 v18, v5, 2, 3
  v_cmp_gt_u32 vcc, v18, v4
  s_nop 1
  v_cndmask_b32 v183, v3, v19, vcc
  s_mov_b32 s47, 262144
L_wdbg_4:
  buffer_load_dword v18, v3, s[36:39], 0 offen offset:40 sc1
  s_waitcnt vmcnt(0)
  s_sub_u32 s47, s47, 1
  s_cbranch_scc1 L_abort
  v_cmp_gt_u32 vcc, 64, v18
  s_cbranch_vccnz L_wdbg_4
L_att_5:
  s_lshr_b32 s46, s49, 2
  s_lshl_b32 s46, s46, 5
  s_add_u32 s46, s46, s50
  s_lshl_b32 s46, s46, 2
  s_add_u32 s46, s46, 78643200
  s_mov_b32 s47, 262144
L_fs_6:
  buffer_load_dword v18, v3, s[40:43], s46 offen sc1
  s_waitcnt vmcnt(0)
  s_sub_u32 s47, s47, 1
  s_cbranch_scc1 L_abort
  v_cmp_eq_u32 vcc, 0, v18
  s_cbranch_vccnz L_fs_6
  s_lshl_b32 s51, s49, 5
  s_add_u32 s51, s51, s50
  s_lshl_b32 s53, s51, 13
  s_add_u32 s53, s53, 33554432
  s_lshl_b32 s54, s51, 14
  buffer_load_dwordx4 v[32:35], v8, s[40:43], s53 offen offset:0 sc1
  buffer_load_dwordx4 v[64:67], v8, s[40:43], s54 offen offset:0 sc1
  buffer_load_dwordx4 v[36:39], v8, s[40:43], s53 offen offset:1024 sc1
  buffer_load_dwordx4 v[68:71], v8, s[40:43], s54 offen offset:1024 sc1
  buffer_load_dwordx4 v[40:43], v8, s[40:43], s53 offen offset:2048 sc1
  buffer_load_dwordx4 v[72:75], v8, s[40:43], s54 offen offset:2048 sc1
  buffer_load_dwordx4 v[44:47], v8, s[40:43], s53 offen offset:3072 sc1
  buffer_load_dwordx4 v[76:79], v8, s[40:43], s54 offen offset:3072 sc1
  s_add_u32 s53, s53, 4096
  s_add_u32 s54, s54, 4096
  buffer_load_dwordx4 v[48:51], v8, s[40:43], s53 offen offset:0 sc1
  buffer_load_dwordx4 v[80:83], v8, s[40:43], s54 offen offset:0 sc1
  buffer_load_dwordx4 v[52:55], v8, s[40:43], s53 offen offset:1024 sc1
  buffer_load_dwordx4 v[84:87], v8, s[40:43], s54 offen offset:1024 sc1
  buffer_load_dwordx4 v[56:59], v8, s[40:43], s53 offen offset:2048 sc1
  buffer_load_dwordx4 v[88:91], v8, s[40:43], s54 offen offset:2048 sc1
  buffer_load_dwordx4 v[60:63], v8, s[40:43], s53 offen offset:3072 sc1
  buffer_load_dwordx4 v[92:95], v8, s[40:43], s54 offen offset:3072 sc1
  s_add_u32 s54, s54, 4096
  buffer_load_dwordx4 v[96:99], v8, s[40:43], s54 offen offset:0 sc1
  buffer_load_dwordx4 v[100:103], v8, s[40:43], s54 offen offset:1024 sc1
  buffer_load_dwordx4 v[104:107], v8, s[40:43], s54 offen offset:2048 sc1
  buffer_load_dwordx4 v[108:111], v8, s[40:43], s54 offen offset:3072 sc1
  s_add_u32 s54, s54, 4096
  buffer_load_dwordx4 v[112:115], v8, s[40:43], s54 offen offset:0 sc1
  buffer_load_dwordx4 v[116:119], v8, s[40:43], s54 offen offset:1024 sc1
  buffer_load_dwordx4 v[120:123], v8, s[40:43], s54 offen offset:2048 sc1
  buffer_load_dwordx4 v[124:127], v8, s[40:43], s54 offen offset:3072 sc1
  s_waitcnt vmcnt(8)
  v_mfma_f32_16x16x32_bf16 v[160:163], v[64:67], v[32:35], v[180:183]
  v_mfma_f32_16x16x32_bf16 v[164:167], v[64:67], v[48:51], 0
  v_mfma_f32_16x16x32_bf16 v[168:171], v[80:83], v[48:51], v[180:183]
  v_mfma_f32_16x16x32_bf16 v[160:163], v[68:71], v[36:39], v[160:163]
  v_mfma_f32_16x16x32_bf16 v[164:167], v[68:71], v[52:55], v[164:167]
  v_mfma_f32_16x16x32_bf16 v[168:171], v[84:87], v[52:55], v[168:171]
  v_mfma_f32_16x16x32_bf16 v[160:163], v[72:75], v[40:43], v[160:163]
  v_mfma_f32_16x16x32_bf16 v[164:167], v[72:75], v[56:59], v[164:167]
  v_mfma_f32_16x16x32_bf16 v[168:171], v[88:91], v[56:59], v[168:171]
  v_mfma_f32_16x16x32_bf16 v[160:163], v[76:79], v[44:47], v[160:163]
  v_mfma_f32_16x16x32_bf16 v[164:167], v[76:79], v[60:63], v[164:167]
  v_mfma_f32_16x16x32_bf16 v[168:171], v[92:95], v[60:63], v[168:171]
  s_lshl_b32 s46, s51, 5
  s_add_u32 s46, s46, 78659584
  s_mov_b32 s47, 262144
L_afm_7:
  buffer_load_dword v18, v9, s[40:43], s46 offen sc1
  s_waitcnt vmcnt(0)
  s_sub_u32 s47, s47, 1
  s_cbranch_scc1 L_abort
  v_cmp_eq_u32 vcc, 0, v18
  s_cbranch_vccz L_afm_7_ok
  s_sleep 2
  s_branch L_afm_7
L_afm_7_ok:
  s_lshl_b32 s53, s51, 11
  s_add_u32 s54, s53, 71303168
  s_add_u32 s53, s53, 67108864
  buffer_load_dwordx4 v[128:131], v10, s[40:43], s53 offen offset:0 sc1
  buffer_load_dwordx4 v[132:135], v10, s[40:43], s53 offen offset:512 sc1
  buffer_load_dwordx4 v[136:139], v10, s[40:43], s53 offen offset:1024 sc1
  buffer_load_dwordx4 v[140:143], v10, s[40:43], s53 offen offset:1536 sc1
  buffer_load_dwordx4 v[144:147], v11, s[40:43], s54 offen offset:0 sc1
  buffer_load_dwordx4 v[148:151], v11, s[40:43], s54 offen offset:512 sc1
  buffer_load_dwordx4 v[152:155], v11, s[40:43], s54 offen offset:1024 sc1
  buffer_load_dwordx4 v[156:159], v11, s[40:43], s54 offen offset:1536 sc1
  s_waitcnt vmcnt(4)
  v_mfma_f32_16x16x32_bf16 v[172:175], v[128:131], v[32:35], v[184:187]
  v_mfma_f32_16x16x32_bf16 v[176:179], v[128:131], v[48:51], v[184:187]
  v_mfma_f32_16x16x32_bf16 v[172:175], v[132:135], v[36:39], v[172:175]
  v_mfma_f32_16x16x32_bf16 v[176:179], v[132:135], v[52:55], v[176:179]
  v_mfma_f32_16x16x32_bf16 v[172:175], v[136:139], v[40:43], v[172:175]
  v_mfma_f32_16x16x32_bf16 v[176:179], v[136:139], v[56:59], v[176:179]
  v_mfma_f32_16x16x32_bf16 v[172:175], v[140:143], v[44:47], v[172:175]
  v_mfma_f32_16x16x32_bf16 v[176:179], v[140:143], v[60:63], v[176:179]
  v_max3_f32 v18, v160, v161, v162
  v_max_f32 v18, v18, v163
  s_nop 4
  v_max3_f32 v18, v18, v172, v173
  v_max3_f32 v18, v18, v174, v175
  v_mov_b32 v19, v18
  s_nop 1
  v_permlane32_swap_b32 v18, v19
  v_max_f32 v18, v18, v19
  v_mov_b32 v19, v18
  s_nop 1
  v_permlane16_swap_b32 v18, v19
  v_max_f32 v18, v18, v19
  v_mul_f32 v18, s57, v18
  v_fma_f32 v160, v160, s56, v18
  v_fma_f32 v161, v161, s56, v18
  v_fma_f32 v162, v162, s56, v18
  v_fma_f32 v163, v163, s56, v18
  v_fma_f32 v172, v172, s56, v18
  v_fma_f32 v173, v173, s56, v18
  v_fma_f32 v174, v174, s56, v18
  v_fma_f32 v175, v175, s56, v18
  v_exp_f32 v160, v160
  v_exp_f32 v161, v161
  v_exp_f32 v162, v162
  v_exp_f32 v163, v163
  v_exp_f32 v172, v172
  v_exp_f32 v173, v173
  v_exp_f32 v174, v174
  v_exp_f32 v175, v175
  v_add_f32 v18, v160, v161
  v_add_f32 v18, v18, v162
  v_add_f32 v18, v18, v163
  v_add_f32 v18, v18, v172
  v_add_f32 v18, v18, v173
  v_add_f32 v18, v18, v174
  v_add_f32 v18, v18, v175
  v_mov_b32 v19, v18
  s_nop 1
  v_permlane32_swap_b32 v18, v19
  v_add_f32 v18, v18, v19
  v_mov_b32 v19, v18
  s_nop 1
  v_permlane16_swap_b32 v18, v19
  v_add_f32 v18, v18, v19
  v_rcp_f32 v18, v18
  s_nop 0
  v_mul_f32 v160, v160, v18
  v_mul_f32 v161, v161, v18
  v_mul_f32 v162, v162, v18
  v_mul_f32 v163, v163, v18
  v_mul_f32 v172, v172, v18
  v_mul_f32 v173, v173, v18
  v_mul_f32 v174, v174, v18
  v_mul_f32 v175, v175, v18
  v_cvt_pk_bf16_f32 v20, v160, v161
  v_cvt_pk_bf16_f32 v21, v162, v163
  v_cvt_pk_bf16_f32 v28, v172, v173
  v_cvt_pk_bf16_f32 v29, v174, v175
  v_max3_f32 v18, v164, v165, v166
  v_max_f32 v18, v18, v167
  v_max3_f32 v18, v18, v168, v169
  v_max3_f32 v18, v18, v170, v171
  v_max3_f32 v18, v18, v176, v177
  v_max3_f32 v18, v18, v178, v179
  v_mov_b32 v19, v18
  s_nop 1
  v_permlane32_swap_b32 v18, v19
  v_max_f32 v18, v18, v19
  v_mov_b32 v19, v18
  s_nop 1
  v_permlane16_swap_b32 v18, v19
  v_max_f32 v18, v18, v19
  v_mul_f32 v18, s57, v18
  v_fma_f32 v164, v164, s56, v18
  v_fma_f32 v165, v165, s56, v18
  v_fma_f32 v166, v166, s56, v18
  v_fma_f32 v167, v167, s56, v18
  v_fma_f32 v168, v168, s56, v18
  v_fma_f32 v169, v169, s56, v18
  v_fma_f32 v170, v170, s56, v18
  v_fma_f32 v171, v171, s56, v18
  v_fma_f32 v176, v176, s56, v18
  v_fma_f32 v177, v177, s56, v18
  v_fma_f32 v178, v178, s56, v18
  v_fma_f32 v179, v179, s56, v18
  v_exp_f32 v164, v164
  v_exp_f32 v165, v165
  v_exp_f32 v166, v166
  v_exp_f32 v167, v167
  v_exp_f32 v168, v168
  v_exp_f32 v169, v169
  v_exp_f32 v170, v170
  v_exp_f32 v171, v171
  v_exp_f32 v176, v176
  v_exp_f32 v177, v177
  v_exp_f32 v178, v178
  v_exp_f32 v179, v179
  v_add_f32 v18, v164, v165
  v_add_f32 v18, v18, v166
  v_add_f32 v18, v18, v167
  v_add_f32 v18, v18, v168
  v_add_f32 v18, v18, v169
  v_add_f32 v18, v18, v170
  v_add_f32 v18, v18, v171
  v_add_f32 v18, v18, v176
  v_add_f32 v18, v18, v177
  v_add_f32 v18, v18, v178
  v_add_f32 v18, v18, v179
  v_mov_b32 v19, v18
  s_nop 1
  v_permlane32_swap_b32 v18, v19
  v_add_f32 v18, v18, v19
  v_mov_b32 v19, v18
  s_nop 1
  v_permlane16_swap_b32 v18, v19
  v_add_f32 v18, v18, v19
  v_rcp_f32 v18, v18
  s_nop 0
  v_mul_f32 v164, v164, v18
  v_mul_f32 v165, v165, v18
  v_mul_f32 v166, v166, v18
  v_mul_f32 v167, v167, v18
  v_mul_f32 v168, v168, v18
  v_mul_f32 v169, v169, v18
  v_mul_f32 v170, v170, v18
  v_mul_f32 v171, v171, v18
  v_mul_f32 v176, v176, v18
  v_mul_f32 v177, v177, v18
  v_mul_f32 v178, v178, v18
  v_mul_f32 v179, v179, v18
  v_cvt_pk_bf16_f32 v24, v164, v165
  v_cvt_pk_bf16_f32 v25, v166, v167
  v_cvt_pk_bf16_f32 v26, v168, v169
  v_cvt_pk_bf16_f32 v27, v170, v171
  v_cvt_pk_bf16_f32 v30, v176, v177
  v_cvt_pk_bf16_f32 v31, v178, v179
  s_waitcnt vmcnt(0)
  v_mfma_f32_16x16x32_bf16 v[188:191], v[96:99], v[20:23], 0
  v_mfma_f32_16x16x32_bf16 v[192:195], v[100:103], v[20:23], 0
  v_mfma_f32_16x16x32_bf16 v[196:199], v[104:107], v[20:23], 0
  v_mfma_f32_16x16x32_bf16 v[200:203], v[108:111], v[20:23], 0
  v_mfma_f32_16x16x32_bf16 v[204:207], v[112:115], v[20:23], 0
  v_mfma_f32_16x16x32_bf16 v[208:211], v[116:119], v[20:23], 0
  v_mfma_f32_16x16x32_bf16 v[212:215], v[120:123], v[20:23], 0
  v_mfma_f32_16x16x32_bf16 v[216:219], v[124:127], v[20:23], 0
  v_mfma_f32_16x16x32_bf16 v[220:223], v[96:99], v[24:27], 0
  v_mfma_f32_16x16x32_bf16 v[224:227], v[100:103], v[24:27], 0
  v_mfma_f32_16x16x32_bf16 v[228:231], v[104:107], v[24:27], 0
  v_mfma_f32_16x16x32_bf16 v[232:235], v[108:111], v[24:27], 0
  v_mfma_f32_16x16x32_bf16 v[236:239], v[112:115], v[24:27], 0
  v_mfma_f32_16x16x32_bf16 v[240:243], v[116:119], v[24:27], 0
  v_mfma_f32_16x16x32_bf16 v[244:247], v[120:123], v[24:27], 0
  v_mfma_f32_16x16x32_bf16 v[248:251], v[124:127], v[24:27], 0
  v_mfma_f32_16x16x16_bf16 v[188:191], v[144:145], v[28:29], v[188:191]
  v_mfma_f32_16x16x16_bf16 v[192:195], v[146:147], v[28:29], v[192:195]
  v_mfma_f32_16x16x16_bf16 v[196:199], v[148:149], v[28:29], v[196:199]
  v_mfma_f32_16x16x16_bf16 v[200:203], v[150:151], v[28:29], v[200:203]
  v_mfma_f32_16x16x16_bf16 v[204:207], v[152:153], v[28:29], v[204:207]
  v_mfma_f32_16x16x16_bf16 v[208:211], v[154:155], v[28:29], v[208:211]
  v_mfma_f32_16x16x16_bf16 v[212:215], v[156:157], v[28:29], v[212:215]
  v_mfma_f32_16x16x16_bf16 v[216:219], v[158:159], v[28:29], v[216:219]
  v_mfma_f32_16x16x16_bf16 v[220:223], v[144:145], v[30:31], v[220:223]
  v_mfma_f32_16x16x16_bf16 v[224:227], v[146:147], v[30:31], v[224:227]
  v_mfma_f32_16x16x16_bf16 v[228:231], v[148:149], v[30:31], v[228:231]
  v_mfma_f32_16x16x16_bf16 v[232:235], v[150:151], v[30:31], v[232:235]
  v_mfma_f32_16x16x16_bf16 v[236:239], v[152:153], v[30:31], v[236:239]
  v_mfma_f32_16x16x16_bf16 v[240:243], v[154:155], v[30:31], v[240:243]
  v_mfma_f32_16x16x16_bf16 v[244:247], v[156:157], v[30:31], v[244:247]
  v_mfma_f32_16x16x16_bf16 v[248:251], v[158:159], v[30:31], v[248:251]
  s_lshl_b32 s53, s49, 18
  s_lshl_b32 s54, s50, 12
  s_add_u32 s53, s53, s54
  s_add_u32 s53, s53, 50331648
  v_cvt_pk_bf16_f32 v32, v188, v189
  v_cvt_pk_bf16_f32 v33, v190, v191
  v_cvt_pk_bf16_f32 v34, v192, v193
  v_cvt_pk_bf16_f32 v35, v194, v195
  buffer_store_dwordx4 v[32:35], v8, s[40:43], s53 offen offset:0 sc1
  v_cvt_pk_bf16_f32 v36, v196, v197
  v_cvt_pk_bf16_f32 v37, v198, v199
  v_cvt_pk_bf16_f32 v38, v200, v201
  v_cvt_pk_bf16_f32 v39, v202, v203
  buffer_store_dwordx4 v[36:39], v8, s[40:43], s53 offen offset:1024 sc1
  v_cvt_pk_bf16_f32 v40, v204, v205
  v_cvt_pk_bf16_f32 v41, v206, v207
  v_cvt_pk_bf16_f32 v42, v208, v209
  v_cvt_pk_bf16_f32 v43, v210, v211
  buffer_store_dwordx4 v[40:43], v8, s[40:43], s53 offen offset:2048 sc1
  v_cvt_pk_bf16_f32 v44, v212, v213
  v_cvt_pk_bf16_f32 v45, v214, v215
  v_cvt_pk_bf16_f32 v46, v216, v217
  v_cvt_pk_bf16_f32 v47, v218, v219
  buffer_store_dwordx4 v[44:47], v8, s[40:43], s53 offen offset:3072 sc1
  s_add_u32 s53, s53, 131072
  v_cvt_pk_bf16_f32 v48, v220, v221
  v_cvt_pk_bf16_f32 v49, v222, v223
  v_cvt_pk_bf16_f32 v50, v224, v225
  v_cvt_pk_bf16_f32 v51, v226, v227
  buffer_store_dwordx4 v[48:51], v8, s[40:43], s53 offen offset:0 sc1
  v_cvt_pk_bf16_f32 v52, v228, v229
  v_cvt_pk_bf16_f32 v53, v230, v231
  v_cvt_pk_bf16_f32 v54, v232, v233
  v_cvt_pk_bf16_f32 v55, v234, v235
  buffer_store_dwordx4 v[52:55], v8, s[40:43], s53 offen offset:1024 sc1
  v_cvt_pk_bf16_f32 v56, v236, v237
  v_cvt_pk_bf16_f32 v57, v238, v239
  v_cvt_pk_bf16_f32 v58, v240, v241
  v_cvt_pk_bf16_f32 v59, v242, v243
  buffer_store_dwordx4 v[56:59], v8, s[40:43], s53 offen offset:2048 sc1
  v_cvt_pk_bf16_f32 v60, v244, v245
  v_cvt_pk_bf16_f32 v61, v246, v247
  v_cvt_pk_bf16_f32 v62, v248, v249
  v_cvt_pk_bf16_f32 v63, v250, v251
  buffer_store_dwordx4 v[60:63], v8, s[40:43], s53 offen offset:3072 sc1
  s_waitcnt vmcnt(0)
  s_lshl_b32 s46, s51, 2
  s_add_u32 s46, s46, 78647296
  v_mov_b32 v18, 1
  s_mov_b64 exec, 1
  buffer_store_dword v18, v3, s[40:43], s46 offen sc1
  s_mov_b64 exec, -1
  s_add_u32 s49, s49, 8
  s_cmp_lt_u32 s49, 64
  s_cbranch_scc1 L_att_5
  s_branch L_end
L_outproj:
  s_and_b32 s51, s48, 31
  s_bfe_u32 s49, s48, 0x10005
  s_mov_b32 s50, s51
  s_cmp_lt_u32 s51, 20
  s_cbranch_scc1 L_opd_9
  s_mul_i32 s46, s49, 12
  s_sub_u32 s50, s51, 20
  s_add_u32 s50, s50, s46
  s_mov_b32 s49, 2
  s_cmp_ge_u32 s50, 20
  s_cbranch_scc1 L_end
L_opd_9:
  s_cmp_lt_u32 s48, 64
  s_cselect_b32 s46, 3, 0
  s_add_u32 s49, s49, s46
  v_and_b32 v4, 15, v1
  v_lshrrev_b32 v5, 4, v1
  v_lshrrev_b32 v6, 2, v4
  v_and_b32 v7, 3, v1
  v_lshlrev_b32 v8, 4, v1
  v_mov_b32 v9, 0x4444
  v_mov_b32 v18, 0xeeee
  v_cmp_lt_u32 vcc, 7, v4
  s_nop 1
  v_cndmask_b32 v9, v9, v18, vcc
  s_lshl_b32 s60, s44, 15
  v_lshrrev_b32 v18, 2, v1
  v_mul_u32_u24 v9, 1280, v18
  v_lshl_add_u32 v9, v7, 4, v9
  v_lshl_add_u32 v10, v5, 2, v6
  v_lshlrev_b32 v10, 6, v10
  v_lshl_add_u32 v10, v7, 3, v10
  v_add_u32 v10, s60, v10
  s_mul_i32 s54, s44, 1310720
  s_lshl_b32 s46, s50, 6
  s_add_u32 s54, s54, s46
  s_add_u32 m0, s60, 0
  s_add_u32 s53, s54, 0
  buffer_load_dwordx4 v9, s[28:31], s53 offen lds
  s_add_u32 m0, s60, 1024
  s_add_u32 s53, s54, 20480
  buffer_load_dwordx4 v9, s[28:31], s53 offen lds
  s_add_u32 m0, s60, 2048
  s_add_u32 s53, s54, 40960
  buffer_load_dwordx4 v9, s[28:31], s53 offen lds
  s_add_u32 m0, s60, 3072
  s_add_u32 s53, s54, 61440
  buffer_load_dwordx4 v9, s[28:31], s53 offen lds
  s_add_u32 m0, s60, 4096
  s_add_u32 s53, s54, 81920
  buffer_load_dwordx4 v9, s[28:31], s53 offen lds
  s_add_u32 m0, s60, 5120
  s_add_u32 s53, s54, 102400
  buffer_load_dwordx4 v9, s[28:31], s53 offen lds
  s_add_u32 m0, s60, 6144
  s_add_u32 s53, s54, 122880
  buffer_load_dwordx4 v9, s[28:31], s53 offen lds
  s_add_u32 m0, s60, 7168
  s_add_u32 s53, s54, 143360
  buffer_load_dwordx4 v9, s[28:31], s53 offen lds
  s_add_u32 m0, s60, 8192
  s_add_u32 s53, s54, 163840
  buffer_load_dwordx4 v9, s[28:31], s53 offen lds
  s_add_u32 m0, s60, 9216
  s_add_u32 s53, s54, 184320
  buffer_load_dwordx4 v9, s[28:31], s53 offen lds
  s_add_u32 m0, s60, 10240
  s_add_u32 s53, s54, 204800
  buffer_load_dwordx4 v9, s[28:31], s53 offen lds
  s_add_u32 m0, s60, 11264
  s_add_u32 s53, s54, 225280
  buffer_load_dwordx4 v9, s[28:31], s53 offen lds
  s_add_u32 m0, s60, 12288
  s_add_u32 s53, s54, 245760
  buffer_load_dwordx4 v9, s[28:31], s53 offen lds
  s_add_u32 m0, s60, 13312
  s_add_u32 s53, s54, 266240
  buffer_load_dwordx4 v9, s[28:31], s53 offen lds
  s_add_u32 m0, s60, 14336
  s_add_u32 s53, s54, 286720
  buffer_load_dwordx4 v9, s[28:31], s53 offen lds
  s_add_u32 m0, s60, 15360
  s_add_u32 s53, s54, 307200
  buffer_load_dwordx4 v9, s[28:31], s53 offen lds
  s_add_u32 m0, s60, 16384
  s_add_u32 s53, s54, 327680
  buffer_load_dwordx4 v9, s[28:31], s53 offen lds
  s_add_u32 m0, s60, 17408
  s_add_u32 s53, s54, 348160
  buffer_load_dwordx4 v9, s[28:31], s53 offen lds
  s_add_u32 m0, s60, 18432
  s_add_u32 s53, s54, 368640
  buffer_load_dwordx4 v9, s[28:31], s53 offen lds
  s_add_u32 m0, s60, 19456
  s_add_u32 s53, s54, 389120
  buffer_load_dwordx4 v9, s[28:31], s53 offen lds
  s_add_u32 m0, s60, 20480
  s_add_u32 s53, s54, 409600
  buffer_load_dwordx4 v9, s[28:31], s53 offen lds
  s_add_u32 m0, s60, 21504
  s_add_u32 s53, s54, 430080
  buffer_load_dwordx4 v9, s[28:31], s53 offen lds
  s_add_u32 m0, s60, 22528
  s_add_u32 s53, s54, 450560
  buffer_load_dwordx4 v9, s[28:31], s53 offen lds
  s_add_u32 m0, s60, 23552
  s_add_u32 s53, s54, 471040
  buffer_load_dwordx4 v9, s[28:31], s53 offen lds
  s_add_u32 m0, s60, 24576
  s_add_u32 s53, s54, 491520
  buffer_load_dwordx4 v9, s[28:31], s53 offen lds
  s_add_u32 m0, s60, 25600
  s_add_u32 s53, s54, 512000
  buffer_load_dwordx4 v9, s[28:31], s53 offen lds
  s_add_u32 m0, s60, 26624
  s_add_u32 s53, s54, 532480
  buffer_load_dwordx4 v9, s[28:31], s53 offen lds
  s_add_u32 m0, s60, 27648
  s_add_u32 s53, s54, 552960
  buffer_load_dwordx4 v9, s[28:31], s53 offen lds
  s_add_u32 m0, s60, 28672
  s_add_u32 s53, s54, 573440
  buffer_load_dwordx4 v9, s[28:31], s53 offen lds
  s_add_u32 m0, s60, 29696
  s_add_u32 s53, s54, 593920
  buffer_load_dwordx4 v9, s[28:31], s53 offen lds
  s_add_u32 m0, s60, 30720
  s_add_u32 s53, s54, 614400
  buffer_load_dwordx4 v9, s[28:31], s53 offen lds
  s_add_u32 m0, s60, 31744
  s_add_u32 s53, s54, 634880
  buffer_load_dwordx4 v9, s[28:31], s53 offen lds
  s_waitcnt vmcnt(28)
  ds_read_b64_tr_b16 a[0:1], v10 offset:0
  ds_read_b64_tr_b16 a[2:3], v10 offset:1024
  ds_read_b64_tr_b16 a[4:5], v10 offset:32
  ds_read_b64_tr_b16 a[6:7], v10 offset:1056
  ds_read_b64_tr_b16 a[8:9], v10 offset:2048
  ds_read_b64_tr_b16 a[10:11], v10 offset:3072
  ds_read_b64_tr_b16 a[12:13], v10 offset:2080
  ds_read_b64_tr_b16 a[14:15], v10 offset:3104
  s_waitcnt lgkmcnt(0)
  s_add_u32 m0, s60, 0
  s_add_u32 s53, s54, 655360
  buffer_load_dwordx4 v9, s[28:31], s53 offen lds
  s_add_u32 m0, s60, 1024
  s_add_u32 s53, s54, 675840
  buffer_load_dwordx4 v9, s[28:31], s53 offen lds
  s_add_u32 m0, s60, 2048
  s_add_u32 s53, s54, 696320
  buffer_load_dwordx4 v9, s[28:31], s53 offen lds
  s_add_u32 m0, s60, 3072
  s_add_u32 s53, s54, 716800
  buffer_load_dwordx4 v9, s[28:31], s53 offen lds
  s_waitcnt vmcnt(28)
  ds_read_b64_tr_b16 a[16:17], v10 offset:4096
  ds_read_b64_tr_b16 a[18:19], v10 offset:5120
  ds_read_b64_tr_b16 a[20:21], v10 offset:4128
  ds_read_b64_tr_b16 a[22:23], v10 offset:5152
  ds_read_b64_tr_b16 a[24:25], v10 offset:6144
  ds_read_b64_tr_b16 a[26:27], v10 offset:7168
  ds_read_b64_tr_b16 a[28:29], v10 offset:6176
  ds_read_b64_tr_b16 a[30:31], v10 offset:7200
  s_waitcnt lgkmcnt(0)
  s_add_u32 m0, s60, 4096
  s_add_u32 s53, s54, 737280
  buffer_load_dwordx4 v9, s[28:31], s53 offen lds
  s_add_u32 m0, s60, 5120
  s_add_u32 s53, s54, 757760
  buffer_load_dwordx4 v9, s[28:31], s53 offen lds
  s_add_u32 m0, s60, 6144
  s_add_u32 s53, s54, 778240
  buffer_load_dwordx4 v9, s[28:31], s53 offen lds
  s_add_u32 m0, s60, 7168
  s_add_u32 s53, s54, 798720
  buffer_load_dwordx4 v9, s[28:31], s53 offen lds
  s_waitcnt vmcnt(28)
  ds_read_b64_tr_b16 a[32:33], v10 offset:8192
  ds_read_b64_tr_b16 a[34:35], v10 offset:9216
  ds_read_b64_tr_b16 a[36:37], v10 offset:8224
  ds_read_b64_tr_b16 a[38:39], v10 offset:9248
  ds_read_b64_tr_b16 a[40:41], v10 offset:10240
  ds_read_b64_tr_b16 a[42:43], v10 offset:11264
  ds_read_b64_tr_b16 a[44:45], v10 offset:10272
  ds_read_b64_tr_b16 a[46:47], v10 offset:11296
  s_waitcnt lgkmcnt(0)
  s_add_u32 m0, s60, 8192
  s_add_u32 s53, s54, 819200
  buffer_load_dwordx4 v9, s[28:31], s53 offen lds
  s_add_u32 m0, s60, 9216
  s_add_u32 s53, s54, 839680
  buffer_load_dwordx4 v9, s[28:31], s53 offen lds
  s_add_u32 m0, s60, 10240
  s_add_u32 s53, s54, 860160
  buffer_load_dwordx4 v9, s[28:31], s53 offen lds
  s_add_u32 m0, s60, 11264
  s_add_u32 s53, s54, 880640
  buffer_load_dwordx4 v9, s[28:31], s53 offen lds
  s_waitcnt vmcnt(28)
  ds_read_b64_tr_b16 a[48:49], v10 offset:12288
  ds_read_b64_tr_b16 a[50:51], v10 offset:13312
  ds_read_b64_tr_b16 a[52:53], v10 offset:12320
  ds_read_b64_tr_b16 a[54:55], v10 offset:13344
  ds_read_b64_tr_b16 a[56:57], v10 offset:14336
  ds_read_b64_tr_b16 a[58:59], v10 offset:15360
  ds_read_b64_tr_b16 a[60:61], v10 offset:14368
  ds_read_b64_tr_b16 a[62:63], v10 offset:15392
  s_waitcnt lgkmcnt(0)
  s_add_u32 m0, s60, 12288
  s_add_u32 s53, s54, 901120
  buffer_load_dwordx4 v9, s[28:31], s53 offen lds
  s_add_u32 m0, s60, 13312
  s_add_u32 s53, s54, 921600
  buffer_load_dwordx4 v9, s[28:31], s53 offen lds
  s_add_u32 m0, s60, 14336
  s_add_u32 s53, s54, 942080
  buffer_load_dwordx4 v9, s[28:31], s53 offen lds
  s_add_u32 m0, s60, 15360
  s_add_u32 s53, s54, 962560
  buffer_load_dwordx4 v9, s[28:31], s53 offen lds
  s_waitcnt vmcnt(28)
  ds_read_b64_tr_b16 a[64:65], v10 offset:16384
  ds_read_b64_tr_b16 a[66:67], v10 offset:17408
  ds_read_b64_tr_b16 a[68:69], v10 offset:16416
  ds_read_b64_tr_b16 a[70:71], v10 offset:17440
  ds_read_b64_tr_b16 a[72:73], v10 offset:18432
  ds_read_b64_tr_b16 a[74:75], v10 offset:19456
  ds_read_b64_tr_b16 a[76:77], v10 offset:18464
  ds_read_b64_tr_b16 a[78:79], v10 offset:19488
  s_waitcnt lgkmcnt(0)
  s_add_u32 m0, s60, 16384
  s_add_u32 s53, s54, 983040
  buffer_load_dwordx4 v9, s[28:31], s53 offen lds
  s_add_u32 m0, s60, 17408
  s_add_u32 s53, s54, 1003520
  buffer_load_dwordx4 v9, s[28:31], s53 offen lds
  s_add_u32 m0, s60, 18432
  s_add_u32 s53, s54, 1024000
  buffer_load_dwordx4 v9, s[28:31], s53 offen lds
  s_add_u32 m0, s60, 19456
  s_add_u32 s53, s54, 1044480
  buffer_load_dwordx4 v9, s[28:31], s53 offen lds
  s_waitcnt vmcnt(28)
  ds_read_b64_tr_b16 a[80:81], v10 offset:20480
  ds_read_b64_tr_b16 a[82:83], v10 offset:21504
  ds_read_b64_tr_b16 a[84:85], v10 offset:20512
  ds_read_b64_tr_b16 a[86:87], v10 offset:21536
  ds_read_b64_tr_b16 a[88:89], v10 offset:22528
  ds_read_b64_tr_b16 a[90:91], v10 offset:23552
  ds_read_b64_tr_b16 a[92:93], v10 offset:22560
  ds_read_b64_tr_b16 a[94:95], v10 offset:23584
  s_waitcnt lgkmcnt(0)
  s_add_u32 m0, s60, 20480
  s_add_u32 s53, s54, 1064960
  buffer_load_dwordx4 v9, s[28:31], s53 offen lds
  s_add_u32 m0, s60, 21504
  s_add_u32 s53, s54, 1085440
  buffer_load_dwordx4 v9, s[28:31], s53 offen lds
  s_add_u32 m0, s60, 22528
  s_add_u32 s53, s54, 1105920
  buffer_load_dwordx4 v9, s[28:31], s53 offen lds
  s_add_u32 m0, s60, 23552
  s_add_u32 s53, s54, 1126400
  buffer_load_dwordx4 v9, s[28:31], s53 offen lds
  s_waitcnt vmcnt(28)
  ds_read_b64_tr_b16 a[96:97], v10 offset:24576
  ds_read_b64_tr_b16 a[98:99], v10 offset:25600
  ds_read_b64_tr_b16 a[100:101], v10 offset:24608
  ds_read_b64_tr_b16 a[102:103], v10 offset:25632
  ds_read_b64_tr_b16 a[104:105], v10 offset:26624
  ds_read_b64_tr_b16 a[106:107], v10 offset:27648
  ds_read_b64_tr_b16 a[108:109], v10 offset:26656
  ds_read_b64_tr_b16 a[110:111], v10 offset:27680
  s_waitcnt lgkmcnt(0)
  s_add_u32 m0, s60, 24576
  s_add_u32 s53, s54, 1146880
  buffer_load_dwordx4 v9, s[28:31], s53 offen lds
  s_add_u32 m0, s60, 25600
  s_add_u32 s53, s54, 1167360
  buffer_load_dwordx4 v9, s[28:31], s53 offen lds
  s_add_u32 m0, s60, 26624
  s_add_u32 s53, s54, 1187840
  buffer_load_dwordx4 v9, s[28:31], s53 offen lds
  s_add_u32 m0, s60, 27648
  s_add_u32 s53, s54, 1208320
  buffer_load_dwordx4 v9, s[28:31], s53 offen lds
  s_waitcnt vmcnt(28)
  ds_read_b64_tr_b16 a[112:113], v10 offset:28672
  ds_read_b64_tr_b16 a[114:115], v10 offset:29696
  ds_read_b64_tr_b16 a[116:117], v10 offset:28704
  ds_read_b64_tr_b16 a[118:119], v10 offset:29728
  ds_read_b64_tr_b16 a[120:121], v10 offset:30720
  ds_read_b64_tr_b16 a[122:123], v10 offset:31744
  ds_read_b64_tr_b16 a[124:125], v10 offset:30752
  ds_read_b64_tr_b16 a[126:127], v10 offset:31776
  s_waitcnt lgkmcnt(0)
  s_add_u32 m0, s60, 28672
  s_add_u32 s53, s54, 1228800
  buffer_load_dwordx4 v9, s[28:31], s53 offen lds
  s_add_u32 m0, s60, 29696
  s_add_u32 s53, s54, 1249280
  buffer_load_dwordx4 v9, s[28:31], s53 offen lds
  s_add_u32 m0, s60, 30720
  s_add_u32 s53, s54, 1269760
  buffer_load_dwordx4 v9, s[28:31], s53 offen lds
  s_add_u32 m0, s60, 31744
  s_add_u32 s53, s54, 1290240
  buffer_load_dwordx4 v9, s[28:31], s53 offen lds
  s_waitcnt vmcnt(28)
  ds_read_b64_tr_b16 a[128:129], v10 offset:0
  ds_read_b64_tr_b16 a[130:131], v10 offset:1024
  ds_read_b64_tr_b16 a[132:133], v10 offset:32
  ds_read_b64_tr_b16 a[134:135], v10 offset:1056
  ds_read_b64_tr_b16 a[136:137], v10 offset:2048
  ds_read_b64_tr_b16 a[138:139], v10 offset:3072
  ds_read_b64_tr_b16 a[140:141], v10 offset:2080
  ds_read_b64_tr_b16 a[142:143], v10 offset:3104
  s_waitcnt vmcnt(24)
  ds_read_b64_tr_b16 a[144:145], v10 offset:4096
  ds_read_b64_tr_b16 a[146:147], v10 offset:5120
  ds_read_b64_tr_b16 a[148:149], v10 offset:4128
  ds_read_b64_tr_b16 a[150:151], v10 offset:5152
  ds_read_b64_tr_b16 a[152:153], v10 offset:6144
  ds_read_b64_tr_b16 a[154:155], v10 offset:7168
  ds_read_b64_tr_b16 a[156:157], v10 offset:6176
  ds_read_b64_tr_b16 a[158:159], v10 offset:7200
  s_waitcnt vmcnt(20)
  ds_read_b64_tr_b16 a[160:161], v10 offset:8192
  ds_read_b64_tr_b16 a[162:163], v10 offset:9216
  ds_read_b64_tr_b16 a[164:165], v10 offset:8224
  ds_read_b64_tr_b16 a[166:167], v10 offset:9248
  ds_read_b64_tr_b16 a[168:169], v10 offset:10240
  ds_read_b64_tr_b16 a[170:171], v10 offset:11264
  ds_read_b64_tr_b16 a[172:173], v10 offset:10272
  ds_read_b64_tr_b16 a[174:175], v10 offset:11296
  s_waitcnt vmcnt(16)
  ds_read_b64_tr_b16 a[176:177], v10 offset:12288
  ds_read_b64_tr_b16 a[178:179], v10 offset:13312
  ds_read_b64_tr_b16 a[180:181], v10 offset:12320
  ds_read_b64_tr_b16 a[182:183], v10 offset:13344
  ds_read_b64_tr_b16 a[184:185], v10 offset:14336
  ds_read_b64_tr_b16 a[186:187], v10 offset:15360
  ds_read_b64_tr_b16 a[188:189], v10 offset:14368
  ds_read_b64_tr_b16 a[190:191], v10 offset:15392
  s_waitcnt vmcnt(12)
  ds_read_b64_tr_b16 a[192:193], v10 offset:16384
  ds_read_b64_tr_b16 a[194:195], v10 offset:17408
  ds_read_b64_tr_b16 a[196:197], v10 offset:16416
  ds_read_b64_tr_b16 a[198:199], v10 offset:17440
  ds_read_b64_tr_b16 a[200:201], v10 offset:18432
  ds_read_b64_tr_b16 a[202:203], v10 offset:19456
  ds_read_b64_tr_b16 a[204:205], v10 offset:18464
  ds_read_b64_tr_b16 a[206:207], v10 offset:19488
  s_waitcnt vmcnt(8)
  ds_read_b64_tr_b16 a[208:209], v10 offset:20480
  ds_read_b64_tr_b16 a[210:211], v10 offset:21504
  ds_read_b64_tr_b16 a[212:213], v10 offset:20512
  ds_read_b64_tr_b16 a[214:215], v10 offset:21536
  ds_read_b64_tr_b16 a[216:217], v10 offset:22528
  ds_read_b64_tr_b16 a[218:219], v10 offset:23552
  ds_read_b64_tr_b16 a[220:221], v10 offset:22560
  ds_read_b64_tr_b16 a[222:223], v10 offset:23584
  s_waitcnt vmcnt(4)
  ds_read_b64_tr_b16 a[224:225], v10 offset:24576
  ds_read_b64_tr_b16 a[226:227], v10 offset:25600
  ds_read_b64_tr_b16 a[228:229], v10 offset:24608
  ds_read_b64_tr_b16 a[230:231], v10 offset:25632
  ds_read_b64_tr_b16 a[232:233], v10 offset:26624
  ds_read_b64_tr_b16 a[234:235], v10 offset:27648
  ds_read_b64_tr_b16 a[236:237], v10 offset:26656
  ds_read_b64_tr_b16 a[238:239], v10 offset:27680
  s_waitcnt vmcnt(0)
  ds_read_b64_tr_b16 a[240:241], v10 offset:28672
  ds_read_b64_tr_b16 a[242:243], v10 offset:29696
  ds_read_b64_tr_b16 a[244:245], v10 offset:28704
  ds_read_b64_tr_b16 a[246:247], v10 offset:29728
  ds_read_b64_tr_b16 a[248:249], v10 offset:30720
  ds_read_b64_tr_b16 a[250:251], v10 offset:31744
  ds_read_b64_tr_b16 a[252:253], v10 offset:30752
  ds_read_b64_tr_b16 a[254:255], v10 offset:31776
  s_waitcnt lgkmcnt(0)
  s_barrier
  v_and_b32 v18, 7, v1
  s_lshl_b32 s46, s44, 5
  v_lshlrev_b32 v11, 2, v18
  v_add_u32 v11, s46, v11
  s_and_b32 s46, s44, 1
  s_lshl_b32 s46, s46, 5
  s_lshl_b32 s53, s50, 6
  s_add_u32 s46, s46, s53
  v_mul_u32_u24 v12, 1280, v4
  v_lshl_add_u32 v12, v5, 3, v12
  v_add_u32 v12, s46, v12
  s_lshl_b32 s46, s44, 12
  v_add_u32 v13, s46, v8
  s_and_b32 s46, s44, 1
  s_lshl_b32 s46, s46, 10
  v_add_u32 v14, s46, v8
  s_mov_b32 s47, 262144
L_wdbg_10:
  buffer_load_dword v18, v3, s[36:39], 0 offen offset:40 sc1
  s_waitcnt vmcnt(0)
  s_sub_u32 s47, s47, 1
  s_cbranch_scc1 L_abort
  v_cmp_gt_u32 vcc, 64, v18
  s_cbranch_vccnz L_wdbg_10
L_ops_11:
  s_lshr_b32 s46, s49, 1
  s_lshl_b32 s46, s46, 7
  s_add_u32 s46, s46, 78647296
  s_mov_b32 s47, 262144
L_opf_12:
  buffer_load_dword v18, v11, s[40:43], s46 offen sc1
  s_waitcnt vmcnt(0)
  s_sub_u32 s47, s47, 1
  s_cbranch_scc1 L_abort
  v_cmp_eq_u32 vcc, 0, v18
  s_cbranch_vccz L_opf_12_ok
  s_sleep 2
  s_branch L_opf_12
L_opf_12_ok:
  s_lshl_b32 s54, s49, 17
  s_lshl_b32 s46, s44, 15
  s_add_u32 s54, s54, s46
  s_add_u32 s54, s54, 50331648
  s_add_u32 s53, s54, 0
  buffer_load_dwordx4 v[40:43], v8, s[40:43], s53 offen offset:0 sc1
  buffer_load_dwordx4 v[44:47], v8, s[40:43], s53 offen offset:1024 sc1
  buffer_load_dwordx4 v[48:51], v8, s[40:43], s53 offen offset:2048 sc1
  buffer_load_dwordx4 v[52:55], v8, s[40:43], s53 offen offset:3072 sc1
  s_add_u32 s53, s54, 4096
  buffer_load_dwordx4 v[56:59], v8, s[40:43], s53 offen offset:0 sc1
  buffer_load_dwordx4 v[60:63], v8, s[40:43], s53 offen offset:1024 sc1
  buffer_load_dwordx4 v[64:67], v8, s[40:43], s53 offen offset:2048 sc1
  buffer_load_dwordx4 v[68:71], v8, s[40:43], s53 offen offset:3072 sc1
  s_add_u32 s53, s54, 8192
  buffer_load_dwordx4 v[72:75], v8, s[40:43], s53 offen offset:0 sc1
  buffer_load_dwordx4 v[76:79], v8, s[40:43], s53 offen offset:1024 sc1
  buffer_load_dwordx4 v[80:83], v8, s[40:43], s53 offen offset:2048 sc1
  buffer_load_dwordx4 v[84:87], v8, s[40:43], s53 offen offset:3072 sc1
  s_add_u32 s53, s54, 12288
  buffer_load_dwordx4 v[88:91], v8, s[40:43], s53 offen offset:0 sc1
  buffer_load_dwordx4 v[92:95], v8, s[40:43], s53 offen offset:1024 sc1
  buffer_load_dwordx4 v[96:99], v8, s[40:43], s53 offen offset:2048 sc1
  buffer_load_dwordx4 v[100:103], v8, s[40:43], s53 offen offset:3072 sc1
  s_add_u32 s53, s54, 16384
  buffer_load_dwordx4 v[104:107], v8, s[40:43], s53 offen offset:0 sc1
  buffer_load_dwordx4 v[108:111], v8, s[40:43], s53 offen offset:1024 sc1
  buffer_load_dwordx4 v[112:115], v8, s[40:43], s53 offen offset:2048 sc1
  buffer_load_dwordx4 v[116:119], v8, s[40:43], s53 offen offset:3072 sc1
  s_add_u32 s53, s54, 20480
  buffer_load_dwordx4 v[120:123], v8, s[40:43], s53 offen offset:0 sc1
  buffer_load_dwordx4 v[124:127], v8, s[40:43], s53 offen offset:1024 sc1
  buffer_load_dwordx4 v[128:131], v8, s[40:43], s53 offen offset:2048 sc1
  buffer_load_dwordx4 v[132:135], v8, s[40:43], s53 offen offset:3072 sc1
  s_add_u32 s53, s54, 24576
  buffer_load_dwordx4 v[136:139], v8, s[40:43], s53 offen offset:0 sc1
  buffer_load_dwordx4 v[140:143], v8, s[40:43], s53 offen offset:1024 sc1
  buffer_load_dwordx4 v[144:147], v8, s[40:43], s53 offen offset:2048 sc1
  buffer_load_dwordx4 v[148:151], v8, s[40:43], s53 offen offset:3072 sc1
  s_add_u32 s53, s54, 28672
  buffer_load_dwordx4 v[152:155], v8, s[40:43], s53 offen offset:0 sc1
  buffer_load_dwordx4 v[156:159], v8, s[40:43], s53 offen offset:1024 sc1
  buffer_load_dwordx4 v[160:163], v8, s[40:43], s53 offen offset:2048 sc1
  buffer_load_dwordx4 v[164:167], v8, s[40:43], s53 offen offset:3072 sc1
  s_waitcnt vmcnt(31)
  v_mfma_f32_16x16x32_bf16 v[20:23], a[0:3], v[40:43], 0
  v_mfma_f32_16x16x32_bf16 v[24:27], a[4:7], v[40:43], 0
  s_waitcnt vmcnt(30)
  v_mfma_f32_16x16x32_bf16 v[20:23], a[8:11], v[44:47], v[20:23]
  v_mfma_f32_16x16x32_bf16 v[24:27], a[12:15], v[44:47], v[24:27]
  s_waitcnt vmcnt(29)
  v_mfma_f32_16x16x32_bf16 v[20:23], a[16:19], v[48:51], v[20:23]
  v_mfma_f32_16x16x32_bf16 v[24:27], a[20:23], v[48:51], v[24:27]
  s_waitcnt vmcnt(28)
  v_mfma_f32_16x16x32_bf16 v[20:23], a[24:27], v[52:55], v[20:23]
  v_mfma_f32_16x16x32_bf16 v[24:27], a[28:31], v[52:55], v[24:27]
  s_waitcnt vmcnt(27)
  v_mfma_f32_16x16x32_bf16 v[20:23], a[32:35], v[56:59], v[20:23]
  v_mfma_f32_16x16x32_bf16 v[24:27], a[36:39], v[56:59], v[24:27]
  s_waitcnt vmcnt(26)
  v_mfma_f32_16x16x32_bf16 v[20:23], a[40:43], v[60:63], v[20:23]
  v_mfma_f32_16x16x32_bf16 v[24:27], a[44:47], v[60:63], v[24:27]
  s_waitcnt vmcnt(25)
  v_mfma_f32_16x16x32_bf16 v[20:23], a[48:51], v[64:67], v[20:23]
  v_mfma_f32_16x16x32_bf16 v[24:27], a[52:55], v[64:67], v[24:27]
  s_waitcnt vmcnt(24)
  v_mfma_f32_16x16x32_bf16 v[20:23], a[56:59], v[68:71], v[20:23]
  v_mfma_f32_16x16x32_bf16 v[24:27], a[60:63], v[68:71], v[24:27]
  s_waitcnt vmcnt(23)
  v_mfma_f32_16x16x32_bf16 v[20:23], a[64:67], v[72:75], v[20:23]
  v_mfma_f32_16x16x32_bf16 v[24:27], a[68:71], v[72:75], v[24:27]
  s_waitcnt vmcnt(22)
  v_mfma_f32_16x16x32_bf16 v[20:23], a[72:75], v[76:79], v[20:23]
  v_mfma_f32_16x16x32_bf16 v[24:27], a[76:79], v[76:79], v[24:27]
  s_waitcnt vmcnt(21)
  v_mfma_f32_16x16x32_bf16 v[20:23], a[80:83], v[80:83], v[20:23]
  v_mfma_f32_16x16x32_bf16 v[24:27], a[84:87], v[80:83], v[24:27]
  s_waitcnt vmcnt(20)
  v_mfma_f32_16x16x32_bf16 v[20:23], a[88:91], v[84:87], v[20:23]
  v_mfma_f32_16x16x32_bf16 v[24:27], a[92:95], v[84:87], v[24:27]
  s_waitcnt vmcnt(19)
  v_mfma_f32_16x16x32_bf16 v[20:23], a[96:99], v[88:91], v[20:23]
  v_mfma_f32_16x16x32_bf16 v[24:27], a[100:103], v[88:91], v[24:27]
  s_waitcnt vmcnt(18)
  v_mfma_f32_16x16x32_bf16 v[20:23], a[104:107], v[92:95], v[20:23]
  v_mfma_f32_16x16x32_bf16 v[24:27], a[108:111], v[92:95], v[24:27]
  s_waitcnt vmcnt(17)
  v_mfma_f32_16x16x32_bf16 v[20:23], a[112:115], v[96:99], v[20:23]
  v_mfma_f32_16x16x32_bf16 v[24:27], a[116:119], v[96:99], v[24:27]
  s_waitcnt vmcnt(16)
  v_mfma_f32_16x16x32_bf16 v[20:23], a[120:123], v[100:103], v[20:23]
  v_mfma_f32_16x16x32_bf16 v[24:27], a[124:127], v[100:103], v[24:27]
  s_waitcnt vmcnt(15)
  v_mfma_f32_16x16x32_bf16 v[20:23], a[128:131], v[104:107], v[20:23]
  v_mfma_f32_16x16x32_bf16 v[24:27], a[132:135], v[104:107], v[24:27]
  s_waitcnt vmcnt(14)
  v_mfma_f32_16x16x32_bf16 v[20:23], a[136:139], v[108:111], v[20:23]
  v_mfma_f32_16x16x32_bf16 v[24:27], a[140:143], v[108:111], v[24:27]
  s_waitcnt vmcnt(13)
  v_mfma_f32_16x16x32_bf16 v[20:23], a[144:147], v[112:115], v[20:23]
  v_mfma_f32_16x16x32_bf16 v[24:27], a[148:151], v[112:115], v[24:27]
  s_waitcnt vmcnt(12)
  v_mfma_f32_16x16x32_bf16 v[20:23], a[152:155], v[116:119], v[20:23]
  v_mfma_f32_16x16x32_bf16 v[24:27], a[156:159], v[116:119], v[24:27]
  s_waitcnt vmcnt(11)
  v_mfma_f32_16x16x32_bf16 v[20:23], a[160:163], v[120:123], v[20:23]
  v_mfma_f32_16x16x32_bf16 v[24:27], a[164:167], v[120:123], v[24:27]
  s_waitcnt vmcnt(10)
  v_mfma_f32_16x16x32_bf16 v[20:23], a[168:171], v[124:127], v[20:23]
  v_mfma_f32_16x16x32_bf16 v[24:27], a[172:175], v[124:127], v[24:27]
  s_waitcnt vmcnt(9)
  v_mfma_f32_16x16x32_bf16 v[20:23], a[176:179], v[128:131], v[20:23]
  v_mfma_f32_16x16x32_bf16 v[24:27], a[180:183], v[128:131], v[24:27]
  s_waitcnt vmcnt(8)
  v_mfma_f32_16x16x32_bf16 v[20:23], a[184:187], v[132:135], v[20:23]
  v_mfma_f32_16x16x32_bf16 v[24:27], a[188:191], v[132:135], v[24:27]
  s_waitcnt vmcnt(7)
  v_mfma_f32_16x16x32_bf16 v[20:23], a[192:195], v[136:139], v[20:23]
  v_mfma_f32_16x16x32_bf16 v[24:27], a[196:199], v[136:139], v[24:27]
  s_waitcnt vmcnt(6)
  v_mfma_f32_16x16x32_bf16 v[20:23], a[200:203], v[140:143], v[20:23]
  v_mfma_f32_16x16x32_bf16 v[24:27], a[204:207], v[140:143], v[24:27]
  s_waitcnt vmcnt(5)
  v_mfma_f32_16x16x32_bf16 v[20:23], a[208:211], v[144:147], v[20:23]
  v_mfma_f32_16x16x32_bf16 v[24:27], a[212:215], v[144:147], v[24:27]
  s_waitcnt vmcnt(4)
  v_mfma_f32_16x16x32_bf16 v[20:23], a[216:219], v[148:151], v[20:23]
  v_mfma_f32_16x16x32_bf16 v[24:27], a[220:223], v[148:151], v[24:27]
  s_waitcnt vmcnt(3)
  v_mfma_f32_16x16x32_bf16 v[20:23], a[224:227], v[152:155], v[20:23]
  v_mfma_f32_16x16x32_bf16 v[24:27], a[228:231], v[152:155], v[24:27]
  s_waitcnt vmcnt(2)
  v_mfma_f32_16x16x32_bf16 v[20:23], a[232:235], v[156:159], v[20:23]
  v_mfma_f32_16x16x32_bf16 v[24:27], a[236:239], v[156:159], v[24:27]
  s_waitcnt vmcnt(1)
  v_mfma_f32_16x16x32_bf16 v[20:23], a[240:243], v[160:163], v[20:23]
  v_mfma_f32_16x16x32_bf16 v[24:27], a[244:247], v[160:163], v[24:27]
  s_waitcnt vmcnt(0)
  v_mfma_f32_16x16x32_bf16 v[20:23], a[248:251], v[164:167], v[20:23]
  v_mfma_f32_16x16x32_bf16 v[24:27], a[252:255], v[164:167], v[24:27]
  s_nop 6
  ds_write_b128 v13, v[20:23] offset:0
  ds_write_b128 v13, v[24:27] offset:1024
  s_waitcnt lgkmcnt(0)
  s_barrier
  ds_read_b128 v[40:43], v14 offset:0
  ds_read_b128 v[44:47], v14 offset:4096
  ds_read_b128 v[48:51], v14 offset:8192
  ds_read_b128 v[52:55], v14 offset:12288
  v_xor_b32 v13, 0x4000, v13
  v_xor_b32 v14, 0x4000, v14
  s_mul_i32 s53, s49, 20480
  s_waitcnt lgkmcnt(0)
  v_add_f32 v40, v40, v44
  v_add_f32 v48, v48, v52
  v_add_f32 v41, v41, v45
  v_add_f32 v49, v49, v53
  v_add_f32 v42, v42, v46
  v_add_f32 v50, v50, v54
  v_add_f32 v43, v43, v47
  v_add_f32 v51, v51, v55
  v_add_f32 v40, v40, v48
  v_add_f32 v41, v41, v49
  v_add_f32 v42, v42, v50
  v_add_f32 v43, v43, v51
  v_cvt_pk_bf16_f32 v18, v40, v41
  v_cvt_pk_bf16_f32 v19, v42, v43
  s_cmp_ge_u32 s44, 2
  s_cbranch_scc1 L_op2_8
  buffer_store_dwordx2 v[18:19], v12, s[32:35], s53 offen
L_op2_8:
  s_add_u32 s49, s49, 6
  s_cmp_lt_u32 s49, 128
  s_cbranch_scc1 L_ops_11
  s_branch L_end
L_chain:
  s_mov_b32 s48, s45
  v_and_b32 v4, 15, v1
  v_lshrrev_b32 v5, 4, v1
  v_lshrrev_b32 v6, 2, v4
  v_and_b32 v7, 3, v1
  v_lshlrev_b32 v8, 4, v1
  v_mov_b32 v9, 0x4444
  v_mov_b32 v18, 0xeeee
  v_cmp_lt_u32 vcc, 7, v4
  s_nop 1
  v_cndmask_b32 v9, v9, v18, vcc
  v_mov_b32 v20, -1
  v_mov_b32 v21, -1
  v_mov_b32 v22, -1
  v_mov_b32 v23, -1
  v_lshlrev_b32 v18, 4, v0
  s_mul_i32 s46, s48, 12288
  s_add_u32 s53, s46, 75497472
  buffer_store_dwordx4 v[20:23], v18, s[40:43], s53 offen sc1
  s_add_u32 s53, s46, 75501568
  buffer_store_dwordx4 v[20:23], v18, s[40:43], s53 offen sc1
  s_add_u32 s53, s46, 75505664
  buffer_store_dwordx4 v[20:23], v18, s[40:43], s53 offen sc1
  s_add_u32 s53, s46, 76546048
  buffer_store_dwordx4 v[20:23], v18, s[40:43], s53 offen sc1
  s_add_u32 s53, s46, 76550144
  buffer_store_dwordx4 v[20:23], v18, s[40:43], s53 offen sc1
  s_add_u32 s53, s46, 76554240
  buffer_store_dwordx4 v[20:23], v18, s[40:43], s53 offen sc1
  s_lshl_b32 s46, s48, 13
  s_add_u32 s53, s46, 77594624
  buffer_store_dwordx4 v[20:23], v18, s[40:43], s53 offen sc1
  s_add_u32 s53, s46, 77598720
  buffer_store_dwordx4 v[20:23], v18, s[40:43], s53 offen sc1
  v_and_b32 v18, 1, v5
  s_lshl_b32 s46, s44, 1
  v_or_b32 v19, s46, v18
  v_lshlrev_b32 v19, 1, v19
  v_xor_b32 v19, v19, v4
  s_lshl_b32 s46, s44, 2
  v_add_u32 v26, s46, v5
  v_lshlrev_b32 v20, 13, v26
  v_lshl_add_u32 v20, v19, 4, v20
  v_lshlrev_b32 v19, 2, v18
  v_xor_b32 v19, v19, v4
  v_mul_u32_u24 v21, 1280, v26
  v_xor_b32 v27, 8, v19
  v_lshl_add_u32 v22, v27, 4, v21
  v_lshl_add_u32 v21, v19, 4, v21
  v_lshrrev_b32 v18, 1, v5
  v_and_b32 v19, 1, v5
  v_lshrrev_b32 v26, 1, v6
  v_and_b32 v27, 1, v6
  v_lshlrev_b32 v28, 4, v18
  v_lshl_add_u32 v28, v19, 2, v28
  v_lshl_add_u32 v28, v26, 3, v28
  v_add_u32 v28, v28, v27
  v_lshlrev_b32 v28, 8, v28
  v_lshl_add_u32 v28, v7, 3, v28
  v_lshl_add_u32 v29, v19, 1, v27
  v_lshl_add_u32 v29, v26, 2, v29
  s_lshl_b32 s46, s44, 1
  v_xor_b32 v29, s46, v29
  v_lshl_add_u32 v23, v29, 5, v28
  v_xor_b32 v29, 1, v29
  v_lshl_add_u32 v24, v29, 5, v28
  v_lshlrev_b32 v28, 4, v19
  v_lshl_add_u32 v28, v18, 2, v28
  v_add_u32 v28, v28, v27
  v_lshlrev_b32 v28, 8, v28
  v_lshl_add_u32 v28, v7, 3, v28
  v_lshlrev_b32 v29, 1, v27
  v_lshl_add_u32 v29, v19, 2, v29
  v_add_u32 v30, s46, v26
  v_xor_b32 v29, v29, v30
  v_lshl_add_u32 v25, v29, 5, v28
  v_add_u32 v26, 0x10000, v23
  v_add_u32 v27, 0x10000, v24
  v_add_u32 v28, 0x10000, v25
  s_lshl_b32 s60, s44, 10
  s_lshl_b32 s0, s48, 8
  s_mul_i32 s1, s48, 163840
  s_add_u32 m0, s60, 0
  s_add_u32 s2, s0, 0
  buffer_load_dwordx4 v20, s[16:19], s2 offen lds
  s_add_u32 m0, s60, 4096
  s_add_u32 s2, s0, 131072
  buffer_load_dwordx4 v20, s[16:19], s2 offen lds
  s_add_u32 m0, s60, 8192
  s_add_u32 s2, s0, 262144
  buffer_load_dwordx4 v20, s[16:19], s2 offen lds
  s_add_u32 m0, s60, 12288
  s_add_u32 s2, s0, 393216
  buffer_load_dwordx4 v20, s[16:19], s2 offen lds
  s_add_u32 m0, s60, 16384
  s_add_u32 s2, s0, 0
  buffer_load_dwordx4 v20, s[20:23], s2 offen lds
  s_add_u32 m0, s60, 20480
  s_add_u32 s2, s0, 131072
  buffer_load_dwordx4 v20, s[20:23], s2 offen lds
  s_add_u32 m0, s60, 24576
  s_add_u32 s2, s0, 262144
  buffer_load_dwordx4 v20, s[20:23], s2 offen lds
  s_add_u32 m0, s60, 28672
  s_add_u32 s2, s0, 393216
  buffer_load_dwordx4 v20, s[20:23], s2 offen lds
  s_add_u32 m0, s60, 32768
  s_add_u32 s2, s0, 524288
  buffer_load_dwordx4 v20, s[16:19], s2 offen lds
  s_add_u32 m0, s60, 36864
  s_add_u32 s2, s0, 655360
  buffer_load_dwordx4 v20, s[16:19], s2 offen lds
  s_add_u32 m0, s60, 40960
  s_add_u32 s2, s0, 786432
  buffer_load_dwordx4 v20, s[16:19], s2 offen lds
  s_add_u32 m0, s60, 45056
  s_add_u32 s2, s0, 917504
  buffer_load_dwordx4 v20, s[16:19], s2 offen lds
  s_add_u32 m0, s60, 49152
  s_add_u32 s2, s0, 524288
  buffer_load_dwordx4 v20, s[20:23], s2 offen lds
  s_add_u32 m0, s60, 53248
  s_add_u32 s2, s0, 655360
  buffer_load_dwordx4 v20, s[20:23], s2 offen lds
  s_add_u32 m0, s60, 57344
  s_add_u32 s2, s0, 786432
  buffer_load_dwordx4 v20, s[20:23], s2 offen lds
  s_add_u32 m0, s60, 61440
  s_add_u32 s2, s0, 917504
  buffer_load_dwordx4 v20, s[20:23], s2 offen lds
  s_add_u32 m0, s60, 65536
  s_add_u32 s2, s0, 1048576
  buffer_load_dwordx4 v20, s[16:19], s2 offen lds
  s_add_u32 m0, s60, 69632
  s_add_u32 s2, s0, 1179648
  buffer_load_dwordx4 v20, s[16:19], s2 offen lds
  s_add_u32 m0, s60, 73728
  s_add_u32 s2, s0, 1310720
  buffer_load_dwordx4 v20, s[16:19], s2 offen lds
  s_add_u32 m0, s60, 77824
  s_add_u32 s2, s0, 1441792
  buffer_load_dwordx4 v20, s[16:19], s2 offen lds
  s_add_u32 m0, s60, 81920
  s_add_u32 s2, s0, 1048576
  buffer_load_dwordx4 v20, s[20:23], s2 offen lds
  s_add_u32 m0, s60, 86016
  s_add_u32 s2, s0, 1179648
  buffer_load_dwordx4 v20, s[20:23], s2 offen lds
  s_add_u32 m0, s60, 90112
  s_add_u32 s2, s0, 1310720
  buffer_load_dwordx4 v20, s[20:23], s2 offen lds
  s_add_u32 m0, s60, 94208
  s_add_u32 s2, s0, 1441792
  buffer_load_dwordx4 v20, s[20:23], s2 offen lds
  s_add_u32 m0, s60, 98304
  s_add_u32 s2, s0, 1572864
  buffer_load_dwordx4 v20, s[16:19], s2 offen lds
  s_add_u32 m0, s60, 102400
  s_add_u32 s2, s0, 1703936
  buffer_load_dwordx4 v20, s[16:19], s2 offen lds
  s_add_u32 m0, s60, 106496
  s_add_u32 s2, s0, 1835008
  buffer_load_dwordx4 v20, s[16:19], s2 offen lds
  s_add_u32 m0, s60, 110592
  s_add_u32 s2, s0, 1966080
  buffer_load_dwordx4 v20, s[16:19], s2 offen lds
  s_add_u32 m0, s60, 114688
  s_add_u32 s2, s0, 1572864
  buffer_load_dwordx4 v20, s[20:23], s2 offen lds
  s_add_u32 m0, s60, 118784
  s_add_u32 s2, s0, 1703936
  buffer_load_dwordx4 v20, s[20:23], s2 offen lds
  s_add_u32 m0, s60, 122880
  s_add_u32 s2, s0, 1835008
  buffer_load_dwordx4 v20, s[20:23], s2 offen lds
  s_add_u32 m0, s60, 126976
  s_add_u32 s2, s0, 1966080
  buffer_load_dwordx4 v20, s[20:23], s2 offen lds
  s_waitcnt vmcnt(28) lgkmcnt(0)
  s_barrier
  s_cmp_lg_u32 s44, 0
  s_cbranch_scc1 L_si_13
  s_mov_b64 exec, 1
  v_mov_b32 v18, 1
  buffer_atomic_add v18, v3, s[36:39], 0 offen offset:40
  s_mov_b64 exec, -1
L_si_13:
  ds_read_b64_tr_b16 v[32:33], v23 offset:0
  ds_read_b64_tr_b16 v[34:35], v23 offset:512
  ds_read_b64_tr_b16 v[36:37], v23 offset:8192
  ds_read_b64_tr_b16 v[38:39], v23 offset:8704
  ds_read_b64_tr_b16 v[40:41], v24 offset:0
  ds_read_b64_tr_b16 v[42:43], v24 offset:512
  ds_read_b64_tr_b16 v[44:45], v24 offset:8192
  ds_read_b64_tr_b16 v[46:47], v24 offset:8704
  s_waitcnt vmcnt(24) lgkmcnt(0)
  s_barrier
  s_add_u32 m0, s60, 0
  s_add_u32 s2, s0, 2097152
  buffer_load_dwordx4 v20, s[16:19], s2 offen lds
  s_add_u32 m0, s60, 4096
  s_add_u32 s2, s0, 2228224
  buffer_load_dwordx4 v20, s[16:19], s2 offen lds
  s_add_u32 m0, s60, 8192
  s_add_u32 s2, s0, 2359296
  buffer_load_dwordx4 v20, s[16:19], s2 offen lds
  s_add_u32 m0, s60, 12288
  s_add_u32 s2, s0, 2490368
  buffer_load_dwordx4 v20, s[16:19], s2 offen lds
  ds_read_b64_tr_b16 v[48:49], v23 offset:16384
  ds_read_b64_tr_b16 v[50:51], v23 offset:16896
  ds_read_b64_tr_b16 v[52:53], v23 offset:24576
  ds_read_b64_tr_b16 v[54:55], v23 offset:25088
  ds_read_b64_tr_b16 v[56:57], v24 offset:16384
  ds_read_b64_tr_b16 v[58:59], v24 offset:16896
  ds_read_b64_tr_b16 v[60:61], v24 offset:24576
  ds_read_b64_tr_b16 v[62:63], v24 offset:25088
  s_waitcnt vmcnt(24) lgkmcnt(0)
  s_barrier
  s_add_u32 m0, s60, 16384
  s_add_u32 s2, s0, 2097152
  buffer_load_dwordx4 v20, s[20:23], s2 offen lds
  s_add_u32 m0, s60, 20480
  s_add_u32 s2, s0, 2228224
  buffer_load_dwordx4 v20, s[20:23], s2 offen lds
  s_add_u32 m0, s60, 24576
  s_add_u32 s2, s0, 2359296
  buffer_load_dwordx4 v20, s[20:23], s2 offen lds
  s_add_u32 m0, s60, 28672
  s_add_u32 s2, s0, 2490368
  buffer_load_dwordx4 v20, s[20:23], s2 offen lds
  ds_read_b64_tr_b16 a[0:1], v23 offset:32768
  ds_read_b64_tr_b16 a[2:3], v23 offset:33280
  ds_read_b64_tr_b16 a[4:5], v23 offset:40960
  ds_read_b64_tr_b16 a[6:7], v23 offset:41472
  ds_read_b64_tr_b16 a[8:9], v24 offset:32768
  ds_read_b64_tr_b16 a[10:11], v24 offset:33280
  ds_read_b64_tr_b16 a[12:13], v24 offset:40960
  ds_read_b64_tr_b16 a[14:15], v24 offset:41472
  s_waitcnt vmcnt(24) lgkmcnt(0)
  s_barrier
  s_add_u32 m0, s60, 32768
  s_add_u32 s2, s0, 2621440
  buffer_load_dwordx4 v20, s[16:19], s2 offen lds
  s_add_u32 m0, s60, 36864
  s_add_u32 s2, s0, 2752512
  buffer_load_dwordx4 v20, s[16:19], s2 offen lds
  s_add_u32 m0, s60, 40960
  s_add_u32 s2, s0, 2883584
  buffer_load_dwordx4 v20, s[16:19], s2 offen lds
  s_add_u32 m0, s60, 45056
  s_add_u32 s2, s0, 3014656
  buffer_load_dwordx4 v20, s[16:19], s2 offen lds
  ds_read_b64_tr_b16 a[16:17], v23 offset:49152
  ds_read_b64_tr_b16 a[18:19], v23 offset:49664
  ds_read_b64_tr_b16 a[20:21], v23 offset:57344
  ds_read_b64_tr_b16 a[22:23], v23 offset:57856
  ds_read_b64_tr_b16 a[24:25], v24 offset:49152
  ds_read_b64_tr_b16 a[26:27], v24 offset:49664
  ds_read_b64_tr_b16 a[28:29], v24 offset:57344
  ds_read_b64_tr_b16 a[30:31], v24 offset:57856
  s_waitcnt vmcnt(24) lgkmcnt(0)
  s_barrier
  s_add_u32 m0, s60, 49152
  s_add_u32 s2, s0, 2621440
  buffer_load_dwordx4 v20, s[20:23], s2 offen lds
  s_add_u32 m0, s60, 53248
  s_add_u32 s2, s0, 2752512
  buffer_load_dwordx4 v20, s[20:23], s2 offen lds
  s_add_u32 m0, s60, 57344
  s_add_u32 s2, s0, 2883584
  buffer_load_dwordx4 v20, s[20:23], s2 offen lds
  s_add_u32 m0, s60, 61440
  s_add_u32 s2, s0, 3014656
  buffer_load_dwordx4 v20, s[20:23], s2 offen lds
  ds_read_b64_tr_b16 a[32:33], v26 offset:0
  ds_read_b64_tr_b16 a[34:35], v26 offset:512
  ds_read_b64_tr_b16 a[36:37], v26 offset:8192
  ds_read_b64_tr_b16 a[38:39], v26 offset:8704
  ds_read_b64_tr_b16 a[40:41], v27 offset:0
  ds_read_b64_tr_b16 a[42:43], v27 offset:512
  ds_read_b64_tr_b16 a[44:45], v27 offset:8192
  ds_read_b64_tr_b16 a[46:47], v27 offset:8704
  s_waitcnt vmcnt(24) lgkmcnt(0)
  s_barrier
  s_add_u32 m0, s60, 65536
  s_add_u32 s2, s0, 3145728
  buffer_load_dwordx4 v20, s[16:19], s2 offen lds
  s_add_u32 m0, s60, 69632
  s_add_u32 s2, s0, 3276800
  buffer_load_dwordx4 v20, s[16:19], s2 offen lds
  s_add_u32 m0, s60, 73728
  s_add_u32 s2, s0, 3407872
  buffer_load_dwordx4 v20, s[16:19], s2 offen lds
  s_add_u32 m0, s60, 77824
  s_add_u32 s2, s0, 3538944
  buffer_load_dwordx4 v20, s[16:19], s2 offen lds
  ds_read_b64_tr_b16 a[48:49], v26 offset:16384
  ds_read_b64_tr_b16 a[50:51], v26 offset:16896
  ds_read_b64_tr_b16 a[52:53], v26 offset:24576
  ds_read_b64_tr_b16 a[54:55], v26 offset:25088
  ds_read_b64_tr_b16 a[56:57], v27 offset:16384
  ds_read_b64_tr_b16 a[58:59], v27 offset:16896
  ds_read_b64_tr_b16 a[60:61], v27 offset:24576
  ds_read_b64_tr_b16 a[62:63], v27 offset:25088
  s_waitcnt vmcnt(24) lgkmcnt(0)
  s_barrier
  s_add_u32 m0, s60, 81920
  s_add_u32 s2, s0, 3145728
  buffer_load_dwordx4 v20, s[20:23], s2 offen lds
  s_add_u32 m0, s60, 86016
  s_add_u32 s2, s0, 3276800
  buffer_load_dwordx4 v20, s[20:23], s2 offen lds
  s_add_u32 m0, s60, 90112
  s_add_u32 s2, s0, 3407872
  buffer_load_dwordx4 v20, s[20:23], s2 offen lds
  s_add_u32 m0, s60, 94208
  s_add_u32 s2, s0, 3538944
  buffer_load_dwordx4 v20, s[20:23], s2 offen lds
  ds_read_b64_tr_b16 a[64:65], v26 offset:32768
  ds_read_b64_tr_b16 a[66:67], v26 offset:33280
  ds_read_b64_tr_b16 a[68:69], v26 offset:40960
  ds_read_b64_tr_b16 a[70:71], v26 offset:41472
  ds_read_b64_tr_b16 a[72:73], v27 offset:32768
  ds_read_b64_tr_b16 a[74:75], v27 offset:33280
  ds_read_b64_tr_b16 a[76:77], v27 offset:40960
  ds_read_b64_tr_b16 a[78:79], v27 offset:41472
  s_waitcnt vmcnt(24) lgkmcnt(0)
  s_barrier
  s_add_u32 m0, s60, 98304
  s_add_u32 s2, s0, 3670016
  buffer_load_dwordx4 v20, s[16:19], s2 offen lds
  s_add_u32 m0, s60, 102400
  s_add_u32 s2, s0, 3801088
  buffer_load_dwordx4 v20, s[16:19], s2 offen lds
  s_add_u32 m0, s60, 106496
  s_add_u32 s2, s0, 3932160
  buffer_load_dwordx4 v20, s[16:19], s2 offen lds
  s_add_u32 m0, s60, 110592
  s_add_u32 s2, s0, 4063232
  buffer_load_dwordx4 v20, s[16:19], s2 offen lds
  ds_read_b64_tr_b16 a[80:81], v26 offset:49152
  ds_read_b64_tr_b16 a[82:83], v26 offset:49664
  ds_read_b64_tr_b16 a[84:85], v26 offset:57344
  ds_read_b64_tr_b16 a[86:87], v26 offset:57856
  ds_read_b64_tr_b16 a[88:89], v27 offset:49152
  ds_read_b64_tr_b16 a[90:91], v27 offset:49664
  ds_read_b64_tr_b16 a[92:93], v27 offset:57344
  ds_read_b64_tr_b16 a[94:95], v27 offset:57856
  s_waitcnt vmcnt(24) lgkmcnt(0)
  s_barrier
  s_add_u32 m0, s60, 114688
  s_add_u32 s2, s0, 3670016
  buffer_load_dwordx4 v20, s[20:23], s2 offen lds
  s_add_u32 m0, s60, 118784
  s_add_u32 s2, s0, 3801088
  buffer_load_dwordx4 v20, s[20:23], s2 offen lds
  s_add_u32 m0, s60, 122880
  s_add_u32 s2, s0, 3932160
  buffer_load_dwordx4 v20, s[20:23], s2 offen lds
  s_add_u32 m0, s60, 126976
  s_add_u32 s2, s0, 4063232
  buffer_load_dwordx4 v20, s[20:23], s2 offen lds
  ds_read_b64_tr_b16 a[96:97], v23 offset:0
  ds_read_b64_tr_b16 a[98:99], v23 offset:512
  ds_read_b64_tr_b16 a[100:101], v23 offset:8192
  ds_read_b64_tr_b16 a[102:103], v23 offset:8704
  ds_read_b64_tr_b16 a[104:105], v24 offset:0
  ds_read_b64_tr_b16 a[106:107], v24 offset:512
  ds_read_b64_tr_b16 a[108:109], v24 offset:8192
  ds_read_b64_tr_b16 a[110:111], v24 offset:8704
  s_waitcnt vmcnt(24) lgkmcnt(0)
  s_barrier
  s_add_u32 m0, s60, 0
  s_add_u32 s2, s0, 4194304
  buffer_load_dwordx4 v20, s[16:19], s2 offen lds
  s_add_u32 m0, s60, 4096
  s_add_u32 s2, s0, 4325376
  buffer_load_dwordx4 v20, s[16:19], s2 offen lds
  s_add_u32 m0, s60, 8192
  s_add_u32 s2, s0, 4456448
  buffer_load_dwordx4 v20, s[16:19], s2 offen lds
  s_add_u32 m0, s60, 12288
  s_add_u32 s2, s0, 4587520
  buffer_load_dwordx4 v20, s[16:19], s2 offen lds
  ds_read_b64_tr_b16 a[112:113], v23 offset:16384
  ds_read_b64_tr_b16 a[114:115], v23 offset:16896
  ds_read_b64_tr_b16 a[116:117], v23 offset:24576
  ds_read_b64_tr_b16 a[118:119], v23 offset:25088
  ds_read_b64_tr_b16 a[120:121], v24 offset:16384
  ds_read_b64_tr_b16 a[122:123], v24 offset:16896
  ds_read_b64_tr_b16 a[124:125], v24 offset:24576
  ds_read_b64_tr_b16 a[126:127], v24 offset:25088
  s_waitcnt vmcnt(24) lgkmcnt(0)
  s_barrier
  buffer_load_dword v10, v3, s[36:39], 0 offen sc1
  buffer_load_dwordx4 v[12:15], v3, s[36:39], 0 offen offset:32 sc1
  v_mov_b32 v16, 0
  s_mov_b32 s94, 0
  s_add_u32 m0, s60, 16384
  s_add_u32 s2, s0, 4194304
  buffer_load_dwordx4 v20, s[20:23], s2 offen lds
  s_add_u32 m0, s60, 20480
  s_add_u32 s2, s0, 4325376
  buffer_load_dwordx4 v20, s[20:23], s2 offen lds
  s_add_u32 m0, s60, 24576
  s_add_u32 s2, s0, 4456448
  buffer_load_dwordx4 v20, s[20:23], s2 offen lds
  s_add_u32 m0, s60, 28672
  s_add_u32 s2, s0, 4587520
  buffer_load_dwordx4 v20, s[20:23], s2 offen lds
  ds_read_b64_tr_b16 v[64:65], v23 offset:32768
  ds_read_b64_tr_b16 v[66:67], v23 offset:33280
  ds_read_b64_tr_b16 v[68:69], v23 offset:40960
  ds_read_b64_tr_b16 v[70:71], v23 offset:41472
  ds_read_b64_tr_b16 v[72:73], v24 offset:32768
  ds_read_b64_tr_b16 v[74:75], v24 offset:33280
  ds_read_b64_tr_b16 v[76:77], v24 offset:40960
  ds_read_b64_tr_b16 v[78:79], v24 offset:41472
  s_waitcnt vmcnt(24) lgkmcnt(0)
  s_barrier
  s_add_u32 m0, s60, 32768
  s_add_u32 s2, s0, 4718592
  buffer_load_dwordx4 v20, s[16:19], s2 offen lds
  s_add_u32 m0, s60, 36864
  s_add_u32 s2, s0, 4849664
  buffer_load_dwordx4 v20, s[16:19], s2 offen lds
  s_add_u32 m0, s60, 40960
  s_add_u32 s2, s0, 4980736
  buffer_load_dwordx4 v20, s[16:19], s2 offen lds
  s_add_u32 m0, s60, 45056
  s_add_u32 s2, s0, 5111808
  buffer_load_dwordx4 v20, s[16:19], s2 offen lds
  ds_read_b64_tr_b16 v[80:81], v23 offset:49152
  ds_read_b64_tr_b16 v[82:83], v23 offset:49664
  ds_read_b64_tr_b16 v[84:85], v23 offset:57344
  ds_read_b64_tr_b16 v[86:87], v23 offset:57856
  ds_read_b64_tr_b16 v[88:89], v24 offset:49152
  ds_read_b64_tr_b16 v[90:91], v24 offset:49664
  ds_read_b64_tr_b16 v[92:93], v24 offset:57344
  ds_read_b64_tr_b16 v[94:95], v24 offset:57856
  s_waitcnt vmcnt(24) lgkmcnt(0)
  s_barrier
  s_add_u32 m0, s60, 49152
  s_add_u32 s2, s0, 4718592
  buffer_load_dwordx4 v20, s[20:23], s2 offen lds
  s_add_u32 m0, s60, 53248
  s_add_u32 s2, s0, 4849664
  buffer_load_dwordx4 v20, s[20:23], s2 offen lds
  s_add_u32 m0, s60, 57344
  s_add_u32 s2, s0, 4980736
  buffer_load_dwordx4 v20, s[20:23], s2 offen lds
  s_add_u32 m0, s60, 61440
  s_add_u32 s2, s0, 5111808
  buffer_load_dwordx4 v20, s[20:23], s2 offen lds
  ds_read_b64_tr_b16 a[128:129], v26 offset:0
  ds_read_b64_tr_b16 a[130:131], v26 offset:512
  ds_read_b64_tr_b16 a[132:133], v26 offset:8192
  ds_read_b64_tr_b16 a[134:135], v26 offset:8704
  ds_read_b64_tr_b16 a[136:137], v27 offset:0
  ds_read_b64_tr_b16 a[138:139], v27 offset:512
  ds_read_b64_tr_b16 a[140:141], v27 offset:8192
  ds_read_b64_tr_b16 a[142:143], v27 offset:8704
  s_waitcnt vmcnt(24) lgkmcnt(0)
  s_barrier
  s_add_u32 m0, s60, 65536
  s_add_u32 s2, s1, 0
  buffer_load_dwordx4 v21, s[28:31], s2 offen lds
  s_add_u32 m0, s60, 69632
  s_add_u32 s2, s1, 20480
  buffer_load_dwordx4 v22, s[28:31], s2 offen lds
  s_add_u32 m0, s60, 73728
  s_add_u32 s2, s1, 40960
  buffer_load_dwordx4 v21, s[28:31], s2 offen lds
  s_add_u32 m0, s60, 77824
  s_add_u32 s2, s1, 61440
  buffer_load_dwordx4 v22, s[28:31], s2 offen lds
  ds_read_b64_tr_b16 a[144:145], v26 offset:16384
  ds_read_b64_tr_b16 a[146:147], v26 offset:16896
  ds_read_b64_tr_b16 a[148:149], v26 offset:24576
  ds_read_b64_tr_b16 a[150:151], v26 offset:25088
  ds_read_b64_tr_b16 a[152:153], v27 offset:16384
  ds_read_b64_tr_b16 a[154:155], v27 offset:16896
  ds_read_b64_tr_b16 a[156:157], v27 offset:24576
  ds_read_b64_tr_b16 a[158:159], v27 offset:25088
  s_waitcnt vmcnt(24) lgkmcnt(0)
  s_barrier
  s_add_u32 m0, s60, 81920
  s_add_u32 s2, s1, 81920
  buffer_load_dwordx4 v21, s[28:31], s2 offen lds
  s_add_u32 m0, s60, 86016
  s_add_u32 s2, s1, 102400
  buffer_load_dwordx4 v22, s[28:31], s2 offen lds
  s_add_u32 m0, s60, 90112
  s_add_u32 s2, s1, 122880
  buffer_load_dwordx4 v21, s[28:31], s2 offen lds
  s_add_u32 m0, s60, 94208
  s_add_u32 s2, s1, 143360
  buffer_load_dwordx4 v22, s[28:31], s2 offen lds
  ds_read_b64_tr_b16 a[160:161], v26 offset:32768
  ds_read_b64_tr_b16 a[162:163], v26 offset:33280
  ds_read_b64_tr_b16 a[164:165], v26 offset:40960
  ds_read_b64_tr_b16 a[166:167], v26 offset:41472
  ds_read_b64_tr_b16 a[168:169], v27 offset:32768
  ds_read_b64_tr_b16 a[170:171], v27 offset:33280
  ds_read_b64_tr_b16 a[172:173], v27 offset:40960
  ds_read_b64_tr_b16 a[174:175], v27 offset:41472
  s_waitcnt vmcnt(24) lgkmcnt(0)
  s_barrier
  s_add_u32 m0, s60, 98304
  s_add_u32 s2, s1, 256
  buffer_load_dwordx4 v21, s[28:31], s2 offen lds
  s_add_u32 m0, s60, 102400
  s_add_u32 s2, s1, 20736
  buffer_load_dwordx4 v22, s[28:31], s2 offen lds
  s_add_u32 m0, s60, 106496
  s_add_u32 s2, s1, 41216
  buffer_load_dwordx4 v21, s[28:31], s2 offen lds
  s_add_u32 m0, s60, 110592
  s_add_u32 s2, s1, 61696
  buffer_load_dwordx4 v22, s[28:31], s2 offen lds
  ds_read_b64_tr_b16 a[176:177], v26 offset:49152
  ds_read_b64_tr_b16 a[178:179], v26 offset:49664
  ds_read_b64_tr_b16 a[180:181], v26 offset:57344
  ds_read_b64_tr_b16 a[182:183], v26 offset:57856
  ds_read_b64_tr_b16 a[184:185], v27 offset:49152
  ds_read_b64_tr_b16 a[186:187], v27 offset:49664
  ds_read_b64_tr_b16 a[188:189], v27 offset:57344
  ds_read_b64_tr_b16 a[190:191], v27 offset:57856
  s_waitcnt vmcnt(24) lgkmcnt(0)
  s_barrier
  s_add_u32 m0, s60, 114688
  s_add_u32 s2, s1, 82176
  buffer_load_dwordx4 v21, s[28:31], s2 offen lds
  s_add_u32 m0, s60, 118784
  s_add_u32 s2, s1, 102656
  buffer_load_dwordx4 v22, s[28:31], s2 offen lds
  s_add_u32 m0, s60, 122880
  s_add_u32 s2, s1, 123136
  buffer_load_dwordx4 v21, s[28:31], s2 offen lds
  s_add_u32 m0, s60, 126976
  s_add_u32 s2, s1, 143616
  buffer_load_dwordx4 v22, s[28:31], s2 offen lds
  ds_read_b64_tr_b16 v[96:97], v23 offset:0
  ds_read_b64_tr_b16 v[98:99], v23 offset:512
  ds_read_b64_tr_b16 v[100:101], v23 offset:8192
  ds_read_b64_tr_b16 v[102:103], v23 offset:8704
  ds_read_b64_tr_b16 v[104:105], v24 offset:0
  ds_read_b64_tr_b16 v[106:107], v24 offset:512
  ds_read_b64_tr_b16 v[108:109], v24 offset:8192
  ds_read_b64_tr_b16 v[110:111], v24 offset:8704
  s_waitcnt vmcnt(24) lgkmcnt(0)
  s_barrier
  s_add_u32 m0, s60, 0
  s_add_u32 s2, s1, 512
  buffer_load_dwordx4 v21, s[28:31], s2 offen lds
  s_add_u32 m0, s60, 4096
  s_add_u32 s2, s1, 20992
  buffer_load_dwordx4 v22, s[28:31], s2 offen lds
  s_add_u32 m0, s60, 8192
  s_add_u32 s2, s1, 41472
  buffer_load_dwordx4 v21, s[28:31], s2 offen lds
  s_add_u32 m0, s60, 12288
  s_add_u32 s2, s1, 61952
  buffer_load_dwordx4 v22, s[28:31], s2 offen lds
  ds_read_b64_tr_b16 v[112:113], v23 offset:16384
  ds_read_b64_tr_b16 v[114:115], v23 offset:16896
  ds_read_b64_tr_b16 v[116:117], v23 offset:24576
  ds_read_b64_tr_b16 v[118:119], v23 offset:25088
  ds_read_b64_tr_b16 v[120:121], v24 offset:16384
  ds_read_b64_tr_b16 v[122:123], v24 offset:16896
  ds_read_b64_tr_b16 v[124:125], v24 offset:24576
  ds_read_b64_tr_b16 v[126:127], v24 offset:25088
  s_waitcnt vmcnt(24) lgkmcnt(0)
  s_barrier
  s_add_u32 m0, s60, 16384
  s_add_u32 s2, s1, 82432
  buffer_load_dwordx4 v21, s[28:31], s2 offen lds
  s_add_u32 m0, s60, 20480
  s_add_u32 s2, s1, 102912
  buffer_load_dwordx4 v22, s[28:31], s2 offen lds
  s_add_u32 m0, s60, 24576
  s_add_u32 s2, s1, 123392
  buffer_load_dwordx4 v21, s[28:31], s2 offen lds
  s_add_u32 m0, s60, 28672
  s_add_u32 s2, s1, 143872
  buffer_load_dwordx4 v22, s[28:31], s2 offen lds
  ds_read_b64_tr_b16 a[192:193], v23 offset:32768
  ds_read_b64_tr_b16 a[194:195], v23 offset:33280
  ds_read_b64_tr_b16 a[196:197], v23 offset:40960
  ds_read_b64_tr_b16 a[198:199], v23 offset:41472
  ds_read_b64_tr_b16 a[200:201], v24 offset:32768
  ds_read_b64_tr_b16 a[202:203], v24 offset:33280
  ds_read_b64_tr_b16 a[204:205], v24 offset:40960
  ds_read_b64_tr_b16 a[206:207], v24 offset:41472
  s_waitcnt vmcnt(24) lgkmcnt(0)
  s_barrier
  v_cmp_gt_u32 vcc, 64, v14
  s_cbranch_vccnz L_h2_14
  s_lshl_b32 s46, s48, 4
  s_add_u32 s46, s46, 78725120
  buffer_load_dword v16, v3, s[40:43], s46 offen sc1
L_h2_14:
  s_add_u32 m0, s60, 32768
  s_add_u32 s2, s1, 768
  buffer_load_dwordx4 v21, s[28:31], s2 offen lds
  s_add_u32 m0, s60, 36864
  s_add_u32 s2, s1, 21248
  buffer_load_dwordx4 v22, s[28:31], s2 offen lds
  s_add_u32 m0, s60, 40960
  s_add_u32 s2, s1, 41728
  buffer_load_dwordx4 v21, s[28:31], s2 offen lds
  s_add_u32 m0, s60, 45056
  s_add_u32 s2, s1, 62208
  buffer_load_dwordx4 v22, s[28:31], s2 offen lds
  ds_read_b64_tr_b16 a[208:209], v23 offset:49152
  ds_read_b64_tr_b16 a[210:211], v23 offset:49664
  ds_read_b64_tr_b16 a[212:213], v23 offset:57344
  ds_read_b64_tr_b16 a[214:215], v23 offset:57856
  ds_read_b64_tr_b16 a[216:217], v24 offset:49152
  ds_read_b64_tr_b16 a[218:219], v24 offset:49664
  ds_read_b64_tr_b16 a[220:221], v24 offset:57344
  ds_read_b64_tr_b16 a[222:223], v24 offset:57856
  s_waitcnt vmcnt(24) lgkmcnt(0)
  s_barrier
  s_add_u32 m0, s60, 49152
  s_add_u32 s2, s1, 82688
  buffer_load_dwordx4 v21, s[28:31], s2 offen lds
  s_add_u32 m0, s60, 53248
  s_add_u32 s2, s1, 103168
  buffer_load_dwordx4 v22, s[28:31], s2 offen lds
  s_add_u32 m0, s60, 57344
  s_add_u32 s2, s1, 123648
  buffer_load_dwordx4 v21, s[28:31], s2 offen lds
  s_add_u32 m0, s60, 61440
  s_add_u32 s2, s1, 144128
  buffer_load_dwordx4 v22, s[28:31], s2 offen lds
  ds_read_b64_tr_b16 a[224:225], v28 offset:0
  ds_read_b64_tr_b16 a[226:227], v28 offset:512
  ds_read_b64_tr_b16 a[228:229], v28 offset:2048
  ds_read_b64_tr_b16 a[230:231], v28 offset:2560
  ds_read_b64_tr_b16 a[232:233], v28 offset:8192
  ds_read_b64_tr_b16 a[234:235], v28 offset:8704
  ds_read_b64_tr_b16 a[236:237], v28 offset:10240
  ds_read_b64_tr_b16 a[238:239], v28 offset:10752
  s_waitcnt vmcnt(24) lgkmcnt(0)
  s_barrier
  s_add_u32 m0, s60, 65536
  s_add_u32 s2, s1, 1024
  buffer_load_dwordx4 v21, s[28:31], s2 offen lds
  s_add_u32 m0, s60, 69632
  s_add_u32 s2, s1, 21504
  buffer_load_dwordx4 v22, s[28:31], s2 offen lds
  s_add_u32 m0, s60, 73728
  s_add_u32 s2, s1, 41984
  buffer_load_dwordx4 v21, s[28:31], s2 offen lds
  s_add_u32 m0, s60, 77824
  s_add_u32 s2, s1, 62464
  buffer_load_dwordx4 v22, s[28:31], s2 offen lds
  ds_read_b64_tr_b16 a[240:241], v28 offset:16384
  ds_read_b64_tr_b16 a[242:243], v28 offset:16896
  ds_read_b64_tr_b16 a[244:245], v28 offset:18432
  ds_read_b64_tr_b16 a[246:247], v28 offset:18944
  ds_read_b64_tr_b16 a[248:249], v28 offset:24576
  ds_read_b64_tr_b16 a[250:251], v28 offset:25088
  ds_read_b64_tr_b16 a[252:253], v28 offset:26624
  ds_read_b64_tr_b16 a[254:255], v28 offset:27136
  s_waitcnt vmcnt(24) lgkmcnt(0)
  s_barrier
  s_add_u32 m0, s60, 81920
  s_add_u32 s2, s1, 82944
  buffer_load_dwordx4 v21, s[28:31], s2 offen lds
  s_add_u32 m0, s60, 86016
  s_add_u32 s2, s1, 103424
  buffer_load_dwordx4 v22, s[28:31], s2 offen lds
  s_add_u32 m0, s60, 90112
  s_add_u32 s2, s1, 123904
  buffer_load_dwordx4 v21, s[28:31], s2 offen lds
  s_add_u32 m0, s60, 94208
  s_add_u32 s2, s1, 144384
  buffer_load_dwordx4 v22, s[28:31], s2 offen lds
  ds_read_b64_tr_b16 v[128:129], v28 offset:32768
  ds_read_b64_tr_b16 v[130:131], v28 offset:33280
  ds_read_b64_tr_b16 v[132:133], v28 offset:34816
  ds_read_b64_tr_b16 v[134:135], v28 offset:35328
  ds_read_b64_tr_b16 v[136:137], v28 offset:40960
  ds_read_b64_tr_b16 v[138:139], v28 offset:41472
  ds_read_b64_tr_b16 v[140:141], v28 offset:43008
  ds_read_b64_tr_b16 v[142:143], v28 offset:43520
  s_waitcnt vmcnt(24) lgkmcnt(0)
  s_barrier
  ds_read_b64_tr_b16 v[144:145], v28 offset:49152
  ds_read_b64_tr_b16 v[146:147], v28 offset:49664
  ds_read_b64_tr_b16 v[148:149], v28 offset:51200
  ds_read_b64_tr_b16 v[150:151], v28 offset:51712
  ds_read_b64_tr_b16 v[152:153], v28 offset:57344
  ds_read_b64_tr_b16 v[154:155], v28 offset:57856
  ds_read_b64_tr_b16 v[156:157], v28 offset:59392
  ds_read_b64_tr_b16 v[158:159], v28 offset:59904
  s_waitcnt vmcnt(20) lgkmcnt(0)
  s_barrier
  ds_read_b64_tr_b16 v[160:161], v25 offset:0
  ds_read_b64_tr_b16 v[162:163], v25 offset:512
  ds_read_b64_tr_b16 v[164:165], v25 offset:2048
  ds_read_b64_tr_b16 v[166:167], v25 offset:2560
  ds_read_b64_tr_b16 v[168:169], v25 offset:8192
  ds_read_b64_tr_b16 v[170:171], v25 offset:8704
  ds_read_b64_tr_b16 v[172:173], v25 offset:10240
  ds_read_b64_tr_b16 v[174:175], v25 offset:10752
  s_waitcnt vmcnt(16) lgkmcnt(0)
  s_barrier
  ds_read_b64_tr_b16 v[176:177], v25 offset:16384
  ds_read_b64_tr_b16 v[178:179], v25 offset:16896
  ds_read_b64_tr_b16 v[180:181], v25 offset:18432
  ds_read_b64_tr_b16 v[182:183], v25 offset:18944
  ds_read_b64_tr_b16 v[184:185], v25 offset:24576
  ds_read_b64_tr_b16 v[186:187], v25 offset:25088
  ds_read_b64_tr_b16 v[188:189], v25 offset:26624
  ds_read_b64_tr_b16 v[190:191], v25 offset:27136
  s_waitcnt vmcnt(12) lgkmcnt(0)
  s_barrier
  ds_read_b64_tr_b16 v[192:193], v25 offset:32768
  ds_read_b64_tr_b16 v[194:195], v25 offset:33280
  ds_read_b64_tr_b16 v[196:197], v25 offset:34816
  ds_read_b64_tr_b16 v[198:199], v25 offset:35328
  ds_read_b64_tr_b16 v[200:201], v25 offset:40960
  ds_read_b64_tr_b16 v[202:203], v25 offset:41472
  ds_read_b64_tr_b16 v[204:205], v25 offset:43008
  ds_read_b64_tr_b16 v[206:207], v25 offset:43520
  s_waitcnt vmcnt(8) lgkmcnt(0)
  s_barrier
  ds_read_b64_tr_b16 v[208:209], v25 offset:49152
  ds_read_b64_tr_b16 v[210:211], v25 offset:49664
  ds_read_b64_tr_b16 v[212:213], v25 offset:51200
  ds_read_b64_tr_b16 v[214:215], v25 offset:51712
  ds_read_b64_tr_b16 v[216:217], v25 offset:57344
  ds_read_b64_tr_b16 v[218:219], v25 offset:57856
  ds_read_b64_tr_b16 v[220:221], v25 offset:59392
  ds_read_b64_tr_b16 v[222:223], v25 offset:59904
  s_waitcnt vmcnt(4) lgkmcnt(0)
  s_barrier
  v_cmp_eq_u32 vcc, 0, v16
  s_cbranch_vccnz L_h3_15
  s_lshl_b32 s53, s48, 14
  s_lshl_b32 s54, s44, 12
  s_add_u32 s53, s53, s54
  s_add_u32 m0, s54, 131072
  s_mov_b32 s94, 1
  buffer_load_dwordx4 v8, s[40:43], s53 offen offset:0 sc1 lds
  buffer_load_dwordx4 v8, s[40:43], s53 offen offset:1024 sc1 lds
  buffer_load_dwordx4 v8, s[40:43], s53 offen offset:2048 sc1 lds
  buffer_load_dwordx4 v8, s[40:43], s53 offen offset:3072 sc1 lds
L_h3_15:
  ds_read_b64_tr_b16 v[224:225], v28 offset:0
  ds_read_b64_tr_b16 v[226:227], v28 offset:512
  ds_read_b64_tr_b16 v[228:229], v28 offset:2048
  ds_read_b64_tr_b16 v[230:231], v28 offset:2560
  ds_read_b64_tr_b16 v[232:233], v28 offset:8192
  ds_read_b64_tr_b16 v[234:235], v28 offset:8704
  ds_read_b64_tr_b16 v[236:237], v28 offset:10240
  ds_read_b64_tr_b16 v[238:239], v28 offset:10752
  s_waitcnt vmcnt(0) lgkmcnt(0)
  s_barrier
  ds_read_b64_tr_b16 v[240:241], v28 offset:16384
  ds_read_b64_tr_b16 v[242:243], v28 offset:16896
  ds_read_b64_tr_b16 v[244:245], v28 offset:18432
  ds_read_b64_tr_b16 v[246:247], v28 offset:18944
  ds_read_b64_tr_b16 v[248:249], v28 offset:24576
  ds_read_b64_tr_b16 v[250:251], v28 offset:25088
  ds_read_b64_tr_b16 v[252:253], v28 offset:26624
  ds_read_b64_tr_b16 v[254:255], v28 offset:27136
  s_waitcnt lgkmcnt(0)
  v_readfirstlane_b32 s95, v10
  v_readfirstlane_b32 s62, v14
  v_readfirstlane_b32 s0, v15
  s_barrier
  s_mul_i32 s46, s44, 24576
  s_add_u32 s46, s46, 32768
  v_add_u32 v13, s46, v8
  ds_write_b128 v13, v[32:35] offset:0
  ds_write_b128 v13, v[36:39] offset:1024
  ds_write_b128 v13, v[40:43] offset:2048
  ds_write_b128 v13, v[44:47] offset:3072
  ds_write_b128 v13, v[48:51] offset:4096
  ds_write_b128 v13, v[52:55] offset:5120
  ds_write_b128 v13, v[56:59] offset:6144
  ds_write_b128 v13, v[60:63] offset:7168
  ds_write_b128 v13, v[64:67] offset:8192
  ds_write_b128 v13, v[68:71] offset:9216
  ds_write_b128 v13, v[72:75] offset:10240
  ds_write_b128 v13, v[76:79] offset:11264
  ds_write_b128 v13, v[80:83] offset:12288
  ds_write_b128 v13, v[84:87] offset:13312
  ds_write_b128 v13, v[88:91] offset:14336
  ds_write_b128 v13, v[92:95] offset:15360
  ds_write_b128 v13, v[96:99] offset:16384
  ds_write_b128 v13, v[100:103] offset:17408
  ds_write_b128 v13, v[104:107] offset:18432
  ds_write_b128 v13, v[108:111] offset:19456
  ds_write_b128 v13, v[112:115] offset:20480
  ds_write_b128 v13, v[116:119] offset:21504
  ds_write_b128 v13, v[120:123] offset:22528
  ds_write_b128 v13, v[124:127] offset:23552
  s_lshl_b32 s46, s44, 10
  v_lshlrev_b32 v10, 5, v4
  v_lshl_add_u32 v10, v5, 3, v10
  v_add_u32 v10, s46, v10
  v_add_u32 v10, 12288, v10
  v_lshl_add_u32 v11, v5, 2, v6
  v_lshlrev_b32 v11, 5, v11
  v_lshl_add_u32 v11, v7, 3, v11
  v_add_u32 v11, 12288, v11
  v_add_u32 v12, 131072, v8
  v_lshrrev_b32 v18, 1, v5
  v_and_b32 v19, 1, v5
  s_lshl_b32 s46, s44, 14
  s_lshl_b32 s53, s48, 8
  s_add_u32 s46, s46, s53
  v_lshlrev_b32 v14, 13, v18
  v_lshl_add_u32 v14, v4, 4, v14
  v_lshl_add_u32 v14, v19, 3, v14
  v_add_u32 v14, s46, v14
  v_mov_b32 v17, 0
  v_mov_b32 v20, 4261412864
  v_cmp_gt_u32 vcc, 2, v5
  s_nop 1
  v_cndmask_b32 v17, v17, v20, vcc
  v_mov_b32 v24, 0x3f803f80
  v_mov_b32 v25, 0x3f803f80
  v_mov_b32 v26, 0x3f803f80
  v_mov_b32 v27, 0x3f803f80
  s_mov_b32 s56, 1040356334
  s_mov_b32 s57, 3187839982
  s_mov_b32 s61, 0xfffffffe
  v_and_b32 v20, 7, v4
  v_mov_b32 v28, 0
  v_mov_b32 v21, 0x3f80
  v_cmp_eq_u32 vcc, 0, v4
  s_nop 1
  v_cndmask_b32 v28, v28, v21, vcc
  v_mov_b32 v21, 0x3f800000
  v_cmp_eq_u32 vcc, 1, v4
  s_nop 1
  v_cndmask_b32 v28, v28, v21, vcc
  v_mov_b32 v29, 0
  v_mov_b32 v21, 0x3f80
  v_cmp_eq_u32 vcc, 2, v4
  s_nop 1
  v_cndmask_b32 v29, v29, v21, vcc
  v_mov_b32 v21, 0x3f800000
  v_cmp_eq_u32 vcc, 3, v4
  s_nop 1
  v_cndmask_b32 v29, v29, v21, vcc
  v_mov_b32 v30, 0
  v_mov_b32 v21, 0x3f80
  v_cmp_eq_u32 vcc, 4, v4
  s_nop 1
  v_cndmask_b32 v30, v30, v21, vcc
  v_mov_b32 v21, 0x3f800000
  v_cmp_eq_u32 vcc, 5, v4
  s_nop 1
  v_cndmask_b32 v30, v30, v21, vcc
  v_mov_b32 v31, 0
  v_mov_b32 v21, 0x3f80
  v_cmp_eq_u32 vcc, 6, v4
  s_nop 1
  v_cndmask_b32 v31, v31, v21, vcc
  v_mov_b32 v21, 0x3f800000
  v_cmp_eq_u32 vcc, 7, v4
  s_nop 1
  v_cndmask_b32 v31, v31, v21, vcc
  s_lshl_b32 s46, s44, 5
  s_add_u32 s46, s46, s48
  s_add_u32 s53, s48, 8
  s_cmp_lt_u32 s46, 8
  s_cselect_b32 s53, s48, s53
  s_cmp_lt_u32 s46, 40
  s_cselect_b32 s46, s53, 39
  s_cselect_b32 s59, s46, -1
  s_cselect_b32 s96, 0x00ff00ff, 0
  s_mov_b32 s97, s96
  s_cmp_eq_u32 s44, 3
  s_cselect_b32 s98, 0xff00ff00, 0
  s_mov_b32 s99, s98
  s_cselect_b32 s100, 1, 0
  s_mov_b32 s101, 0
  s_min_u32 s46, s46, 39
  s_lshl_b32 s46, s46, 8
  v_lshlrev_b32 v15, 7, v18
  v_lshl_add_u32 v15, v20, 4, v15
  v_lshl_add_u32 v15, v19, 3, v15
  v_add_u32 v15, s46, v15
  s_lshl_b32 s46, s48, 11
  s_add_u32 s53, s46, 67108864
  v_lshl_add_u32 v0, v5, 3, v20
  v_lshlrev_b32 v0, 4, v0
  v_add_u32 v0, s53, v0
  s_min_u32 s46, s95, 32
  s_min_u32 s53, s62, 64
  s_add_u32 s46, s46, s53
  s_cmp_eq_u32 s46, 96
  s_cbranch_scc1 L_chain_fast
  s_mov_b32 s47, 262144
L_wdbg_16:
  buffer_load_dword v18, v3, s[36:39], 0 offen offset:40 sc1
  s_waitcnt vmcnt(0)
  s_sub_u32 s47, s47, 1
  s_cbranch_scc1 L_abort
  v_cmp_gt_u32 vcc, 64, v18
  s_cbranch_vccnz L_wdbg_16
  buffer_load_dword v18, v3, s[36:39], 0 offen offset:44 sc1
  s_waitcnt vmcnt(0)
  v_readfirstlane_b32 s0, v18
  s_mov_b32 s47, 262144
L_mode_17:
  buffer_load_dwordx4 v[32:35], v3, s[36:39], 0 offen sc1
  buffer_load_dwordx4 v[36:39], v3, s[36:39], 0 offen offset:16 sc1
  s_waitcnt vmcnt(0)
  s_sub_u32 s47, s47, 1
  s_cbranch_scc1 L_abort
  v_cmp_le_u32 vcc, 32, v32
  s_cbranch_vccnz L_chain_fast
  v_add3_u32 v18, v32, v33, v34
  v_add3_u32 v18, v18, v35, v36
  v_add3_u32 v18, v18, v37, v38
  v_add_u32 v18, v18, v39
  v_cmp_le_u32 vcc, 256, v18
  s_cbranch_vccz L_mode_17
  s_branch L_chain_slow
L_chain_fast:
  s_mov_b32 s49, 0
  s_mov_b32 s50, 0
  s_mov_b32 s51, 16384
  s_mov_b32 s52, 32768
  s_lshl_b32 s46, s59, 13
  s_add_u32 s88, s46, 75497472
  s_add_u32 s89, s88, 4096
  s_mov_b32 s3, 75497472
  s_mov_b32 s4, 75563008
  s_mov_b32 s5, 75628544
  s_mov_b32 s6, 75694080
  s_mov_b32 s7, 75759616
  v_mul_u32_u24 v18, 1280, v4
  v_lshl_add_u32 v18, v5, 3, v18
  s_lshl_b32 s46, s59, 5
  s_and_b32 s46, s46, 0x7ff
  s_mov_b64 exec, s[96:97]
  buffer_load_dwordx2 v[20:21], v18, s[12:15], s46 offen
  buffer_load_dwordx4 v[116:119], v18, s[12:15], s46 offen
  s_waitcnt vmcnt(0)
  v_min_u32 v20, s61, v20
  s_mov_b32 s53, 77660160
  s_cmp_ge_i32 s59, 32
  s_cselect_b32 s54, 17, 16
  s_cselect_b32 s55, 8192, 0
  s_lshr_b32 s91, s0, s54
  s_and_b32 s91, s91, 1
  s_lshl_b32 s91, s91, 13
  s_lshl_b32 s46, s54, 14
  s_add_u32 s91, s91, s46
  s_add_u32 s91, s91, 76546048
  s_sub_u32 s91, s91, s55
  buffer_store_dwordx2 v[20:21], v15, s[40:43], s53 offen
  s_mov_b32 s98, 0xff
  s_mov_b32 s99, 0xff
  s_cmp_eq_u32 s59, -1
  s_cselect_b32 s91, 0x20000000, s91
  s_mov_b64 exec, s[98:99]
  v_and_b32 v116, s61, v116
  buffer_store_dwordx4 v[116:119], v15, s[40:43], s91 offen sc1
  s_mov_b64 exec, s[96:97]
  s_mov_b64 exec, -1
  s_lshl_b32 s46, s44, 11
  s_add_u32 s46, s46, 2048
  v_add_u32 v19, s46, v8
  s_lshr_b32 s54, s48, 1
  s_lshr_b32 s93, s0, s54
  s_and_b32 s93, s93, 1
  s_lshl_b32 s93, s93, 13
  s_lshl_b32 s46, s54, 14
  s_add_u32 s93, s93, s46
  s_add_u32 s93, s93, 76546048
  s_and_b32 s46, s48, 1
  s_lshl_b32 s46, s46, 12
  s_add_u32 s93, s93, s46
  s_lshl_b32 s46, s44, 10
  s_add_u32 s93, s93, s46
  s_add_u32 s46, s46, 16384
  v_add_u32 v1, s46, v8
  v_and_b32 v4, 0x37f, v8
  s_lshl_b32 s63, s44, 11
  s_add_u32 s63, s63, 8192
  s_lshl_b32 s46, s48, 4
  s_add_u32 s46, s46, 78725120
  s_mov_b32 s92, s46
  s_cmp_eq_u32 s94, 1
  s_cbranch_scc1 L_pre_22
  s_mov_b32 s47, 262144
L_fs_23:
  buffer_load_dword v16, v3, s[40:43], s46 offen sc1
  s_waitcnt vmcnt(0)
  s_sub_u32 s47, s47, 1
  s_cbranch_scc1 L_abort
  v_cmp_eq_u32 vcc, 0, v16
  s_cbranch_vccnz L_fs_23
  s_mov_b32 s62, 0
  s_lshl_b32 s0, s62, 5
  s_add_u32 s0, s0, s48
  s_lshl_b32 s0, s0, 14
  s_lshl_b32 s1, s44, 12
  s_add_u32 s0, s0, s1
  s_lshl_b32 s46, s62, 14
  s_add_u32 s1, s1, s46
  s_add_u32 s1, s1, 131072
  s_mov_b32 m0, s1
  s_nop 0
  buffer_load_dwordx4 v8, s[40:43], s0 offen offset:0 sc1 lds
  buffer_load_dwordx4 v8, s[40:43], s0 offen offset:1024 sc1 lds
  buffer_load_dwordx4 v8, s[40:43], s0 offen offset:2048 sc1 lds
  buffer_load_dwordx4 v8, s[40:43], s0 offen offset:3072 sc1 lds
L_pre_22:
  buffer_load_dword v16, v3, s[40:43], s92 offen offset:4 sc1
  s_waitcnt vmcnt(0) lgkmcnt(0)
  s_barrier
  s_add_u32 s53, s50, 77660160
  s_add_u32 s54, s53, 0
  s_mov_b32 s47, 262144
  v_mov_b64 v[72:73], 0
  v_mov_b64 v[74:75], 0
  v_mov_b64 v[76:77], 0
  v_mov_b64 v[78:79], 0
  v_mov_b64 v[80:81], 0
  v_mov_b64 v[82:83], 0
  v_mov_b64 v[84:85], 0
  v_mov_b64 v[86:87], 0
  v_mov_b32 v120, v17
  v_mov_b32 v121, v17
  v_mov_b32 v122, v17
  v_mov_b32 v123, v17
  ds_read_b128 v[88:91], v13 offset:0
  ds_read_b128 v[92:95], v13 offset:1024
  ds_read_b128 v[96:99], v13 offset:2048
  ds_read_b128 v[100:103], v13 offset:3072
  ds_read_b128 v[104:107], v13 offset:4096
  ds_read_b128 v[108:111], v13 offset:5120
  ds_read_b128 v[112:115], v13 offset:6144
  ds_read_b128 v[116:119], v13 offset:7168
  buffer_load_dwordx4 v[48:51], v19, s[40:43], s54 offen sc1
  buffer_load_dwordx4 v[52:55], v19, s[40:43], s54 offen offset:1024 sc1
  buffer_load_dwordx4 v[32:35], v8, s[40:43], s53 offen sc1
  buffer_load_dwordx4 v[36:39], v8, s[40:43], s53 offen offset:1024 sc1
L_cstep_18:
  s_and_b32 s58, s49, 1
  v_mov_b32 v2, s58
  s_add_u32 s62, s49, 1
  s_min_u32 s62, s62, 62
  s_xor_b32 s2, s58, 1
  s_lshl_b32 s0, s62, 5
  s_add_u32 s0, s0, s48
  s_lshl_b32 s0, s0, 14
  s_lshl_b32 s1, s44, 12
  s_add_u32 s0, s0, s1
  s_lshl_b32 s46, s2, 14
  s_add_u32 s1, s1, s46
  s_add_u32 s1, s1, 131072
  s_mov_b32 m0, s1
  s_add_u32 s46, s49, 2
  s_min_u32 s46, s46, 63
  s_lshr_b32 s2, s46, 2
  s_lshl_b32 s2, s2, 5
  s_add_u32 s2, s2, s48
  s_lshl_b32 s2, s2, 2
  s_and_b32 s46, s46, 3
  s_add_u32 s2, s2, s46
  s_lshl_b32 s2, s2, 2
  s_add_u32 s2, s2, 78725120
  s_add_u32 s90, s51, 77660160
  s_add_u32 s92, s52, 77660160
  v_mov_b64 v[20:21], -1
  v_xor_b32 v0, 1, v2
  v_cmp_eq_u32 vcc, 0, v16
  s_cbranch_vccnz L_fslow_20
L_fok_21:
  buffer_load_dwordx4 v[56:59], v19, s[40:43], s54 offen sc1
  buffer_load_dwordx4 v[60:63], v19, s[40:43], s54 offen offset:1024 sc1
  buffer_load_dwordx4 v[64:67], v8, s[40:43], s53 offen sc1
  buffer_load_dwordx4 v[68:71], v8, s[40:43], s53 offen offset:1024 sc1
  s_waitcnt vmcnt(6)
  ds_write_b128 v19, v[48:51]
  ds_write_b128 v19, v[52:55] offset:1024
  v_max3_u32 v18, v48, v50, v52
  s_waitcnt vmcnt(4)
  v_max3_u32 v18, v18, v54, v32
  v_max3_u32 v18, v18, v34, v36
  v_max_u32 v18, v18, v38
  v_cmp_eq_u32 vcc, -1, v18
  s_cbranch_vccnz L_mp_24
L_mj_25:
  s_waitcnt lgkmcnt(2)
  v_smfmac_f32_16x16x64_bf16 v[72:75], v[32:35], v[88:95], v9
  v_smfmac_f32_16x16x64_bf16 v[80:83], v[32:35], v[104:111], v9
  v_smfmac_f32_16x16x64_bf16 v[76:79], v[32:35], v[96:103], v9
  v_smfmac_f32_16x16x64_bf16 v[84:87], v[32:35], v[112:119], v9
  s_waitcnt lgkmcnt(0)
  s_barrier
  ds_read_b128 v[40:43], v8 offset:2048
  ds_read_b128 v[44:47], v8 offset:3072
  v_smfmac_f32_16x16x64_bf16 v[72:75], v[36:39], a[0:7], v9
  s_waitcnt vmcnt(0)
  ds_read_b128 v[48:51], v8 offset:4096
  v_smfmac_f32_16x16x64_bf16 v[80:83], v[36:39], a[16:23], v9
  ds_read_b128 v[52:55], v8 offset:5120
  buffer_load_dwordx4 v8, s[40:43], s0 offen offset:0 sc1 lds
  v_smfmac_f32_16x16x64_bf16 v[76:79], v[36:39], a[8:15], v9
  ds_read_b128 v[56:59], v8 offset:6144
  buffer_load_dwordx4 v8, s[40:43], s0 offen offset:1024 sc1 lds
  v_smfmac_f32_16x16x64_bf16 v[84:87], v[36:39], a[24:31], v9
  ds_read_b128 v[60:63], v8 offset:7168
  buffer_load_dwordx4 v8, s[40:43], s0 offen offset:2048 sc1 lds
  s_waitcnt lgkmcnt(5)
  v_smfmac_f32_16x16x64_bf16 v[72:75], v[40:43], a[32:39], v9
  ds_read_b128 v[64:67], v8 offset:8192
  buffer_load_dwordx4 v8, s[40:43], s0 offen offset:3072 sc1 lds
  v_smfmac_f32_16x16x64_bf16 v[80:83], v[40:43], a[48:55], v9
  ds_read_b128 v[68:71], v8 offset:9216
  buffer_load_dword v16, v3, s[40:43], s2 offen sc1
  v_smfmac_f32_16x16x64_bf16 v[76:79], v[40:43], a[40:47], v9
  ds_read_b128 v[88:91], v13 offset:8192
  v_smfmac_f32_16x16x64_bf16 v[84:87], v[40:43], a[56:63], v9
  ds_read_b128 v[92:95], v13 offset:9216
  s_waitcnt lgkmcnt(8)
  v_smfmac_f32_16x16x64_bf16 v[72:75], v[44:47], a[64:71], v9
  ds_read_b128 v[104:107], v13 offset:12288
  v_smfmac_f32_16x16x64_bf16 v[80:83], v[44:47], a[80:87], v9
  ds_read_b128 v[108:111], v13 offset:13312
  v_smfmac_f32_16x16x64_bf16 v[76:79], v[44:47], a[72:79], v9
  ds_read_b128 v[96:99], v13 offset:10240
  v_smfmac_f32_16x16x64_bf16 v[84:87], v[44:47], a[88:95], v9
  ds_read_b128 v[100:103], v13 offset:11264
  s_waitcnt lgkmcnt(11)
  v_smfmac_f32_16x16x64_bf16 v[72:75], v[48:51], a[96:103], v9
  ds_read_b128 v[112:115], v13 offset:14336
  v_smfmac_f32_16x16x64_bf16 v[80:83], v[48:51], a[112:119], v9
  ds_read_b128 v[116:119], v13 offset:15360
  v_smfmac_f32_16x16x64_bf16 v[76:79], v[48:51], a[104:111], v9
  ds_read_b128 v[32:35], v12 offset:0
  v_smfmac_f32_16x16x64_bf16 v[84:87], v[48:51], a[120:127], v9
  ds_read_b128 v[36:39], v12 offset:1024
  s_waitcnt lgkmcnt(14)
  s_waitcnt lgkmcnt(8)
  v_smfmac_f32_16x16x64_bf16 v[72:75], v[52:55], v[88:95], v9
  ds_read_b128 v[40:43], v12 offset:2048
  s_waitcnt lgkmcnt(7)
  v_smfmac_f32_16x16x64_bf16 v[80:83], v[52:55], v[104:111], v9
  ds_read_b128 v[44:47], v12 offset:3072
  s_waitcnt lgkmcnt(6)
  v_smfmac_f32_16x16x64_bf16 v[76:79], v[52:55], v[96:103], v9
  ds_read_b128 v[48:51], v12 offset:4096
  s_waitcnt lgkmcnt(5)
  v_smfmac_f32_16x16x64_bf16 v[84:87], v[52:55], v[112:119], v9
  v_add_u32 v124, s63, v12
  v_smfmac_f32_16x16x64_bf16 v[72:75], v[56:59], a[128:135], v9
  ds_read_b128 v[88:91], v13 offset:16384
  v_smfmac_f32_16x16x64_bf16 v[80:83], v[56:59], a[144:151], v9
  ds_read_b128 v[92:95], v13 offset:17408
  v_smfmac_f32_16x16x64_bf16 v[76:79], v[56:59], a[136:143], v9
  ds_read_b128 v[104:107], v13 offset:20480
  v_smfmac_f32_16x16x64_bf16 v[84:87], v[56:59], a[152:159], v9
  ds_read_b128 v[108:111], v13 offset:21504
  v_smfmac_f32_16x16x64_bf16 v[72:75], v[60:63], a[160:167], v9
  ds_read_b128 v[96:99], v13 offset:18432
  v_smfmac_f32_16x16x64_bf16 v[80:83], v[60:63], a[176:183], v9
  ds_read_b128 v[100:103], v13 offset:19456
  v_smfmac_f32_16x16x64_bf16 v[76:79], v[60:63], a[168:175], v9
  ds_read_b128 v[112:115], v13 offset:22528
  v_smfmac_f32_16x16x64_bf16 v[84:87], v[60:63], a[184:191], v9
  ds_read_b128 v[116:119], v13 offset:23552
  s_waitcnt lgkmcnt(6)
  v_smfmac_f32_16x16x64_bf16 v[72:75], v[64:67], v[88:95], v9
  ds_read_b128 v[52:55], v12 offset:5120
  s_waitcnt lgkmcnt(5)
  v_smfmac_f32_16x16x64_bf16 v[80:83], v[64:67], v[104:111], v9
  ds_read_b128 v[56:59], v12 offset:6144
  v_smfmac_f32_16x16x64_bf16 v[72:75], v[68:71], a[192:199], v9
  ds_read_b128 v[60:63], v12 offset:7168
  ds_read_b128 v[88:91], v124 offset:0
  v_smfmac_f32_16x16x64_bf16 v[80:83], v[68:71], a[208:215], v9
  ds_read_b128 v[92:95], v124 offset:1024
  s_waitcnt lgkmcnt(7)
  v_smfmac_f32_16x16x64_bf16 v[76:79], v[64:67], v[96:103], v9
  s_waitcnt lgkmcnt(5)
  v_smfmac_f32_16x16x64_bf16 v[84:87], v[64:67], v[112:119], v9
  v_smfmac_f32_16x16x64_bf16 v[76:79], v[68:71], a[200:207], v9
  s_nop 1
  v_permlane32_swap_b32 v72, v80
  v_permlane32_swap_b32 v73, v81
  v_smfmac_f32_16x16x64_bf16 v[84:87], v[68:71], a[216:223], v9
  v_permlane32_swap_b32 v74, v82
  v_permlane32_swap_b32 v75, v83
  v_add_f32 v72, v72, v80
  v_add_f32 v73, v73, v81
  v_add_f32 v74, v74, v82
  v_add_f32 v75, v75, v83
  v_cvt_pk_bf16_f32 v80, v72, v73
  v_cvt_pk_bf16_f32 v81, v74, v75
  ds_write_b64 v10, v[80:81] offset:0
  v_permlane32_swap_b32 v76, v84
  v_permlane32_swap_b32 v77, v85
  v_permlane32_swap_b32 v78, v86
  v_permlane32_swap_b32 v79, v87
  v_add_f32 v76, v76, v84
  v_add_f32 v77, v77, v85
  v_add_f32 v78, v78, v86
  v_add_f32 v79, v79, v87
  v_cvt_pk_bf16_f32 v84, v76, v77
  v_cvt_pk_bf16_f32 v85, v78, v79
  ds_write_b64 v10, v[84:85] offset:512
  s_waitcnt lgkmcnt(0)
  s_barrier
  ds_read_b64_tr_b16 v[72:73], v11 offset:0
  ds_read_b64_tr_b16 v[74:75], v11 offset:512
  ds_read_b64_tr_b16 v[76:77], v11 offset:1024
  ds_read_b64_tr_b16 v[78:79], v11 offset:1536
  ds_read_b64_tr_b16 v[80:81], v11 offset:2048
  ds_read_b64_tr_b16 v[82:83], v11 offset:2560
  ds_read_b64_tr_b16 v[84:85], v11 offset:3072
  ds_read_b64_tr_b16 v[86:87], v11 offset:3584
  v_xor_b32 v12, 0x4000, v12
  s_mov_b64 exec, s[96:97]
  buffer_store_dwordx2 v[20:21], v15, s[40:43], s92 offen
  s_mov_b64 exec, -1
  v_mov_b64 v[96:97], 0
  v_mov_b64 v[98:99], 0
  v_mov_b64 v[100:101], 0
  v_mov_b64 v[102:103], 0
  v_mov_b64 v[104:105], 0
  v_mov_b64 v[106:107], 0
  buffer_load_dwordx4 v[116:119], v8, s[40:43], s93 offen sc1
  s_waitcnt lgkmcnt(6)
  v_mfma_f32_16x16x32_bf16 v[68:71], v[48:51], v[72:75], 0
  v_mfma_f32_16x16x32_bf16 v[64:67], v[32:35], v[72:75], 0
  v_mov_b64 v[108:109], 0
  s_waitcnt lgkmcnt(4)
  v_mfma_f32_16x16x32_bf16 v[68:71], v[52:55], v[76:79], v[68:71]
  v_mfma_f32_16x16x32_bf16 v[64:67], v[36:39], v[76:79], v[64:67]
  v_mov_b64 v[110:111], 0
  s_waitcnt lgkmcnt(2)
  v_mfma_f32_16x16x32_bf16 v[68:71], v[56:59], v[80:83], v[68:71]
  v_mfma_f32_16x16x32_bf16 v[64:67], v[40:43], v[80:83], v[64:67]
  v_mov_b64 v[112:113], 0
  s_waitcnt lgkmcnt(0)
  v_mfma_f32_16x16x32_bf16 v[68:71], v[60:63], v[84:87], v[68:71]
  v_mfma_f32_16x16x32_bf16 v[64:67], v[44:47], v[84:87], v[64:67]
  v_mov_b64 v[114:115], 0
  v_mfma_f32_16x16x32_bf16 v[120:123], v[72:75], v[72:75], v[120:123]
  v_mfma_f32_16x16x32_bf16 v[120:123], v[76:79], v[76:79], v[120:123]
  v_mfma_f32_16x16x32_bf16 v[120:123], v[80:83], v[80:83], v[120:123]
  v_mfma_f32_16x16x32_bf16 v[120:123], v[84:87], v[84:87], v[120:123]
  s_mov_b32 s47, 262144
  buffer_load_dwordx4 v[32:35], v8, s[40:43], s93 offen sc1
  v_max3_f32 v18, v68, v69, v70
  v_max3_f32 v124, v71, v64, v65
  v_max3_f32 v18, v18, v66, v67
  s_nop 2
  v_max3_f32 v124, v124, v120, v121
  v_max3_f32 v18, v18, v122, v123
  v_max_f32 v18, v18, v124
  v_mov_b32 v124, v18
  s_nop 1
  v_permlane32_swap_b32 v18, v124
  v_max_f32 v18, v18, v124
  v_mov_b32 v124, v18
  s_nop 1
  v_permlane16_swap_b32 v18, v124
  v_max_f32 v18, v18, v124
  v_mul_f32 v18, s57, v18
  v_fma_f32 v64, v64, s56, v18
  v_fma_f32 v65, v65, s56, v18
  v_fma_f32 v66, v66, s56, v18
  v_fma_f32 v67, v67, s56, v18
  v_exp_f32 v64, v64
  v_exp_f32 v65, v65
  v_exp_f32 v66, v66
  v_exp_f32 v67, v67
  v_fma_f32 v68, v68, s56, v18
  v_fma_f32 v69, v69, s56, v18
  v_fma_f32 v70, v70, s56, v18
  v_fma_f32 v71, v71, s56, v18
  v_exp_f32 v68, v68
  v_exp_f32 v69, v69
  v_exp_f32 v70, v70
  v_exp_f32 v71, v71
  v_fma_f32 v120, v120, s56, v18
  v_fma_f32 v121, v121, s56, v18
  v_fma_f32 v122, v122, s56, v18
  v_fma_f32 v123, v123, s56, v18
  v_cvt_pk_bf16_f32 v124, v64, v65
  v_cvt_pk_bf16_f32 v125, v66, v67
  v_cvt_pk_bf16_f32 v126, v68, v69
  v_cvt_pk_bf16_f32 v127, v70, v71
  v_exp_f32 v120, v120
  v_exp_f32 v121, v121
  v_mfma_f32_16x16x32_bf16 v[20:23], v[24:27], v[124:127], 0
  v_exp_f32 v122, v122
  v_mfma_f32_16x16x32_bf16 v[40:43], v[88:91], v[124:127], 0
  v_exp_f32 v123, v123
  v_mfma_f32_16x16x32_bf16 v[44:47], v[92:95], v[124:127], 0
  v_cvt_pk_bf16_f32 v6, v120, v121
  v_cvt_pk_bf16_f32 v7, v122, v123
  v_cvt_pk_bf16_f32 v70, v120, v121
  v_cvt_pk_bf16_f32 v71, v122, v123
  v_mov_b64 v[68:69], v[6:7]
  v_mfma_f32_16x16x16_bf16 v[20:23], v[24:25], v[6:7], v[20:23]
  s_waitcnt vmcnt(1)
  v_permlane32_swap_b32 v70, v68
  v_permlane32_swap_b32 v71, v69
  v_xor_b32 v18, v116, v2
  v_and_b32 v18, 1, v18
  v_cmp_ne_u32 vcc, 0, v18
  s_cbranch_vccnz L_vm_26
L_vmj_27:
  v_mfma_f32_16x16x16_bf16 v[40:43], v[116:117], v[68:69], v[40:43]
  v_mfma_f32_16x16x16_bf16 v[44:47], v[118:119], v[68:69], v[44:47]
  v_rcp_f32 v20, v20
  s_nop 5
  v_mul_f32 v40, v40, v20
  v_mul_f32 v41, v41, v20
  v_cvt_pk_bf16_f32 v64, v40, v41
  v_mul_f32 v42, v42, v20
  v_mul_f32 v43, v43, v20
  v_cvt_pk_bf16_f32 v65, v42, v43
  v_mul_f32 v44, v44, v20
  v_mul_f32 v45, v45, v20
  v_cvt_pk_bf16_f32 v66, v44, v45
  v_mul_f32 v46, v46, v20
  v_mul_f32 v47, v47, v20
  v_cvt_pk_bf16_f32 v67, v46, v47
  ds_write_b128 v1, v[64:67]
  s_waitcnt lgkmcnt(0)
  s_barrier
  ds_read_b128 v[48:51], v4 offset:16384
  ds_read_b128 v[52:55], v4 offset:17408
  ds_read_b128 v[56:59], v4 offset:18432
  ds_read_b128 v[60:63], v4 offset:19456
  s_waitcnt lgkmcnt(3)
  v_smfmac_f32_16x16x64_bf16 v[96:99], v[48:51], a[224:231], v9
  s_waitcnt lgkmcnt(2)
  v_smfmac_f32_16x16x64_bf16 v[96:99], v[52:55], a[232:239], v9
  s_waitcnt lgkmcnt(1)
  v_smfmac_f32_16x16x64_bf16 v[96:99], v[56:59], a[240:247], v9
  s_waitcnt lgkmcnt(0)
  v_smfmac_f32_16x16x64_bf16 v[96:99], v[60:63], a[248:255], v9
  v_smfmac_f32_16x16x64_bf16 v[100:103], v[48:51], v[128:135], v9
  v_smfmac_f32_16x16x64_bf16 v[100:103], v[52:55], v[136:143], v9
  v_smfmac_f32_16x16x64_bf16 v[100:103], v[56:59], v[144:151], v9
  s_nop 4
  v_cvt_pk_bf16_f32 v96, v96, v97
  v_smfmac_f32_16x16x64_bf16 v[100:103], v[60:63], v[152:159], v9
  v_cvt_pk_bf16_f32 v97, v98, v99
  v_smfmac_f32_16x16x64_bf16 v[104:107], v[48:51], v[160:167], v9
  v_and_or_b32 v96, v96, s61, v2
  v_smfmac_f32_16x16x64_bf16 v[104:107], v[52:55], v[168:175], v9
  buffer_store_dwordx2 v[96:97], v14, s[40:43], s3 offen
  v_smfmac_f32_16x16x64_bf16 v[104:107], v[56:59], v[176:183], v9
  s_nop 1
  v_cvt_pk_bf16_f32 v100, v100, v101
  v_smfmac_f32_16x16x64_bf16 v[104:107], v[60:63], v[184:191], v9
  v_cvt_pk_bf16_f32 v101, v102, v103
  v_smfmac_f32_16x16x64_bf16 v[108:111], v[48:51], v[192:199], v9
  v_and_or_b32 v100, v100, s61, v2
  v_smfmac_f32_16x16x64_bf16 v[108:111], v[52:55], v[200:207], v9
  buffer_store_dwordx2 v[100:101], v14, s[40:43], s4 offen
  v_smfmac_f32_16x16x64_bf16 v[108:111], v[56:59], v[208:215], v9
  s_nop 1
  v_cvt_pk_bf16_f32 v104, v104, v105
  v_smfmac_f32_16x16x64_bf16 v[108:111], v[60:63], v[216:223], v9
  v_cvt_pk_bf16_f32 v105, v106, v107
  v_smfmac_f32_16x16x64_bf16 v[112:115], v[48:51], v[224:231], v9
  v_and_or_b32 v104, v104, s61, v2
  v_smfmac_f32_16x16x64_bf16 v[112:115], v[52:55], v[232:239], v9
  buffer_store_dwordx2 v[104:105], v14, s[40:43], s5 offen
  v_smfmac_f32_16x16x64_bf16 v[112:115], v[56:59], v[240:247], v9
  s_nop 1
  v_cvt_pk_bf16_f32 v108, v108, v109
  v_smfmac_f32_16x16x64_bf16 v[112:115], v[60:63], v[248:255], v9
  v_cvt_pk_bf16_f32 v109, v110, v111
  v_and_or_b32 v108, v108, s61, v2
  buffer_store_dwordx2 v[108:109], v14, s[40:43], s6 offen
  s_nop 4
  v_cvt_pk_bf16_f32 v112, v112, v113
  v_cvt_pk_bf16_f32 v113, v114, v115
  v_and_or_b32 v112, v112, s61, v2
  buffer_store_dwordx2 v[112:113], v14, s[40:43], s7 offen
  s_cmp_eq_u32 s59, -1
  s_cbranch_scc1 L_side_30
  s_mov_b32 s46, s50
  s_mov_b32 s50, s51
  s_mov_b32 s51, s52
  s_mov_b32 s52, s46
  s_add_u32 s49, s49, 1
  s_add_u32 s53, s50, 77660160
  s_add_u32 s54, s53, 0
  s_mov_b32 s47, 262144
  v_mov_b64 v[72:73], 0
  v_mov_b64 v[74:75], 0
  v_mov_b64 v[76:77], 0
  v_mov_b64 v[78:79], 0
  v_mov_b64 v[80:81], 0
  v_mov_b64 v[82:83], 0
  v_mov_b64 v[84:85], 0
  v_mov_b64 v[86:87], 0
  v_mov_b32 v120, v17
  v_mov_b32 v121, v17
  v_mov_b32 v122, v17
  v_mov_b32 v123, v17
  buffer_load_dwordx4 v[32:35], v8, s[40:43], s88 offen offset:0 sc1
  buffer_load_dwordx4 v[36:39], v8, s[40:43], s88 offen offset:1024 sc1
  buffer_load_dwordx4 v[40:43], v8, s[40:43], s88 offen offset:2048 sc1
  buffer_load_dwordx4 v[44:47], v8, s[40:43], s88 offen offset:3072 sc1
  buffer_load_dwordx4 v[48:51], v8, s[40:43], s89 offen offset:0 sc1
  buffer_load_dwordx4 v[52:55], v8, s[40:43], s89 offen offset:1024 sc1
  buffer_load_dwordx4 v[56:59], v8, s[40:43], s89 offen offset:2048 sc1
  buffer_load_dwordx4 v[60:63], v8, s[40:43], s89 offen offset:3072 sc1
L_ra_29:
  s_waitcnt vmcnt(7)
  v_mfma_f32_16x16x32_bf16 v[64:67], v[32:35], v[28:31], 0
  buffer_load_dwordx4 v[88:91], v8, s[40:43], s88 offen offset:0 sc1
  v_xor_b32 v18, v32, v2
  v_bitop3_b32 v18, v18, v34, v2 bitop3:0xf6
  s_waitcnt vmcnt(7)
  v_mfma_f32_16x16x32_bf16 v[64:67], v[36:39], v[28:31], v[64:67]
  buffer_load_dwordx4 v[92:95], v8, s[40:43], s88 offen offset:1024 sc1
  v_bitop3_b32 v18, v18, v36, v2 bitop3:0xf6
  v_bitop3_b32 v18, v18, v38, v2 bitop3:0xf6
  s_waitcnt vmcnt(7)
  v_mfma_f32_16x16x32_bf16 v[64:67], v[40:43], v[28:31], v[64:67]
  buffer_load_dwordx4 v[96:99], v8, s[40:43], s88 offen offset:2048 sc1
  v_bitop3_b32 v18, v18, v40, v2 bitop3:0xf6
  v_bitop3_b32 v18, v18, v42, v2 bitop3:0xf6
  s_waitcnt vmcnt(7)
  v_mfma_f32_16x16x32_bf16 v[64:67], v[44:47], v[28:31], v[64:67]
  buffer_load_dwordx4 v[100:103], v8, s[40:43], s88 offen offset:3072 sc1
  v_bitop3_b32 v18, v18, v44, v2 bitop3:0xf6
  v_bitop3_b32 v18, v18, v46, v2 bitop3:0xf6
  s_waitcnt vmcnt(7)
  v_mfma_f32_16x16x32_bf16 v[64:67], v[48:51], v[28:31], v[64:67]
  buffer_load_dwordx4 v[104:107], v8, s[40:43], s89 offen offset:0 sc1
  v_bitop3_b32 v18, v18, v48, v2 bitop3:0xf6
  v_bitop3_b32 v18, v18, v50, v2 bitop3:0xf6
  s_waitcnt vmcnt(7)
  v_mfma_f32_16x16x32_bf16 v[64:67], v[52:55], v[28:31], v[64:67]
  buffer_load_dwordx4 v[108:111], v8, s[40:43], s89 offen offset:1024 sc1
  v_bitop3_b32 v18, v18, v52, v2 bitop3:0xf6
  v_bitop3_b32 v18, v18, v54, v2 bitop3:0xf6
  s_waitcnt vmcnt(7)
  v_mfma_f32_16x16x32_bf16 v[64:67], v[56:59], v[28:31], v[64:67]
  buffer_load_dwordx4 v[112:115], v8, s[40:43], s89 offen offset:2048 sc1
  v_bitop3_b32 v18, v18, v56, v2 bitop3:0xf6
  v_bitop3_b32 v18, v18, v58, v2 bitop3:0xf6
  s_waitcnt vmcnt(7)
  v_mfma_f32_16x16x32_bf16 v[64:67], v[60:63], v[28:31], v[64:67]
  buffer_load_dwordx4 v[116:119], v8, s[40:43], s89 offen offset:3072 sc1
  v_bitop3_b32 v18, v18, v60, v2 bitop3:0xf6
  v_bitop3_b32 v18, v18, v62, v2 bitop3:0xf6
  v_and_b32 v18, 1, v18
  v_cmp_ne_u32 vcc, 0, v18
  s_cbranch_vccz L_rj_31
  s_sub_u32 s47, s47, 1
  s_cbranch_scc1 L_abort
  s_waitcnt vmcnt(7)
  v_mfma_f32_16x16x32_bf16 v[64:67], v[88:91], v[28:31], 0
  buffer_load_dwordx4 v[32:35], v8, s[40:43], s88 offen offset:0 sc1
  v_xor_b32 v18, v88, v2
  v_bitop3_b32 v18, v18, v90, v2 bitop3:0xf6
  s_waitcnt vmcnt(7)
  v_mfma_f32_16x16x32_bf16 v[64:67], v[92:95], v[28:31], v[64:67]
  buffer_load_dwordx4 v[36:39], v8, s[40:43], s88 offen offset:1024 sc1
  v_bitop3_b32 v18, v18, v92, v2 bitop3:0xf6
  v_bitop3_b32 v18, v18, v94, v2 bitop3:0xf6
  s_waitcnt vmcnt(7)
  v_mfma_f32_16x16x32_bf16 v[64:67], v[96:99], v[28:31], v[64:67]
  buffer_load_dwordx4 v[40:43], v8, s[40:43], s88 offen offset:2048 sc1
  v_bitop3_b32 v18, v18, v96, v2 bitop3:0xf6
  v_bitop3_b32 v18, v18, v98, v2 bitop3:0xf6
  s_waitcnt vmcnt(7)
  v_mfma_f32_16x16x32_bf16 v[64:67], v[100:103], v[28:31], v[64:67]
  buffer_load_dwordx4 v[44:47], v8, s[40:43], s88 offen offset:3072 sc1
  v_bitop3_b32 v18, v18, v100, v2 bitop3:0xf6
  v_bitop3_b32 v18, v18, v102, v2 bitop3:0xf6
  s_waitcnt vmcnt(7)
  v_mfma_f32_16x16x32_bf16 v[64:67], v[104:107], v[28:31], v[64:67]
  buffer_load_dwordx4 v[48:51], v8, s[40:43], s89 offen offset:0 sc1
  v_bitop3_b32 v18, v18, v104, v2 bitop3:0xf6
  v_bitop3_b32 v18, v18, v106, v2 bitop3:0xf6
  s_waitcnt vmcnt(7)
  v_mfma_f32_16x16x32_bf16 v[64:67], v[108:111], v[28:31], v[64:67]
  buffer_load_dwordx4 v[52:55], v8, s[40:43], s89 offen offset:1024 sc1
  v_bitop3_b32 v18, v18, v108, v2 bitop3:0xf6
  v_bitop3_b32 v18, v18, v110, v2 bitop3:0xf6
  s_waitcnt vmcnt(7)
  v_mfma_f32_16x16x32_bf16 v[64:67], v[112:115], v[28:31], v[64:67]
  buffer_load_dwordx4 v[56:59], v8, s[40:43], s89 offen offset:2048 sc1
  v_bitop3_b32 v18, v18, v112, v2 bitop3:0xf6
  v_bitop3_b32 v18, v18, v114, v2 bitop3:0xf6
  s_waitcnt vmcnt(7)
  v_mfma_f32_16x16x32_bf16 v[64:67], v[116:119], v[28:31], v[64:67]
  buffer_load_dwordx4 v[60:63], v8, s[40:43], s89 offen offset:3072 sc1
  v_bitop3_b32 v18, v18, v116, v2 bitop3:0xf6
  v_bitop3_b32 v18, v18, v118, v2 bitop3:0xf6
  v_and_b32 v18, 1, v18
  v_cmp_ne_u32 vcc, 0, v18
  s_cbranch_vccnz L_ra_29
L_rj_31:
  s_nop 2
  v_cvt_pk_bf16_f32 v68, v64, v65
  v_cvt_pk_bf16_f32 v69, v66, v67
  v_cvt_pk_bf16_f32 v71, v66, v67
  v_min_u32 v64, s61, v68
  v_mov_b32 v70, v68
  v_and_or_b32 v68, v68, s61, v0
  v_mov_b32 v65, v69
  v_permlane16_swap_b32 v69, v71
  v_permlane16_swap_b32 v68, v70
  s_mov_b64 exec, s[98:99]
  buffer_store_dwordx4 v[68:71], v15, s[40:43], s91 offen sc1
  s_mov_b64 exec, s[96:97]
  buffer_store_dwordx2 v[64:65], v15, s[40:43], s90 offen
  s_mov_b64 exec, -1
  s_barrier
  s_waitcnt vmcnt(2)
L_rbar_28:
  ds_read_b128 v[88:91], v13 offset:0
  ds_read_b128 v[92:95], v13 offset:1024
  ds_read_b128 v[96:99], v13 offset:2048
  ds_read_b128 v[100:103], v13 offset:3072
  ds_read_b128 v[104:107], v13 offset:4096
  ds_read_b128 v[108:111], v13 offset:5120
  ds_read_b128 v[112:115], v13 offset:6144
  ds_read_b128 v[116:119], v13 offset:7168
  buffer_load_dwordx4 v[48:51], v19, s[40:43], s54 offen sc1
  buffer_load_dwordx4 v[52:55], v19, s[40:43], s54 offen offset:1024 sc1
  buffer_load_dwordx4 v[32:35], v8, s[40:43], s53 offen sc1
  buffer_load_dwordx4 v[36:39], v8, s[40:43], s53 offen offset:1024 sc1
  s_cmp_lt_u32 s49, 63
  s_cbranch_scc1 L_cstep_18
  s_branch L_end
L_side_30:
  s_mov_b32 s46, s50
  s_mov_b32 s50, s51
  s_mov_b32 s51, s52
  s_mov_b32 s52, s46
  s_add_u32 s49, s49, 1
  s_add_u32 s53, s50, 77660160
  s_add_u32 s54, s53, 0
  s_mov_b32 s47, 262144
  v_mov_b64 v[72:73], 0
  v_mov_b64 v[74:75], 0
  v_mov_b64 v[76:77], 0
  v_mov_b64 v[78:79], 0
  v_mov_b64 v[80:81], 0
  v_mov_b64 v[82:83], 0
  v_mov_b64 v[84:85], 0
  v_mov_b64 v[86:87], 0
  v_mov_b32 v120, v17
  v_mov_b32 v121, v17
  v_mov_b32 v122, v17
  v_mov_b32 v123, v17
  s_waitcnt vmcnt(0)
  s_barrier
  s_branch L_rbar_28
L_vm_26:
  buffer_load_dwordx4 v[116:119], v8, s[40:43], s93 offen sc1
  s_waitcnt vmcnt(1)
  v_xor_b32 v18, v32, v2
  v_and_b32 v18, 1, v18
  v_cmp_ne_u32 vcc, 0, v18
  s_cbranch_vccz L_vmb_32
  buffer_load_dwordx4 v[32:35], v8, s[40:43], s93 offen sc1
  s_sub_u32 s47, s47, 1
  s_cbranch_scc1 L_abort
  s_waitcnt vmcnt(1)
  v_xor_b32 v18, v116, v2
  v_and_b32 v18, 1, v18
  v_cmp_ne_u32 vcc, 0, v18
  s_cbranch_vccnz L_vm_26
  s_branch L_vmj_27
L_vmb_32:
  v_mov_b64 v[116:117], v[32:33]
  v_mov_b64 v[118:119], v[34:35]
  s_nop 0
  s_branch L_vmj_27
L_m2_34:
  s_sub_u32 s47, s47, 1
  s_cbranch_scc1 L_abort
  s_waitcnt vmcnt(3)
L_mp_24:
  buffer_load_dwordx4 v[48:51], v19, s[40:43], s54 offen sc1
  buffer_load_dwordx4 v[52:55], v19, s[40:43], s54 offen offset:1024 sc1
  buffer_load_dwordx4 v[32:35], v8, s[40:43], s53 offen sc1
  buffer_load_dwordx4 v[36:39], v8, s[40:43], s53 offen offset:1024 sc1
  s_waitcnt vmcnt(6)
  ds_write_b128 v19, v[56:59]
  ds_write_b128 v19, v[60:63] offset:1024
  v_max3_u32 v18, v56, v58, v60
  s_waitcnt vmcnt(4)
  v_max3_u32 v18, v18, v62, v64
  v_max3_u32 v18, v18, v66, v68
  v_max_u32 v18, v18, v70
  v_cmp_eq_u32 vcc, -1, v18
  s_cbranch_vccz L_mb_33
  s_waitcnt vmcnt(3)
  buffer_load_dwordx4 v[56:59], v19, s[40:43], s54 offen sc1
  buffer_load_dwordx4 v[60:63], v19, s[40:43], s54 offen offset:1024 sc1
  buffer_load_dwordx4 v[64:67], v8, s[40:43], s53 offen sc1
  buffer_load_dwordx4 v[68:71], v8, s[40:43], s53 offen offset:1024 sc1
  s_waitcnt vmcnt(6)
  ds_write_b128 v19, v[48:51]
  ds_write_b128 v19, v[52:55] offset:1024
  v_max3_u32 v18, v48, v50, v52
  s_waitcnt vmcnt(4)
  v_max3_u32 v18, v18, v54, v32
  v_max3_u32 v18, v18, v34, v36
  v_max_u32 v18, v18, v38
  v_cmp_eq_u32 vcc, -1, v18
  s_cbranch_vccnz L_m2_34
  s_branch L_mx_35
L_mb_33:
  v_mov_b64 v[32:33], v[64:65]
  v_mov_b64 v[34:35], v[66:67]
  v_mov_b64 v[36:37], v[68:69]
  v_mov_b64 v[38:39], v[70:71]
L_mx_35:
  s_branch L_mj_25
L_fslow_20:
  s_lshr_b32 s46, s62, 2
  s_lshl_b32 s46, s46, 5
  s_add_u32 s46, s46, s48
  s_lshl_b32 s46, s46, 2
  s_and_b32 s47, s62, 3
  s_add_u32 s46, s46, s47
  s_lshl_b32 s46, s46, 2
  s_add_u32 s46, s46, 78725120
  s_mov_b32 s47, 262144
L_fs_36:
  buffer_load_dword v16, v3, s[40:43], s46 offen sc1
  s_waitcnt vmcnt(0)
  s_sub_u32 s47, s47, 1
  s_cbranch_scc1 L_abort
  v_cmp_eq_u32 vcc, 0, v16
  s_cbranch_vccnz L_fs_36
  s_mov_b32 s47, 262144
  s_branch L_fok_21
L_chain_slow:
  s_mov_b32 s49, 0
  s_mov_b32 s50, 0
  s_mov_b32 s51, 16384
  s_mov_b32 s52, 32768
  s_lshl_b32 s46, s59, 13
  s_add_u32 s88, s46, 75497472
  s_add_u32 s89, s88, 4096
  s_mov_b32 s3, 75497472
  s_mov_b32 s4, 75563008
  s_mov_b32 s5, 75628544
  s_mov_b32 s6, 75694080
  s_mov_b32 s7, 75759616
  v_mul_u32_u24 v18, 1280, v4
  v_lshl_add_u32 v18, v5, 3, v18
  s_lshl_b32 s46, s59, 5
  s_and_b32 s46, s46, 0x7ff
  s_mov_b64 exec, s[96:97]
  buffer_load_dwordx2 v[20:21], v18, s[12:15], s46 offen
  buffer_load_dwordx4 v[116:119], v18, s[12:15], s46 offen
  s_waitcnt vmcnt(0)
  v_min_u32 v20, s61, v20
  s_mov_b32 s53, 77660160
  s_cmp_ge_i32 s59, 32
  s_cselect_b32 s54, 17, 16
  s_cselect_b32 s55, 8192, 0
  s_lshr_b32 s91, s0, s54
  s_and_b32 s91, s91, 1
  s_lshl_b32 s91, s91, 13
  s_lshl_b32 s46, s54, 14
  s_add_u32 s91, s91, s46
  s_add_u32 s91, s91, 76546048
  s_sub_u32 s91, s91, s55
  buffer_store_dwordx2 v[20:21], v15, s[40:43], s53 offen sc1
  s_mov_b32 s98, 0xff
  s_mov_b32 s99, 0xff
  s_cmp_eq_u32 s59, -1
  s_cselect_b32 s91, 0x20000000, s91
  s_mov_b64 exec, s[98:99]
  v_and_b32 v116, s61, v116
  buffer_store_dwordx4 v[116:119], v15, s[40:43], s91 offen sc1
  s_mov_b64 exec, s[96:97]
  s_mov_b64 exec, -1
  s_lshl_b32 s46, s44, 11
  s_add_u32 s46, s46, 2048
  v_add_u32 v19, s46, v8
  s_lshr_b32 s54, s48, 1
  s_lshr_b32 s93, s0, s54
  s_and_b32 s93, s93, 1
  s_lshl_b32 s93, s93, 13
  s_lshl_b32 s46, s54, 14
  s_add_u32 s93, s93, s46
  s_add_u32 s93, s93, 76546048
  s_and_b32 s46, s48, 1
  s_lshl_b32 s46, s46, 12
  s_add_u32 s93, s93, s46
  s_lshl_b32 s46, s44, 10
  s_add_u32 s93, s93, s46
  s_add_u32 s46, s46, 16384
  v_add_u32 v1, s46, v8
  v_and_b32 v4, 0x37f, v8
  s_lshl_b32 s63, s44, 11
  s_add_u32 s63, s63, 8192
  s_lshl_b32 s46, s48, 4
  s_add_u32 s46, s46, 78725120
  s_mov_b32 s92, s46
  s_cmp_eq_u32 s94, 1
  s_cbranch_scc1 L_pre_41
  s_mov_b32 s47, 262144
L_fs_42:
  buffer_load_dword v16, v3, s[40:43], s46 offen sc1
  s_waitcnt vmcnt(0)
  s_sub_u32 s47, s47, 1
  s_cbranch_scc1 L_abort
  v_cmp_eq_u32 vcc, 0, v16
  s_cbranch_vccnz L_fs_42
  s_mov_b32 s62, 0
  s_lshl_b32 s0, s62, 5
  s_add_u32 s0, s0, s48
  s_lshl_b32 s0, s0, 14
  s_lshl_b32 s1, s44, 12
  s_add_u32 s0, s0, s1
  s_lshl_b32 s46, s62, 14
  s_add_u32 s1, s1, s46
  s_add_u32 s1, s1, 131072
  s_mov_b32 m0, s1
  s_nop 0
  buffer_load_dwordx4 v8, s[40:43], s0 offen offset:0 sc1 lds
  buffer_load_dwordx4 v8, s[40:43], s0 offen offset:1024 sc1 lds
  buffer_load_dwordx4 v8, s[40:43], s0 offen offset:2048 sc1 lds
  buffer_load_dwordx4 v8, s[40:43], s0 offen offset:3072 sc1 lds
L_pre_41:
  buffer_load_dword v16, v3, s[40:43], s92 offen offset:4 sc1
  s_waitcnt vmcnt(0) lgkmcnt(0)
  s_barrier
  s_add_u32 s53, s50, 77660160
  s_add_u32 s54, s53, 0
  s_mov_b32 s47, 262144
  v_mov_b64 v[72:73], 0
  v_mov_b64 v[74:75], 0
  v_mov_b64 v[76:77], 0
  v_mov_b64 v[78:79], 0
  v_mov_b64 v[80:81], 0
  v_mov_b64 v[82:83], 0
  v_mov_b64 v[84:85], 0
  v_mov_b64 v[86:87], 0
  v_mov_b32 v120, v17
  v_mov_b32 v121, v17
  v_mov_b32 v122, v17
  v_mov_b32 v123, v17
  ds_read_b128 v[88:91], v13 offset:0
  ds_read_b128 v[92:95], v13 offset:1024
  ds_read_b128 v[96:99], v13 offset:2048
  ds_read_b128 v[100:103], v13 offset:3072
  ds_read_b128 v[104:107], v13 offset:4096
  ds_read_b128 v[108:111], v13 offset:5120
  ds_read_b128 v[112:115], v13 offset:6144
  ds_read_b128 v[116:119], v13 offset:7168
  buffer_load_dwordx4 v[48:51], v19, s[40:43], s54 offen sc1
  buffer_load_dwordx4 v[52:55], v19, s[40:43], s54 offen offset:1024 sc1
  buffer_load_dwordx4 v[32:35], v8, s[40:43], s53 offen sc1
  buffer_load_dwordx4 v[36:39], v8, s[40:43], s53 offen offset:1024 sc1
L_cstep_37:
  s_and_b32 s58, s49, 1
  v_mov_b32 v2, s58
  s_add_u32 s62, s49, 1
  s_min_u32 s62, s62, 62
  s_xor_b32 s2, s58, 1
  s_lshl_b32 s0, s62, 5
  s_add_u32 s0, s0, s48
  s_lshl_b32 s0, s0, 14
  s_lshl_b32 s1, s44, 12
  s_add_u32 s0, s0, s1
  s_lshl_b32 s46, s2, 14
  s_add_u32 s1, s1, s46
  s_add_u32 s1, s1, 131072
  s_mov_b32 m0, s1
  s_add_u32 s46, s49, 2
  s_min_u32 s46, s46, 63
  s_lshr_b32 s2, s46, 2
  s_lshl_b32 s2, s2, 5
  s_add_u32 s2, s2, s48
  s_lshl_b32 s2, s2, 2
  s_and_b32 s46, s46, 3
  s_add_u32 s2, s2, s46
  s_lshl_b32 s2, s2, 2
  s_add_u32 s2, s2, 78725120
  s_add_u32 s90, s51, 77660160
  s_add_u32 s92, s52, 77660160
  v_mov_b64 v[20:21], -1
  v_xor_b32 v0, 1, v2
  v_cmp_eq_u32 vcc, 0, v16
  s_cbranch_vccnz L_fslow_39
L_fok_40:
  buffer_load_dwordx4 v[56:59], v19, s[40:43], s54 offen sc1
  buffer_load_dwordx4 v[60:63], v19, s[40:43], s54 offen offset:1024 sc1
  buffer_load_dwordx4 v[64:67], v8, s[40:43], s53 offen sc1
  buffer_load_dwordx4 v[68:71], v8, s[40:43], s53 offen offset:1024 sc1
  s_waitcnt vmcnt(6)
  ds_write_b128 v19, v[48:51]
  ds_write_b128 v19, v[52:55] offset:1024
  v_max3_u32 v18, v48, v50, v52
  s_waitcnt vmcnt(4)
  v_max3_u32 v18, v18, v54, v32
  v_max3_u32 v18, v18, v34, v36
  v_max_u32 v18, v18, v38
  v_cmp_eq_u32 vcc, -1, v18
  s_cbranch_vccnz L_mp_43
L_mj_44:
  s_waitcnt lgkmcnt(2)
  v_smfmac_f32_16x16x64_bf16 v[72:75], v[32:35], v[88:95], v9
  v_smfmac_f32_16x16x64_bf16 v[80:83], v[32:35], v[104:111], v9
  v_smfmac_f32_16x16x64_bf16 v[76:79], v[32:35], v[96:103], v9
  v_smfmac_f32_16x16x64_bf16 v[84:87], v[32:35], v[112:119], v9
  s_waitcnt lgkmcnt(0)
  s_barrier
  ds_read_b128 v[40:43], v8 offset:2048
  ds_read_b128 v[44:47], v8 offset:3072
  v_smfmac_f32_16x16x64_bf16 v[72:75], v[36:39], a[0:7], v9
  s_waitcnt vmcnt(0)
  ds_read_b128 v[48:51], v8 offset:4096
  v_smfmac_f32_16x16x64_bf16 v[80:83], v[36:39], a[16:23], v9
  ds_read_b128 v[52:55], v8 offset:5120
  buffer_load_dwordx4 v8, s[40:43], s0 offen offset:0 sc1 lds
  v_smfmac_f32_16x16x64_bf16 v[76:79], v[36:39], a[8:15], v9
  ds_read_b128 v[56:59], v8 offset:6144
  buffer_load_dwordx4 v8, s[40:43], s0 offen offset:1024 sc1 lds
  v_smfmac_f32_16x16x64_bf16 v[84:87], v[36:39], a[24:31], v9
  ds_read_b128 v[60:63], v8 offset:7168
  buffer_load_dwordx4 v8, s[40:43], s0 offen offset:2048 sc1 lds
  s_waitcnt lgkmcnt(5)
  v_smfmac_f32_16x16x64_bf16 v[72:75], v[40:43], a[32:39], v9
  ds_read_b128 v[64:67], v8 offset:8192
  buffer_load_dwordx4 v8, s[40:43], s0 offen offset:3072 sc1 lds
  v_smfmac_f32_16x16x64_bf16 v[80:83], v[40:43], a[48:55], v9
  ds_read_b128 v[68:71], v8 offset:9216
  buffer_load_dword v16, v3, s[40:43], s2 offen sc1
  v_smfmac_f32_16x16x64_bf16 v[76:79], v[40:43], a[40:47], v9
  ds_read_b128 v[88:91], v13 offset:8192
  v_smfmac_f32_16x16x64_bf16 v[84:87], v[40:43], a[56:63], v9
  ds_read_b128 v[92:95], v13 offset:9216
  s_waitcnt lgkmcnt(8)
  v_smfmac_f32_16x16x64_bf16 v[72:75], v[44:47], a[64:71], v9
  ds_read_b128 v[104:107], v13 offset:12288
  v_smfmac_f32_16x16x64_bf16 v[80:83], v[44:47], a[80:87], v9
  ds_read_b128 v[108:111], v13 offset:13312
  v_smfmac_f32_16x16x64_bf16 v[76:79], v[44:47], a[72:79], v9
  ds_read_b128 v[96:99], v13 offset:10240
  v_smfmac_f32_16x16x64_bf16 v[84:87], v[44:47], a[88:95], v9
  ds_read_b128 v[100:103], v13 offset:11264
  s_waitcnt lgkmcnt(11)
  v_smfmac_f32_16x16x64_bf16 v[72:75], v[48:51], a[96:103], v9
  ds_read_b128 v[112:115], v13 offset:14336
  v_smfmac_f32_16x16x64_bf16 v[80:83], v[48:51], a[112:119], v9
  ds_read_b128 v[116:119], v13 offset:15360
  v_smfmac_f32_16x16x64_bf16 v[76:79], v[48:51], a[104:111], v9
  ds_read_b128 v[32:35], v12 offset:0
  v_smfmac_f32_16x16x64_bf16 v[84:87], v[48:51], a[120:127], v9
  ds_read_b128 v[36:39], v12 offset:1024
  s_waitcnt lgkmcnt(14)
  s_waitcnt lgkmcnt(8)
  v_smfmac_f32_16x16x64_bf16 v[72:75], v[52:55], v[88:95], v9
  ds_read_b128 v[40:43], v12 offset:2048
  s_waitcnt lgkmcnt(7)
  v_smfmac_f32_16x16x64_bf16 v[80:83], v[52:55], v[104:111], v9
  ds_read_b128 v[44:47], v12 offset:3072
  s_waitcnt lgkmcnt(6)
  v_smfmac_f32_16x16x64_bf16 v[76:79], v[52:55], v[96:103], v9
  ds_read_b128 v[48:51], v12 offset:4096
  s_waitcnt lgkmcnt(5)
  v_smfmac_f32_16x16x64_bf16 v[84:87], v[52:55], v[112:119], v9
  v_add_u32 v124, s63, v12
  v_smfmac_f32_16x16x64_bf16 v[72:75], v[56:59], a[128:135], v9
  ds_read_b128 v[88:91], v13 offset:16384
  v_smfmac_f32_16x16x64_bf16 v[80:83], v[56:59], a[144:151], v9
  ds_read_b128 v[92:95], v13 offset:17408
  v_smfmac_f32_16x16x64_bf16 v[76:79], v[56:59], a[136:143], v9
  ds_read_b128 v[104:107], v13 offset:20480
  v_smfmac_f32_16x16x64_bf16 v[84:87], v[56:59], a[152:159], v9
  ds_read_b128 v[108:111], v13 offset:21504
  v_smfmac_f32_16x16x64_bf16 v[72:75], v[60:63], a[160:167], v9
  ds_read_b128 v[96:99], v13 offset:18432
  v_smfmac_f32_16x16x64_bf16 v[80:83], v[60:63], a[176:183], v9
  ds_read_b128 v[100:103], v13 offset:19456
  v_smfmac_f32_16x16x64_bf16 v[76:79], v[60:63], a[168:175], v9
  ds_read_b128 v[112:115], v13 offset:22528
  v_smfmac_f32_16x16x64_bf16 v[84:87], v[60:63], a[184:191], v9
  ds_read_b128 v[116:119], v13 offset:23552
  s_waitcnt lgkmcnt(6)
  v_smfmac_f32_16x16x64_bf16 v[72:75], v[64:67], v[88:95], v9
  ds_read_b128 v[52:55], v12 offset:5120
  s_waitcnt lgkmcnt(5)
  v_smfmac_f32_16x16x64_bf16 v[80:83], v[64:67], v[104:111], v9
  ds_read_b128 v[56:59], v12 offset:6144
  v_smfmac_f32_16x16x64_bf16 v[72:75], v[68:71], a[192:199], v9
  ds_read_b128 v[60:63], v12 offset:7168
  ds_read_b128 v[88:91], v124 offset:0
  v_smfmac_f32_16x16x64_bf16 v[80:83], v[68:71], a[208:215], v9
  ds_read_b128 v[92:95], v124 offset:1024
  s_waitcnt lgkmcnt(7)
  v_smfmac_f32_16x16x64_bf16 v[76:79], v[64:67], v[96:103], v9
  s_waitcnt lgkmcnt(5)
  v_smfmac_f32_16x16x64_bf16 v[84:87], v[64:67], v[112:119], v9
  v_smfmac_f32_16x16x64_bf16 v[76:79], v[68:71], a[200:207], v9
  s_nop 1
  v_permlane32_swap_b32 v72, v80
  v_permlane32_swap_b32 v73, v81
  v_smfmac_f32_16x16x64_bf16 v[84:87], v[68:71], a[216:223], v9
  v_permlane32_swap_b32 v74, v82
  v_permlane32_swap_b32 v75, v83
  v_add_f32 v72, v72, v80
  v_add_f32 v73, v73, v81
  v_add_f32 v74, v74, v82
  v_add_f32 v75, v75, v83
  v_cvt_pk_bf16_f32 v80, v72, v73
  v_cvt_pk_bf16_f32 v81, v74, v75
  ds_write_b64 v10, v[80:81] offset:0
  v_permlane32_swap_b32 v76, v84
  v_permlane32_swap_b32 v77, v85
  v_permlane32_swap_b32 v78, v86
  v_permlane32_swap_b32 v79, v87
  v_add_f32 v76, v76, v84
  v_add_f32 v77, v77, v85
  v_add_f32 v78, v78, v86
  v_add_f32 v79, v79, v87
  v_cvt_pk_bf16_f32 v84, v76, v77
  v_cvt_pk_bf16_f32 v85, v78, v79
  ds_write_b64 v10, v[84:85] offset:512
  s_waitcnt lgkmcnt(0)
  s_barrier
  ds_read_b64_tr_b16 v[72:73], v11 offset:0
  ds_read_b64_tr_b16 v[74:75], v11 offset:512
  ds_read_b64_tr_b16 v[76:77], v11 offset:1024
  ds_read_b64_tr_b16 v[78:79], v11 offset:1536
  ds_read_b64_tr_b16 v[80:81], v11 offset:2048
  ds_read_b64_tr_b16 v[82:83], v11 offset:2560
  ds_read_b64_tr_b16 v[84:85], v11 offset:3072
  ds_read_b64_tr_b16 v[86:87], v11 offset:3584
  v_xor_b32 v12, 0x4000, v12
  s_mov_b64 exec, s[96:97]
  buffer_store_dwordx2 v[20:21], v15, s[40:43], s92 offen sc1
  s_mov_b64 exec, -1
  v_mov_b64 v[96:97], 0
  v_mov_b64 v[98:99], 0
  v_mov_b64 v[100:101], 0
  v_mov_b64 v[102:103], 0
  v_mov_b64 v[104:105], 0
  v_mov_b64 v[106:107], 0
  buffer_load_dwordx4 v[116:119], v8, s[40:43], s93 offen sc1
  s_waitcnt lgkmcnt(6)
  v_mfma_f32_16x16x32_bf16 v[68:71], v[48:51], v[72:75], 0
  v_mfma_f32_16x16x32_bf16 v[64:67], v[32:35], v[72:75], 0
  v_mov_b64 v[108:109], 0
  s_waitcnt lgkmcnt(4)
  v_mfma_f32_16x16x32_bf16 v[68:71], v[52:55], v[76:79], v[68:71]
  v_mfma_f32_16x16x32_bf16 v[64:67], v[36:39], v[76:79], v[64:67]
  v_mov_b64 v[110:111], 0
  s_waitcnt lgkmcnt(2)
  v_mfma_f32_16x16x32_bf16 v[68:71], v[56:59], v[80:83], v[68:71]
  v_mfma_f32_16x16x32_bf16 v[64:67], v[40:43], v[80:83], v[64:67]
  v_mov_b64 v[112:113], 0
  s_waitcnt lgkmcnt(0)
  v_mfma_f32_16x16x32_bf16 v[68:71], v[60:63], v[84:87], v[68:71]
  v_mfma_f32_16x16x32_bf16 v[64:67], v[44:47], v[84:87], v[64:67]
  v_mov_b64 v[114:115], 0
  v_mfma_f32_16x16x32_bf16 v[120:123], v[72:75], v[72:75], v[120:123]
  v_mfma_f32_16x16x32_bf16 v[120:123], v[76:79], v[76:79], v[120:123]
  v_mfma_f32_16x16x32_bf16 v[120:123], v[80:83], v[80:83], v[120:123]
  v_mfma_f32_16x16x32_bf16 v[120:123], v[84:87], v[84:87], v[120:123]
  s_mov_b32 s47, 262144
  buffer_load_dwordx4 v[32:35], v8, s[40:43], s93 offen sc1
  v_max3_f32 v18, v68, v69, v70
  v_max3_f32 v124, v71, v64, v65
  v_max3_f32 v18, v18, v66, v67
  s_nop 2
  v_max3_f32 v124, v124, v120, v121
  v_max3_f32 v18, v18, v122, v123
  v_max_f32 v18, v18, v124
  v_mov_b32 v124, v18
  s_nop 1
  v_permlane32_swap_b32 v18, v124
  v_max_f32 v18, v18, v124
  v_mov_b32 v124, v18
  s_nop 1
  v_permlane16_swap_b32 v18, v124
  v_max_f32 v18, v18, v124
  v_mul_f32 v18, s57, v18
  v_fma_f32 v64, v64, s56, v18
  v_fma_f32 v65, v65, s56, v18
  v_fma_f32 v66, v66, s56, v18
  v_fma_f32 v67, v67, s56, v18
  v_exp_f32 v64, v64
  v_exp_f32 v65, v65
  v_exp_f32 v66, v66
  v_exp_f32 v67, v67
  v_fma_f32 v68, v68, s56, v18
  v_fma_f32 v69, v69, s56, v18
  v_fma_f32 v70, v70, s56, v18
  v_fma_f32 v71, v71, s56, v18
  v_exp_f32 v68, v68
  v_exp_f32 v69, v69
  v_exp_f32 v70, v70
  v_exp_f32 v71, v71
  v_fma_f32 v120, v120, s56, v18
  v_fma_f32 v121, v121, s56, v18
  v_fma_f32 v122, v122, s56, v18
  v_fma_f32 v123, v123, s56, v18
  v_cvt_pk_bf16_f32 v124, v64, v65
  v_cvt_pk_bf16_f32 v125, v66, v67
  v_cvt_pk_bf16_f32 v126, v68, v69
  v_cvt_pk_bf16_f32 v127, v70, v71
  v_exp_f32 v120, v120
  v_exp_f32 v121, v121
  v_mfma_f32_16x16x32_bf16 v[20:23], v[24:27], v[124:127], 0
  v_exp_f32 v122, v122
  v_mfma_f32_16x16x32_bf16 v[40:43], v[88:91], v[124:127], 0
  v_exp_f32 v123, v123
  v_mfma_f32_16x16x32_bf16 v[44:47], v[92:95], v[124:127], 0
  v_cvt_pk_bf16_f32 v6, v120, v121
  v_cvt_pk_bf16_f32 v7, v122, v123
  v_cvt_pk_bf16_f32 v70, v120, v121
  v_cvt_pk_bf16_f32 v71, v122, v123
  v_mov_b64 v[68:69], v[6:7]
  v_mfma_f32_16x16x16_bf16 v[20:23], v[24:25], v[6:7], v[20:23]
  s_waitcnt vmcnt(1)
  v_permlane32_swap_b32 v70, v68
  v_permlane32_swap_b32 v71, v69
  v_xor_b32 v18, v116, v2
  v_and_b32 v18, 1, v18
  v_cmp_ne_u32 vcc, 0, v18
  s_cbranch_vccnz L_vm_45
L_vmj_46:
  v_mfma_f32_16x16x16_bf16 v[40:43], v[116:117], v[68:69], v[40:43]
  v_mfma_f32_16x16x16_bf16 v[44:47], v[118:119], v[68:69], v[44:47]
  v_rcp_f32 v20, v20
  s_nop 5
  v_mul_f32 v40, v40, v20
  v_mul_f32 v41, v41, v20
  v_cvt_pk_bf16_f32 v64, v40, v41
  v_mul_f32 v42, v42, v20
  v_mul_f32 v43, v43, v20
  v_cvt_pk_bf16_f32 v65, v42, v43
  v_mul_f32 v44, v44, v20
  v_mul_f32 v45, v45, v20
  v_cvt_pk_bf16_f32 v66, v44, v45
  v_mul_f32 v46, v46, v20
  v_mul_f32 v47, v47, v20
  v_cvt_pk_bf16_f32 v67, v46, v47
  ds_write_b128 v1, v[64:67]
  s_waitcnt lgkmcnt(0)
  s_barrier
  ds_read_b128 v[48:51], v4 offset:16384
  ds_read_b128 v[52:55], v4 offset:17408
  ds_read_b128 v[56:59], v4 offset:18432
  ds_read_b128 v[60:63], v4 offset:19456
  s_waitcnt lgkmcnt(3)
  v_smfmac_f32_16x16x64_bf16 v[96:99], v[48:51], a[224:231], v9
  s_waitcnt lgkmcnt(2)
  v_smfmac_f32_16x16x64_bf16 v[96:99], v[52:55], a[232:239], v9
  s_waitcnt lgkmcnt(1)
  v_smfmac_f32_16x16x64_bf16 v[96:99], v[56:59], a[240:247], v9
  s_waitcnt lgkmcnt(0)
  v_smfmac_f32_16x16x64_bf16 v[96:99], v[60:63], a[248:255], v9
  v_smfmac_f32_16x16x64_bf16 v[100:103], v[48:51], v[128:135], v9
  v_smfmac_f32_16x16x64_bf16 v[100:103], v[52:55], v[136:143], v9
  v_smfmac_f32_16x16x64_bf16 v[100:103], v[56:59], v[144:151], v9
  s_nop 4
  v_cvt_pk_bf16_f32 v96, v96, v97
  v_smfmac_f32_16x16x64_bf16 v[100:103], v[60:63], v[152:159], v9
  v_cvt_pk_bf16_f32 v97, v98, v99
  v_smfmac_f32_16x16x64_bf16 v[104:107], v[48:51], v[160:167], v9
  v_and_or_b32 v96, v96, s61, v2
  v_smfmac_f32_16x16x64_bf16 v[104:107], v[52:55], v[168:175], v9
  buffer_store_dwordx2 v[96:97], v14, s[40:43], s3 offen sc1
  v_smfmac_f32_16x16x64_bf16 v[104:107], v[56:59], v[176:183], v9
  s_nop 1
  v_cvt_pk_bf16_f32 v100, v100, v101
  v_smfmac_f32_16x16x64_bf16 v[104:107], v[60:63], v[184:191], v9
  v_cvt_pk_bf16_f32 v101, v102, v103
  v_smfmac_f32_16x16x64_bf16 v[108:111], v[48:51], v[192:199], v9
  v_and_or_b32 v100, v100, s61, v2
  v_smfmac_f32_16x16x64_bf16 v[108:111], v[52:55], v[200:207], v9
  buffer_store_dwordx2 v[100:101], v14, s[40:43], s4 offen sc1
  v_smfmac_f32_16x16x64_bf16 v[108:111], v[56:59], v[208:215], v9
  s_nop 1
  v_cvt_pk_bf16_f32 v104, v104, v105
  v_smfmac_f32_16x16x64_bf16 v[108:111], v[60:63], v[216:223], v9
  v_cvt_pk_bf16_f32 v105, v106, v107
  v_smfmac_f32_16x16x64_bf16 v[112:115], v[48:51], v[224:231], v9
  v_and_or_b32 v104, v104, s61, v2
  v_smfmac_f32_16x16x64_bf16 v[112:115], v[52:55], v[232:239], v9
  buffer_store_dwordx2 v[104:105], v14, s[40:43], s5 offen sc1
  v_smfmac_f32_16x16x64_bf16 v[112:115], v[56:59], v[240:247], v9
  s_nop 1
  v_cvt_pk_bf16_f32 v108, v108, v109
  v_smfmac_f32_16x16x64_bf16 v[112:115], v[60:63], v[248:255], v9
  v_cvt_pk_bf16_f32 v109, v110, v111
  v_and_or_b32 v108, v108, s61, v2
  buffer_store_dwordx2 v[108:109], v14, s[40:43], s6 offen sc1
  s_nop 4
  v_cvt_pk_bf16_f32 v112, v112, v113
  v_cvt_pk_bf16_f32 v113, v114, v115
  v_and_or_b32 v112, v112, s61, v2
  buffer_store_dwordx2 v[112:113], v14, s[40:43], s7 offen sc1
  s_cmp_eq_u32 s59, -1
  s_cbranch_scc1 L_side_49
  s_mov_b32 s46, s50
  s_mov_b32 s50, s51
  s_mov_b32 s51, s52
  s_mov_b32 s52, s46
  s_add_u32 s49, s49, 1
  s_add_u32 s53, s50, 77660160
  s_add_u32 s54, s53, 0
  s_mov_b32 s47, 262144
  v_mov_b64 v[72:73], 0
  v_mov_b64 v[74:75], 0
  v_mov_b64 v[76:77], 0
  v_mov_b64 v[78:79], 0
  v_mov_b64 v[80:81], 0
  v_mov_b64 v[82:83], 0
  v_mov_b64 v[84:85], 0
  v_mov_b64 v[86:87], 0
  v_mov_b32 v120, v17
  v_mov_b32 v121, v17
  v_mov_b32 v122, v17
  v_mov_b32 v123, v17
  buffer_load_dwordx4 v[32:35], v8, s[40:43], s88 offen offset:0 sc1
  buffer_load_dwordx4 v[36:39], v8, s[40:43], s88 offen offset:1024 sc1
  buffer_load_dwordx4 v[40:43], v8, s[40:43], s88 offen offset:2048 sc1
  buffer_load_dwordx4 v[44:47], v8, s[40:43], s88 offen offset:3072 sc1
  buffer_load_dwordx4 v[48:51], v8, s[40:43], s89 offen offset:0 sc1
  buffer_load_dwordx4 v[52:55], v8, s[40:43], s89 offen offset:1024 sc1
  buffer_load_dwordx4 v[56:59], v8, s[40:43], s89 offen offset:2048 sc1
  buffer_load_dwordx4 v[60:63], v8, s[40:43], s89 offen offset:3072 sc1
L_ra_48:
  s_waitcnt vmcnt(7)
  v_mfma_f32_16x16x32_bf16 v[64:67], v[32:35], v[28:31], 0
  buffer_load_dwordx4 v[88:91], v8, s[40:43], s88 offen offset:0 sc1
  v_xor_b32 v18, v32, v2
  v_bitop3_b32 v18, v18, v34, v2 bitop3:0xf6
  s_waitcnt vmcnt(7)
  v_mfma_f32_16x16x32_bf16 v[64:67], v[36:39], v[28:31], v[64:67]
  buffer_load_dwordx4 v[92:95], v8, s[40:43], s88 offen offset:1024 sc1
  v_bitop3_b32 v18, v18, v36, v2 bitop3:0xf6
  v_bitop3_b32 v18, v18, v38, v2 bitop3:0xf6
  s_waitcnt vmcnt(7)
  v_mfma_f32_16x16x32_bf16 v[64:67], v[40:43], v[28:31], v[64:67]
  buffer_load_dwordx4 v[96:99], v8, s[40:43], s88 offen offset:2048 sc1
  v_bitop3_b32 v18, v18, v40, v2 bitop3:0xf6
  v_bitop3_b32 v18, v18, v42, v2 bitop3:0xf6
  s_waitcnt vmcnt(7)
  v_mfma_f32_16x16x32_bf16 v[64:67], v[44:47], v[28:31], v[64:67]
  buffer_load_dwordx4 v[100:103], v8, s[40:43], s88 offen offset:3072 sc1
  v_bitop3_b32 v18, v18, v44, v2 bitop3:0xf6
  v_bitop3_b32 v18, v18, v46, v2 bitop3:0xf6
  s_waitcnt vmcnt(7)
  v_mfma_f32_16x16x32_bf16 v[64:67], v[48:51], v[28:31], v[64:67]
  buffer_load_dwordx4 v[104:107], v8, s[40:43], s89 offen offset:0 sc1
  v_bitop3_b32 v18, v18, v48, v2 bitop3:0xf6
  v_bitop3_b32 v18, v18, v50, v2 bitop3:0xf6
  s_waitcnt vmcnt(7)
  v_mfma_f32_16x16x32_bf16 v[64:67], v[52:55], v[28:31], v[64:67]
  buffer_load_dwordx4 v[108:111], v8, s[40:43], s89 offen offset:1024 sc1
  v_bitop3_b32 v18, v18, v52, v2 bitop3:0xf6
  v_bitop3_b32 v18, v18, v54, v2 bitop3:0xf6
  s_waitcnt vmcnt(7)
  v_mfma_f32_16x16x32_bf16 v[64:67], v[56:59], v[28:31], v[64:67]
  buffer_load_dwordx4 v[112:115], v8, s[40:43], s89 offen offset:2048 sc1
  v_bitop3_b32 v18, v18, v56, v2 bitop3:0xf6
  v_bitop3_b32 v18, v18, v58, v2 bitop3:0xf6
  s_waitcnt vmcnt(7)
  v_mfma_f32_16x16x32_bf16 v[64:67], v[60:63], v[28:31], v[64:67]
  buffer_load_dwordx4 v[116:119], v8, s[40:43], s89 offen offset:3072 sc1
  v_bitop3_b32 v18, v18, v60, v2 bitop3:0xf6
  v_bitop3_b32 v18, v18, v62, v2 bitop3:0xf6
  v_and_b32 v18, 1, v18
  v_cmp_ne_u32 vcc, 0, v18
  s_cbranch_vccz L_rj_50
  s_sub_u32 s47, s47, 1
  s_cbranch_scc1 L_abort
  s_waitcnt vmcnt(7)
  v_mfma_f32_16x16x32_bf16 v[64:67], v[88:91], v[28:31], 0
  buffer_load_dwordx4 v[32:35], v8, s[40:43], s88 offen offset:0 sc1
  v_xor_b32 v18, v88, v2
  v_bitop3_b32 v18, v18, v90, v2 bitop3:0xf6
  s_waitcnt vmcnt(7)
  v_mfma_f32_16x16x32_bf16 v[64:67], v[92:95], v[28:31], v[64:67]
  buffer_load_dwordx4 v[36:39], v8, s[40:43], s88 offen offset:1024 sc1
  v_bitop3_b32 v18, v18, v92, v2 bitop3:0xf6
  v_bitop3_b32 v18, v18, v94, v2 bitop3:0xf6
  s_waitcnt vmcnt(7)
  v_mfma_f32_16x16x32_bf16 v[64:67], v[96:99], v[28:31], v[64:67]
  buffer_load_dwordx4 v[40:43], v8, s[40:43], s88 offen offset:2048 sc1
  v_bitop3_b32 v18, v18, v96, v2 bitop3:0xf6
  v_bitop3_b32 v18, v18, v98, v2 bitop3:0xf6
  s_waitcnt vmcnt(7)
  v_mfma_f32_16x16x32_bf16 v[64:67], v[100:103], v[28:31], v[64:67]
  buffer_load_dwordx4 v[44:47], v8, s[40:43], s88 offen offset:3072 sc1
  v_bitop3_b32 v18, v18, v100, v2 bitop3:0xf6
  v_bitop3_b32 v18, v18, v102, v2 bitop3:0xf6
  s_waitcnt vmcnt(7)
  v_mfma_f32_16x16x32_bf16 v[64:67], v[104:107], v[28:31], v[64:67]
  buffer_load_dwordx4 v[48:51], v8, s[40:43], s89 offen offset:0 sc1
  v_bitop3_b32 v18, v18, v104, v2 bitop3:0xf6
  v_bitop3_b32 v18, v18, v106, v2 bitop3:0xf6
  s_waitcnt vmcnt(7)
  v_mfma_f32_16x16x32_bf16 v[64:67], v[108:111], v[28:31], v[64:67]
  buffer_load_dwordx4 v[52:55], v8, s[40:43], s89 offen offset:1024 sc1
  v_bitop3_b32 v18, v18, v108, v2 bitop3:0xf6
  v_bitop3_b32 v18, v18, v110, v2 bitop3:0xf6
  s_waitcnt vmcnt(7)
  v_mfma_f32_16x16x32_bf16 v[64:67], v[112:115], v[28:31], v[64:67]
  buffer_load_dwordx4 v[56:59], v8, s[40:43], s89 offen offset:2048 sc1
  v_bitop3_b32 v18, v18, v112, v2 bitop3:0xf6
  v_bitop3_b32 v18, v18, v114, v2 bitop3:0xf6
  s_waitcnt vmcnt(7)
  v_mfma_f32_16x16x32_bf16 v[64:67], v[116:119], v[28:31], v[64:67]
  buffer_load_dwordx4 v[60:63], v8, s[40:43], s89 offen offset:3072 sc1
  v_bitop3_b32 v18, v18, v116, v2 bitop3:0xf6
  v_bitop3_b32 v18, v18, v118, v2 bitop3:0xf6
  v_and_b32 v18, 1, v18
  v_cmp_ne_u32 vcc, 0, v18
  s_cbranch_vccnz L_ra_48
L_rj_50:
  s_nop 2
  v_cvt_pk_bf16_f32 v68, v64, v65
  v_cvt_pk_bf16_f32 v69, v66, v67
  v_cvt_pk_bf16_f32 v71, v66, v67
  v_min_u32 v64, s61, v68
  v_mov_b32 v70, v68
  v_and_or_b32 v68, v68, s61, v0
  v_mov_b32 v65, v69
  v_permlane16_swap_b32 v69, v71
  v_permlane16_swap_b32 v68, v70
  s_mov_b64 exec, s[98:99]
  buffer_store_dwordx4 v[68:71], v15, s[40:43], s91 offen sc1
  s_mov_b64 exec, s[96:97]
  buffer_store_dwordx2 v[64:65], v15, s[40:43], s90 offen sc1
  s_mov_b64 exec, -1
  s_barrier
  s_waitcnt vmcnt(2)
L_rbar_47:
  ds_read_b128 v[88:91], v13 offset:0
  ds_read_b128 v[92:95], v13 offset:1024
  ds_read_b128 v[96:99], v13 offset:2048
  ds_read_b128 v[100:103], v13 offset:3072
  ds_read_b128 v[104:107], v13 offset:4096
  ds_read_b128 v[108:111], v13 offset:5120
  ds_read_b128 v[112:115], v13 offset:6144
  ds_read_b128 v[116:119], v13 offset:7168
  buffer_load_dwordx4 v[48:51], v19, s[40:43], s54 offen sc1
  buffer_load_dwordx4 v[52:55], v19, s[40:43], s54 offen offset:1024 sc1
  buffer_load_dwordx4 v[32:35], v8, s[40:43], s53 offen sc1
  buffer_load_dwordx4 v[36:39], v8, s[40:43], s53 offen offset:1024 sc1
  s_cmp_lt_u32 s49, 63
  s_cbranch_scc1 L_cstep_37
  s_branch L_end
L_side_49:
  s_mov_b32 s46, s50
  s_mov_b32 s50, s51
  s_mov_b32 s51, s52
  s_mov_b32 s52, s46
  s_add_u32 s49, s49, 1
  s_add_u32 s53, s50, 77660160
  s_add_u32 s54, s53, 0
  s_mov_b32 s47, 262144
  v_mov_b64 v[72:73], 0
  v_mov_b64 v[74:75], 0
  v_mov_b64 v[76:77], 0
  v_mov_b64 v[78:79], 0
  v_mov_b64 v[80:81], 0
  v_mov_b64 v[82:83], 0
  v_mov_b64 v[84:85], 0
  v_mov_b64 v[86:87], 0
  v_mov_b32 v120, v17
  v_mov_b32 v121, v17
  v_mov_b32 v122, v17
  v_mov_b32 v123, v17
  s_waitcnt vmcnt(0)
  s_barrier
  s_branch L_rbar_47
L_vm_45:
  buffer_load_dwordx4 v[116:119], v8, s[40:43], s93 offen sc1
  s_waitcnt vmcnt(1)
  v_xor_b32 v18, v32, v2
  v_and_b32 v18, 1, v18
  v_cmp_ne_u32 vcc, 0, v18
  s_cbranch_vccz L_vmb_51
  buffer_load_dwordx4 v[32:35], v8, s[40:43], s93 offen sc1
  s_sub_u32 s47, s47, 1
  s_cbranch_scc1 L_abort
  s_waitcnt vmcnt(1)
  v_xor_b32 v18, v116, v2
  v_and_b32 v18, 1, v18
  v_cmp_ne_u32 vcc, 0, v18
  s_cbranch_vccnz L_vm_45
  s_branch L_vmj_46
L_vmb_51:
  v_mov_b64 v[116:117], v[32:33]
  v_mov_b64 v[118:119], v[34:35]
  s_nop 0
  s_branch L_vmj_46
L_m2_53:
  s_sub_u32 s47, s47, 1
  s_cbranch_scc1 L_abort
  s_waitcnt vmcnt(3)
L_mp_43:
  buffer_load_dwordx4 v[48:51], v19, s[40:43], s54 offen sc1
  buffer_load_dwordx4 v[52:55], v19, s[40:43], s54 offen offset:1024 sc1
  buffer_load_dwordx4 v[32:35], v8, s[40:43], s53 offen sc1
  buffer_load_dwordx4 v[36:39], v8, s[40:43], s53 offen offset:1024 sc1
  s_waitcnt vmcnt(6)
  ds_write_b128 v19, v[56:59]
  ds_write_b128 v19, v[60:63] offset:1024
  v_max3_u32 v18, v56, v58, v60
  s_waitcnt vmcnt(4)
  v_max3_u32 v18, v18, v62, v64
  v_max3_u32 v18, v18, v66, v68
  v_max_u32 v18, v18, v70
  v_cmp_eq_u32 vcc, -1, v18
  s_cbranch_vccz L_mb_52
  s_waitcnt vmcnt(3)
  buffer_load_dwordx4 v[56:59], v19, s[40:43], s54 offen sc1
  buffer_load_dwordx4 v[60:63], v19, s[40:43], s54 offen offset:1024 sc1
  buffer_load_dwordx4 v[64:67], v8, s[40:43], s53 offen sc1
  buffer_load_dwordx4 v[68:71], v8, s[40:43], s53 offen offset:1024 sc1
  s_waitcnt vmcnt(6)
  ds_write_b128 v19, v[48:51]
  ds_write_b128 v19, v[52:55] offset:1024
  v_max3_u32 v18, v48, v50, v52
  s_waitcnt vmcnt(4)
  v_max3_u32 v18, v18, v54, v32
  v_max3_u32 v18, v18, v34, v36
  v_max_u32 v18, v18, v38
  v_cmp_eq_u32 vcc, -1, v18
  s_cbranch_vccnz L_m2_53
  s_branch L_mx_54
L_mb_52:
  v_mov_b64 v[32:33], v[64:65]
  v_mov_b64 v[34:35], v[66:67]
  v_mov_b64 v[36:37], v[68:69]
  v_mov_b64 v[38:39], v[70:71]
L_mx_54:
  s_branch L_mj_44
L_fslow_39:
  s_lshr_b32 s46, s62, 2
  s_lshl_b32 s46, s46, 5
  s_add_u32 s46, s46, s48
  s_lshl_b32 s46, s46, 2
  s_and_b32 s47, s62, 3
  s_add_u32 s46, s46, s47
  s_lshl_b32 s46, s46, 2
  s_add_u32 s46, s46, 78725120
  s_mov_b32 s47, 262144
L_fs_55:
  buffer_load_dword v16, v3, s[40:43], s46 offen sc1
  s_waitcnt vmcnt(0)
  s_sub_u32 s47, s47, 1
  s_cbranch_scc1 L_abort
  v_cmp_eq_u32 vcc, 0, v16
  s_cbranch_vccnz L_fs_55
  s_mov_b32 s47, 262144
  s_branch L_fok_40
L_helper:
  s_sub_u32 s48, s45, 32
  v_and_b32 v4, 15, v1
  v_lshrrev_b32 v5, 4, v1
  v_lshrrev_b32 v6, 2, v4
  v_and_b32 v7, 3, v1
  v_lshlrev_b32 v8, 4, v1
  v_mov_b32 v9, 0x4444
  v_mov_b32 v18, 0xeeee
  v_cmp_lt_u32 vcc, 7, v4
  s_nop 1
  v_cndmask_b32 v9, v9, v18, vcc
  v_mov_b32 v20, 0
  v_mov_b32 v21, 0
  v_mov_b32 v22, 0
  v_mov_b32 v23, 0
  v_lshlrev_b32 v18, 4, v0
  s_lshl_b32 s46, s48, 12
  s_add_u32 s46, s46, 78643200
  buffer_store_dwordx4 v[20:23], v18, s[40:43], s46 offen sc1
  s_lshr_b32 s55, s48, 1
  s_add_u32 s46, s55, 16
  s_bitcmp1_b32 s48, 0
  s_cselect_b32 s55, s46, s55
  s_cmp_ge_u32 s55, 18
  s_cbranch_scc1 L_np_56
  s_cmp_lg_u32 s44, 0
  s_cbranch_scc1 L_np_56
  s_mov_b64 exec, 1
  v_mov_b32 v19, -1
  s_mov_b32 s53, -1
  s_mov_b32 s54, -1
  s_lshl_b32 s0, s55, 14
  s_add_u32 s0, s0, 76546048
  s_add_u32 s1, s0, 8192
  s_memtime s[64:65]
  s_waitcnt lgkmcnt(0)
  buffer_store_dword v19, v3, s[40:43], s0 offen offset:0 sc1
  s_waitcnt vmcnt(0)
  s_memtime s[66:67]
  s_waitcnt lgkmcnt(0)
  s_sub_u32 s46, s66, s64
  s_min_u32 s53, s53, s46
  s_memtime s[64:65]
  s_waitcnt lgkmcnt(0)
  buffer_store_dword v19, v3, s[40:43], s1 offen offset:0 sc1
  s_waitcnt vmcnt(0)
  s_memtime s[66:67]
  s_waitcnt lgkmcnt(0)
  s_sub_u32 s46, s66, s64
  s_min_u32 s54, s54, s46
  s_memtime s[64:65]
  s_waitcnt lgkmcnt(0)
  buffer_store_dword v19, v3, s[40:43], s0 offen offset:256 sc1
  s_waitcnt vmcnt(0)
  s_memtime s[66:67]
  s_waitcnt lgkmcnt(0)
  s_sub_u32 s46, s66, s64
  s_min_u32 s53, s53, s46
  s_memtime s[64:65]
  s_waitcnt lgkmcnt(0)
  buffer_store_dword v19, v3, s[40:43], s1 offen offset:256 sc1
  s_waitcnt vmcnt(0)
  s_memtime s[66:67]
  s_waitcnt lgkmcnt(0)
  s_sub_u32 s46, s66, s64
  s_min_u32 s54, s54, s46
  s_memtime s[64:65]
  s_waitcnt lgkmcnt(0)
  buffer_store_dword v19, v3, s[40:43], s0 offen offset:512 sc1
  s_waitcnt vmcnt(0)
  s_memtime s[66:67]
  s_waitcnt lgkmcnt(0)
  s_sub_u32 s46, s66, s64
  s_min_u32 s53, s53, s46
  s_memtime s[64:65]
  s_waitcnt lgkmcnt(0)
  buffer_store_dword v19, v3, s[40:43], s1 offen offset:512 sc1
  s_waitcnt vmcnt(0)
  s_memtime s[66:67]
  s_waitcnt lgkmcnt(0)
  s_sub_u32 s46, s66, s64
  s_min_u32 s54, s54, s46
  s_memtime s[64:65]
  s_waitcnt lgkmcnt(0)
  buffer_store_dword v19, v3, s[40:43], s0 offen offset:768 sc1
  s_waitcnt vmcnt(0)
  s_memtime s[66:67]
  s_waitcnt lgkmcnt(0)
  s_sub_u32 s46, s66, s64
  s_min_u32 s53, s53, s46
  s_memtime s[64:65]
  s_waitcnt lgkmcnt(0)
  buffer_store_dword v19, v3, s[40:43], s1 offen offset:768 sc1
  s_waitcnt vmcnt(0)
  s_memtime s[66:67]
  s_waitcnt lgkmcnt(0)
  s_sub_u32 s46, s66, s64
  s_min_u32 s54, s54, s46
  s_cmp_le_u32 s53, s54
  s_cselect_b32 s46, 0, 1
  s_lshl_b32 s46, s46, s55
  v_mov_b32 v18, s46
  buffer_atomic_or v18, v3, s[36:39], 0 offen offset:44
  s_mov_b64 exec, -1
L_np_56:
  v_and_b32 v18, 1, v5
  s_lshl_b32 s46, s44, 1
  v_or_b32 v19, s46, v18
  v_lshlrev_b32 v19, 1, v19
  v_xor_b32 v19, v19, v4
  s_lshl_b32 s46, s44, 2
  v_add_u32 v26, s46, v5
  v_lshlrev_b32 v20, 13, v26
  v_lshl_add_u32 v20, v19, 4, v20
  v_lshlrev_b32 v19, 2, v18
  v_xor_b32 v19, v19, v4
  v_mul_u32_u24 v21, 1280, v26
  v_xor_b32 v27, 8, v19
  v_lshl_add_u32 v22, v27, 4, v21
  v_lshl_add_u32 v21, v19, 4, v21
  v_lshrrev_b32 v18, 1, v5
  v_and_b32 v19, 1, v5
  v_lshrrev_b32 v26, 1, v6
  v_and_b32 v27, 1, v6
  v_lshlrev_b32 v28, 4, v18
  v_lshl_add_u32 v28, v19, 2, v28
  v_lshl_add_u32 v28, v26, 3, v28
  v_add_u32 v28, v28, v27
  v_lshlrev_b32 v28, 8, v28
  v_lshl_add_u32 v28, v7, 3, v28
  v_lshl_add_u32 v29, v19, 1, v27
  v_lshl_add_u32 v29, v26, 2, v29
  s_lshl_b32 s46, s44, 1
  v_xor_b32 v29, s46, v29
  v_lshl_add_u32 v23, v29, 5, v28
  v_xor_b32 v29, 1, v29
  v_lshl_add_u32 v24, v29, 5, v28
  v_lshlrev_b32 v28, 4, v19
  v_lshl_add_u32 v28, v18, 2, v28
  v_add_u32 v28, v28, v27
  v_lshlrev_b32 v28, 8, v28
  v_lshl_add_u32 v28, v7, 3, v28
  v_lshlrev_b32 v29, 1, v27
  v_lshl_add_u32 v29, v19, 2, v29
  v_add_u32 v30, s46, v26
  v_xor_b32 v29, v29, v30
  v_lshl_add_u32 v25, v29, 5, v28
  v_add_u32 v26, 0x10000, v23
  v_add_u32 v27, 0x10000, v24
  v_add_u32 v28, 0x10000, v25
  s_lshl_b32 s60, s44, 10
  s_lshl_b32 s0, s48, 8
  s_mul_i32 s1, s48, 163840
  s_add_u32 m0, s60, 0
  s_add_u32 s2, s0, 0
  buffer_load_dwordx4 v20, s[24:27], s2 offen lds
  s_add_u32 m0, s60, 4096
  s_add_u32 s2, s0, 131072
  buffer_load_dwordx4 v20, s[24:27], s2 offen lds
  s_add_u32 m0, s60, 8192
  s_add_u32 s2, s0, 262144
  buffer_load_dwordx4 v20, s[24:27], s2 offen lds
  s_add_u32 m0, s60, 12288
  s_add_u32 s2, s0, 393216
  buffer_load_dwordx4 v20, s[24:27], s2 offen lds
  s_add_u32 m0, s60, 16384
  s_add_u32 s2, s0, 524288
  buffer_load_dwordx4 v20, s[24:27], s2 offen lds
  s_add_u32 m0, s60, 20480
  s_add_u32 s2, s0, 655360
  buffer_load_dwordx4 v20, s[24:27], s2 offen lds
  s_add_u32 m0, s60, 24576
  s_add_u32 s2, s0, 786432
  buffer_load_dwordx4 v20, s[24:27], s2 offen lds
  s_add_u32 m0, s60, 28672
  s_add_u32 s2, s0, 917504
  buffer_load_dwordx4 v20, s[24:27], s2 offen lds
  s_add_u32 m0, s60, 32768
  s_add_u32 s2, s0, 1048576
  buffer_load_dwordx4 v20, s[24:27], s2 offen lds
  s_add_u32 m0, s60, 36864
  s_add_u32 s2, s0, 1179648
  buffer_load_dwordx4 v20, s[24:27], s2 offen lds
  s_add_u32 m0, s60, 40960
  s_add_u32 s2, s0, 1310720
  buffer_load_dwordx4 v20, s[24:27], s2 offen lds
  s_add_u32 m0, s60, 45056
  s_add_u32 s2, s0, 1441792
  buffer_load_dwordx4 v20, s[24:27], s2 offen lds
  s_add_u32 m0, s60, 49152
  s_add_u32 s2, s0, 1572864
  buffer_load_dwordx4 v20, s[24:27], s2 offen lds
  s_add_u32 m0, s60, 53248
  s_add_u32 s2, s0, 1703936
  buffer_load_dwordx4 v20, s[24:27], s2 offen lds
  s_add_u32 m0, s60, 57344
  s_add_u32 s2, s0, 1835008
  buffer_load_dwordx4 v20, s[24:27], s2 offen lds
  s_add_u32 m0, s60, 61440
  s_add_u32 s2, s0, 1966080
  buffer_load_dwordx4 v20, s[24:27], s2 offen lds
  s_add_u32 m0, s60, 65536
  s_add_u32 s2, s0, 2097152
  buffer_load_dwordx4 v20, s[24:27], s2 offen lds
  s_add_u32 m0, s60, 69632
  s_add_u32 s2, s0, 2228224
  buffer_load_dwordx4 v20, s[24:27], s2 offen lds
  s_add_u32 m0, s60, 73728
  s_add_u32 s2, s0, 2359296
  buffer_load_dwordx4 v20, s[24:27], s2 offen lds
  s_add_u32 m0, s60, 77824
  s_add_u32 s2, s0, 2490368
  buffer_load_dwordx4 v20, s[24:27], s2 offen lds
  s_add_u32 m0, s60, 81920
  s_add_u32 s2, s0, 2621440
  buffer_load_dwordx4 v20, s[24:27], s2 offen lds
  s_add_u32 m0, s60, 86016
  s_add_u32 s2, s0, 2752512
  buffer_load_dwordx4 v20, s[24:27], s2 offen lds
  s_add_u32 m0, s60, 90112
  s_add_u32 s2, s0, 2883584
  buffer_load_dwordx4 v20, s[24:27], s2 offen lds
  s_add_u32 m0, s60, 94208
  s_add_u32 s2, s0, 3014656
  buffer_load_dwordx4 v20, s[24:27], s2 offen lds
  s_add_u32 m0, s60, 98304
  s_add_u32 s2, s0, 3145728
  buffer_load_dwordx4 v20, s[24:27], s2 offen lds
  s_add_u32 m0, s60, 102400
  s_add_u32 s2, s0, 3276800
  buffer_load_dwordx4 v20, s[24:27], s2 offen lds
  s_add_u32 m0, s60, 106496
  s_add_u32 s2, s0, 3407872
  buffer_load_dwordx4 v20, s[24:27], s2 offen lds
  s_add_u32 m0, s60, 110592
  s_add_u32 s2, s0, 3538944
  buffer_load_dwordx4 v20, s[24:27], s2 offen lds
  s_add_u32 m0, s60, 114688
  s_add_u32 s2, s0, 3670016
  buffer_load_dwordx4 v20, s[24:27], s2 offen lds
  s_add_u32 m0, s60, 118784
  s_add_u32 s2, s0, 3801088
  buffer_load_dwordx4 v20, s[24:27], s2 offen lds
  s_add_u32 m0, s60, 122880
  s_add_u32 s2, s0, 3932160
  buffer_load_dwordx4 v20, s[24:27], s2 offen lds
  s_add_u32 m0, s60, 126976
  s_add_u32 s2, s0, 4063232
  buffer_load_dwordx4 v20, s[24:27], s2 offen lds
  s_waitcnt vmcnt(28) lgkmcnt(0)
  s_barrier
  s_cmp_lg_u32 s44, 0
  s_cbranch_scc1 L_si_57
  s_mov_b64 exec, 1
  v_mov_b32 v18, 1
  buffer_atomic_add v18, v3, s[36:39], 0 offen offset:40
  s_mov_b64 exec, -1
L_si_57:
  ds_read_b64_tr_b16 a[0:1], v23 offset:0
  ds_read_b64_tr_b16 a[2:3], v23 offset:512
  ds_read_b64_tr_b16 a[4:5], v23 offset:8192
  ds_read_b64_tr_b16 a[6:7], v23 offset:8704
  ds_read_b64_tr_b16 a[8:9], v24 offset:0
  ds_read_b64_tr_b16 a[10:11], v24 offset:512
  ds_read_b64_tr_b16 a[12:13], v24 offset:8192
  ds_read_b64_tr_b16 a[14:15], v24 offset:8704
  s_waitcnt vmcnt(24) lgkmcnt(0)
  s_barrier
  s_add_u32 m0, s60, 0
  s_add_u32 s2, s0, 4194304
  buffer_load_dwordx4 v20, s[24:27], s2 offen lds
  s_add_u32 m0, s60, 4096
  s_add_u32 s2, s0, 4325376
  buffer_load_dwordx4 v20, s[24:27], s2 offen lds
  s_add_u32 m0, s60, 8192
  s_add_u32 s2, s0, 4456448
  buffer_load_dwordx4 v20, s[24:27], s2 offen lds
  s_add_u32 m0, s60, 12288
  s_add_u32 s2, s0, 4587520
  buffer_load_dwordx4 v20, s[24:27], s2 offen lds
  ds_read_b64_tr_b16 a[16:17], v23 offset:16384
  ds_read_b64_tr_b16 a[18:19], v23 offset:16896
  ds_read_b64_tr_b16 a[20:21], v23 offset:24576
  ds_read_b64_tr_b16 a[22:23], v23 offset:25088
  ds_read_b64_tr_b16 a[24:25], v24 offset:16384
  ds_read_b64_tr_b16 a[26:27], v24 offset:16896
  ds_read_b64_tr_b16 a[28:29], v24 offset:24576
  ds_read_b64_tr_b16 a[30:31], v24 offset:25088
  s_waitcnt vmcnt(24) lgkmcnt(0)
  s_barrier
  s_add_u32 m0, s60, 16384
  s_add_u32 s2, s0, 4718592
  buffer_load_dwordx4 v20, s[24:27], s2 offen lds
  s_add_u32 m0, s60, 20480
  s_add_u32 s2, s0, 4849664
  buffer_load_dwordx4 v20, s[24:27], s2 offen lds
  s_add_u32 m0, s60, 24576
  s_add_u32 s2, s0, 4980736
  buffer_load_dwordx4 v20, s[24:27], s2 offen lds
  s_add_u32 m0, s60, 28672
  s_add_u32 s2, s0, 5111808
  buffer_load_dwordx4 v20, s[24:27], s2 offen lds
  ds_read_b64_tr_b16 a[32:33], v23 offset:32768
  ds_read_b64_tr_b16 a[34:35], v23 offset:33280
  ds_read_b64_tr_b16 a[36:37], v23 offset:40960
  ds_read_b64_tr_b16 a[38:39], v23 offset:41472
  ds_read_b64_tr_b16 a[40:41], v24 offset:32768
  ds_read_b64_tr_b16 a[42:43], v24 offset:33280
  ds_read_b64_tr_b16 a[44:45], v24 offset:40960
  ds_read_b64_tr_b16 a[46:47], v24 offset:41472
  s_waitcnt vmcnt(24) lgkmcnt(0)
  s_barrier
  s_add_u32 m0, s60, 32768
  s_add_u32 s2, s0, 0
  buffer_load_dwordx4 v20, s[20:23], s2 offen lds
  s_add_u32 m0, s60, 36864
  s_add_u32 s2, s0, 131072
  buffer_load_dwordx4 v20, s[20:23], s2 offen lds
  s_add_u32 m0, s60, 40960
  s_add_u32 s2, s0, 262144
  buffer_load_dwordx4 v20, s[20:23], s2 offen lds
  s_add_u32 m0, s60, 45056
  s_add_u32 s2, s0, 393216
  buffer_load_dwordx4 v20, s[20:23], s2 offen lds
  ds_read_b64_tr_b16 a[48:49], v23 offset:49152
  ds_read_b64_tr_b16 a[50:51], v23 offset:49664
  ds_read_b64_tr_b16 a[52:53], v23 offset:57344
  ds_read_b64_tr_b16 a[54:55], v23 offset:57856
  ds_read_b64_tr_b16 a[56:57], v24 offset:49152
  ds_read_b64_tr_b16 a[58:59], v24 offset:49664
  ds_read_b64_tr_b16 a[60:61], v24 offset:57344
  ds_read_b64_tr_b16 a[62:63], v24 offset:57856
  s_waitcnt vmcnt(24) lgkmcnt(0)
  s_barrier
  s_add_u32 m0, s60, 49152
  s_add_u32 s2, s0, 524288
  buffer_load_dwordx4 v20, s[20:23], s2 offen lds
  s_add_u32 m0, s60, 53248
  s_add_u32 s2, s0, 655360
  buffer_load_dwordx4 v20, s[20:23], s2 offen lds
  s_add_u32 m0, s60, 57344
  s_add_u32 s2, s0, 786432
  buffer_load_dwordx4 v20, s[20:23], s2 offen lds
  s_add_u32 m0, s60, 61440
  s_add_u32 s2, s0, 917504
  buffer_load_dwordx4 v20, s[20:23], s2 offen lds
  ds_read_b64_tr_b16 a[64:65], v26 offset:0
  ds_read_b64_tr_b16 a[66:67], v26 offset:512
  ds_read_b64_tr_b16 a[68:69], v26 offset:8192
  ds_read_b64_tr_b16 a[70:71], v26 offset:8704
  ds_read_b64_tr_b16 a[72:73], v27 offset:0
  ds_read_b64_tr_b16 a[74:75], v27 offset:512
  ds_read_b64_tr_b16 a[76:77], v27 offset:8192
  ds_read_b64_tr_b16 a[78:79], v27 offset:8704
  s_waitcnt vmcnt(24) lgkmcnt(0)
  s_barrier
  s_add_u32 m0, s60, 65536
  s_add_u32 s2, s0, 1048576
  buffer_load_dwordx4 v20, s[20:23], s2 offen lds
  s_add_u32 m0, s60, 69632
  s_add_u32 s2, s0, 1179648
  buffer_load_dwordx4 v20, s[20:23], s2 offen lds
  s_add_u32 m0, s60, 73728
  s_add_u32 s2, s0, 1310720
  buffer_load_dwordx4 v20, s[20:23], s2 offen lds
  s_add_u32 m0, s60, 77824
  s_add_u32 s2, s0, 1441792
  buffer_load_dwordx4 v20, s[20:23], s2 offen lds
  ds_read_b64_tr_b16 a[80:81], v26 offset:16384
  ds_read_b64_tr_b16 a[82:83], v26 offset:16896
  ds_read_b64_tr_b16 a[84:85], v26 offset:24576
  ds_read_b64_tr_b16 a[86:87], v26 offset:25088
  ds_read_b64_tr_b16 a[88:89], v27 offset:16384
  ds_read_b64_tr_b16 a[90:91], v27 offset:16896
  ds_read_b64_tr_b16 a[92:93], v27 offset:24576
  ds_read_b64_tr_b16 a[94:95], v27 offset:25088
  s_waitcnt vmcnt(24) lgkmcnt(0)
  s_barrier
  s_add_u32 m0, s60, 81920
  s_add_u32 s2, s0, 1572864
  buffer_load_dwordx4 v20, s[20:23], s2 offen lds
  s_add_u32 m0, s60, 86016
  s_add_u32 s2, s0, 1703936
  buffer_load_dwordx4 v20, s[20:23], s2 offen lds
  s_add_u32 m0, s60, 90112
  s_add_u32 s2, s0, 1835008
  buffer_load_dwordx4 v20, s[20:23], s2 offen lds
  s_add_u32 m0, s60, 94208
  s_add_u32 s2, s0, 1966080
  buffer_load_dwordx4 v20, s[20:23], s2 offen lds
  ds_read_b64_tr_b16 a[96:97], v26 offset:32768
  ds_read_b64_tr_b16 a[98:99], v26 offset:33280
  ds_read_b64_tr_b16 a[100:101], v26 offset:40960
  ds_read_b64_tr_b16 a[102:103], v26 offset:41472
  ds_read_b64_tr_b16 a[104:105], v27 offset:32768
  ds_read_b64_tr_b16 a[106:107], v27 offset:33280
  ds_read_b64_tr_b16 a[108:109], v27 offset:40960
  ds_read_b64_tr_b16 a[110:111], v27 offset:41472
  s_waitcnt vmcnt(24) lgkmcnt(0)
  s_barrier
  s_add_u32 m0, s60, 98304
  s_add_u32 s2, s0, 2097152
  buffer_load_dwordx4 v20, s[20:23], s2 offen lds
  s_add_u32 m0, s60, 102400
  s_add_u32 s2, s0, 2228224
  buffer_load_dwordx4 v20, s[20:23], s2 offen lds
  s_add_u32 m0, s60, 106496
  s_add_u32 s2, s0, 2359296
  buffer_load_dwordx4 v20, s[20:23], s2 offen lds
  s_add_u32 m0, s60, 110592
  s_add_u32 s2, s0, 2490368
  buffer_load_dwordx4 v20, s[20:23], s2 offen lds
  ds_read_b64_tr_b16 a[112:113], v26 offset:49152
  ds_read_b64_tr_b16 a[114:115], v26 offset:49664
  ds_read_b64_tr_b16 a[116:117], v26 offset:57344
  ds_read_b64_tr_b16 a[118:119], v26 offset:57856
  ds_read_b64_tr_b16 a[120:121], v27 offset:49152
  ds_read_b64_tr_b16 a[122:123], v27 offset:49664
  ds_read_b64_tr_b16 a[124:125], v27 offset:57344
  ds_read_b64_tr_b16 a[126:127], v27 offset:57856
  s_waitcnt vmcnt(24) lgkmcnt(0)
  s_barrier
  s_add_u32 m0, s60, 114688
  s_add_u32 s2, s0, 2621440
  buffer_load_dwordx4 v20, s[20:23], s2 offen lds
  s_add_u32 m0, s60, 118784
  s_add_u32 s2, s0, 2752512
  buffer_load_dwordx4 v20, s[20:23], s2 offen lds
  s_add_u32 m0, s60, 122880
  s_add_u32 s2, s0, 2883584
  buffer_load_dwordx4 v20, s[20:23], s2 offen lds
  s_add_u32 m0, s60, 126976
  s_add_u32 s2, s0, 3014656
  buffer_load_dwordx4 v20, s[20:23], s2 offen lds
  ds_read_b64_tr_b16 a[128:129], v23 offset:0
  ds_read_b64_tr_b16 a[130:131], v23 offset:512
  ds_read_b64_tr_b16 a[132:133], v23 offset:8192
  ds_read_b64_tr_b16 a[134:135], v23 offset:8704
  ds_read_b64_tr_b16 a[136:137], v24 offset:0
  ds_read_b64_tr_b16 a[138:139], v24 offset:512
  ds_read_b64_tr_b16 a[140:141], v24 offset:8192
  ds_read_b64_tr_b16 a[142:143], v24 offset:8704
  s_waitcnt vmcnt(24) lgkmcnt(0)
  s_barrier
  s_add_u32 m0, s60, 0
  s_add_u32 s2, s0, 3145728
  buffer_load_dwordx4 v20, s[20:23], s2 offen lds
  s_add_u32 m0, s60, 4096
  s_add_u32 s2, s0, 3276800
  buffer_load_dwordx4 v20, s[20:23], s2 offen lds
  s_add_u32 m0, s60, 8192
  s_add_u32 s2, s0, 3407872
  buffer_load_dwordx4 v20, s[20:23], s2 offen lds
  s_add_u32 m0, s60, 12288
  s_add_u32 s2, s0, 3538944
  buffer_load_dwordx4 v20, s[20:23], s2 offen lds
  ds_read_b64_tr_b16 a[144:145], v23 offset:16384
  ds_read_b64_tr_b16 a[146:147], v23 offset:16896
  ds_read_b64_tr_b16 a[148:149], v23 offset:24576
  ds_read_b64_tr_b16 a[150:151], v23 offset:25088
  ds_read_b64_tr_b16 a[152:153], v24 offset:16384
  ds_read_b64_tr_b16 a[154:155], v24 offset:16896
  ds_read_b64_tr_b16 a[156:157], v24 offset:24576
  ds_read_b64_tr_b16 a[158:159], v24 offset:25088
  s_waitcnt vmcnt(24) lgkmcnt(0)
  s_barrier
  s_add_u32 m0, s60, 16384
  s_add_u32 s2, s0, 3670016
  buffer_load_dwordx4 v20, s[20:23], s2 offen lds
  s_add_u32 m0, s60, 20480
  s_add_u32 s2, s0, 3801088
  buffer_load_dwordx4 v20, s[20:23], s2 offen lds
  s_add_u32 m0, s60, 24576
  s_add_u32 s2, s0, 3932160
  buffer_load_dwordx4 v20, s[20:23], s2 offen lds
  s_add_u32 m0, s60, 28672
  s_add_u32 s2, s0, 4063232
  buffer_load_dwordx4 v20, s[20:23], s2 offen lds
  ds_read_b64_tr_b16 a[160:161], v23 offset:32768
  ds_read_b64_tr_b16 a[162:163], v23 offset:33280
  ds_read_b64_tr_b16 a[164:165], v23 offset:40960
  ds_read_b64_tr_b16 a[166:167], v23 offset:41472
  ds_read_b64_tr_b16 a[168:169], v24 offset:32768
  ds_read_b64_tr_b16 a[170:171], v24 offset:33280
  ds_read_b64_tr_b16 a[172:173], v24 offset:40960
  ds_read_b64_tr_b16 a[174:175], v24 offset:41472
  s_waitcnt vmcnt(24) lgkmcnt(0)
  s_barrier
  s_add_u32 m0, s60, 32768
  s_add_u32 s2, s0, 4194304
  buffer_load_dwordx4 v20, s[20:23], s2 offen lds
  s_add_u32 m0, s60, 36864
  s_add_u32 s2, s0, 4325376
  buffer_load_dwordx4 v20, s[20:23], s2 offen lds
  s_add_u32 m0, s60, 40960
  s_add_u32 s2, s0, 4456448
  buffer_load_dwordx4 v20, s[20:23], s2 offen lds
  s_add_u32 m0, s60, 45056
  s_add_u32 s2, s0, 4587520
  buffer_load_dwordx4 v20, s[20:23], s2 offen lds
  ds_read_b64_tr_b16 a[176:177], v23 offset:49152
  ds_read_b64_tr_b16 a[178:179], v23 offset:49664
  ds_read_b64_tr_b16 a[180:181], v23 offset:57344
  ds_read_b64_tr_b16 a[182:183], v23 offset:57856
  ds_read_b64_tr_b16 a[184:185], v24 offset:49152
  ds_read_b64_tr_b16 a[186:187], v24 offset:49664
  ds_read_b64_tr_b16 a[188:189], v24 offset:57344
  ds_read_b64_tr_b16 a[190:191], v24 offset:57856
  s_waitcnt vmcnt(24) lgkmcnt(0)
  s_barrier
  s_add_u32 m0, s60, 49152
  s_add_u32 s2, s0, 4718592
  buffer_load_dwordx4 v20, s[20:23], s2 offen lds
  s_add_u32 m0, s60, 53248
  s_add_u32 s2, s0, 4849664
  buffer_load_dwordx4 v20, s[20:23], s2 offen lds
  s_add_u32 m0, s60, 57344
  s_add_u32 s2, s0, 4980736
  buffer_load_dwordx4 v20, s[20:23], s2 offen lds
  s_add_u32 m0, s60, 61440
  s_add_u32 s2, s0, 5111808
  buffer_load_dwordx4 v20, s[20:23], s2 offen lds
  ds_read_b64_tr_b16 a[192:193], v26 offset:0
  ds_read_b64_tr_b16 a[194:195], v26 offset:512
  ds_read_b64_tr_b16 a[196:197], v26 offset:8192
  ds_read_b64_tr_b16 a[198:199], v26 offset:8704
  ds_read_b64_tr_b16 a[200:201], v27 offset:0
  ds_read_b64_tr_b16 a[202:203], v27 offset:512
  ds_read_b64_tr_b16 a[204:205], v27 offset:8192
  ds_read_b64_tr_b16 a[206:207], v27 offset:8704
  s_waitcnt vmcnt(24) lgkmcnt(0)
  s_barrier
  ds_read_b64_tr_b16 a[208:209], v26 offset:16384
  ds_read_b64_tr_b16 a[210:211], v26 offset:16896
  ds_read_b64_tr_b16 a[212:213], v26 offset:24576
  ds_read_b64_tr_b16 a[214:215], v26 offset:25088
  ds_read_b64_tr_b16 a[216:217], v27 offset:16384
  ds_read_b64_tr_b16 a[218:219], v27 offset:16896
  ds_read_b64_tr_b16 a[220:221], v27 offset:24576
  ds_read_b64_tr_b16 a[222:223], v27 offset:25088
  s_waitcnt vmcnt(20) lgkmcnt(0)
  s_barrier
  ds_read_b64_tr_b16 a[224:225], v26 offset:32768
  ds_read_b64_tr_b16 a[226:227], v26 offset:33280
  ds_read_b64_tr_b16 a[228:229], v26 offset:40960
  ds_read_b64_tr_b16 a[230:231], v26 offset:41472
  ds_read_b64_tr_b16 a[232:233], v27 offset:32768
  ds_read_b64_tr_b16 a[234:235], v27 offset:33280
  ds_read_b64_tr_b16 a[236:237], v27 offset:40960
  ds_read_b64_tr_b16 a[238:239], v27 offset:41472
  s_waitcnt vmcnt(16) lgkmcnt(0)
  s_barrier
  ds_read_b64_tr_b16 a[240:241], v26 offset:49152
  ds_read_b64_tr_b16 a[242:243], v26 offset:49664
  ds_read_b64_tr_b16 a[244:245], v26 offset:57344
  ds_read_b64_tr_b16 a[246:247], v26 offset:57856
  ds_read_b64_tr_b16 a[248:249], v27 offset:49152
  ds_read_b64_tr_b16 a[250:251], v27 offset:49664
  ds_read_b64_tr_b16 a[252:253], v27 offset:57344
  ds_read_b64_tr_b16 a[254:255], v27 offset:57856
  s_waitcnt vmcnt(12) lgkmcnt(0)
  s_barrier
  ds_read_b64_tr_b16 v[128:129], v23 offset:0
  ds_read_b64_tr_b16 v[130:131], v23 offset:512
  ds_read_b64_tr_b16 v[132:133], v23 offset:8192
  ds_read_b64_tr_b16 v[134:135], v23 offset:8704
  ds_read_b64_tr_b16 v[136:137], v24 offset:0
  ds_read_b64_tr_b16 v[138:139], v24 offset:512
  ds_read_b64_tr_b16 v[140:141], v24 offset:8192
  ds_read_b64_tr_b16 v[142:143], v24 offset:8704
  s_waitcnt vmcnt(8) lgkmcnt(0)
  s_barrier
  ds_read_b64_tr_b16 v[144:145], v23 offset:16384
  ds_read_b64_tr_b16 v[146:147], v23 offset:16896
  ds_read_b64_tr_b16 v[148:149], v23 offset:24576
  ds_read_b64_tr_b16 v[150:151], v23 offset:25088
  ds_read_b64_tr_b16 v[152:153], v24 offset:16384
  ds_read_b64_tr_b16 v[154:155], v24 offset:16896
  ds_read_b64_tr_b16 v[156:157], v24 offset:24576
  ds_read_b64_tr_b16 v[158:159], v24 offset:25088
  s_waitcnt vmcnt(4) lgkmcnt(0)
  s_barrier
  ds_read_b64_tr_b16 v[160:161], v23 offset:32768
  ds_read_b64_tr_b16 v[162:163], v23 offset:33280
  ds_read_b64_tr_b16 v[164:165], v23 offset:40960
  ds_read_b64_tr_b16 v[166:167], v23 offset:41472
  ds_read_b64_tr_b16 v[168:169], v24 offset:32768
  ds_read_b64_tr_b16 v[170:171], v24 offset:33280
  ds_read_b64_tr_b16 v[172:173], v24 offset:40960
  ds_read_b64_tr_b16 v[174:175], v24 offset:41472
  s_waitcnt vmcnt(0) lgkmcnt(0)
  s_barrier
  ds_read_b64_tr_b16 v[176:177], v23 offset:49152
  ds_read_b64_tr_b16 v[178:179], v23 offset:49664
  ds_read_b64_tr_b16 v[180:181], v23 offset:57344
  ds_read_b64_tr_b16 v[182:183], v23 offset:57856
  ds_read_b64_tr_b16 v[184:185], v24 offset:49152
  ds_read_b64_tr_b16 v[186:187], v24 offset:49664
  ds_read_b64_tr_b16 v[188:189], v24 offset:57344
  ds_read_b64_tr_b16 v[190:191], v24 offset:57856
  s_waitcnt lgkmcnt(0)
  s_barrier
  s_lshl_b32 s46, s48, 11
  s_lshl_b32 s53, s44, 9
  s_add_u32 s46, s46, s53
  v_add_u32 v15, s46, v8
  v_and_b32 v20, 7, v4
  v_lshl_add_u32 v0, v5, 3, v20
  v_lshlrev_b32 v0, 4, v0
  v_add_u32 v0, s46, v0
  v_lshrrev_b32 v18, 1, v5
  v_and_b32 v19, 1, v5
  s_add_u32 s53, s53, 12288
  v_lshl_add_u32 v10, v18, 4, v4
  v_lshlrev_b32 v10, 4, v10
  v_lshl_add_u32 v10, v19, 3, v10
  v_add_u32 v10, s53, v10
  v_lshl_add_u32 v11, v5, 2, v6
  v_lshlrev_b32 v11, 4, v11
  v_and_b32 v20, 1, v7
  v_lshl_add_u32 v11, v20, 3, v11
  v_add_u32 v11, s53, v11
  s_mov_b32 s61, 0xfffffffe
  s_mov_b32 s49, 0
  s_lshl_b32 s46, s44, 10
  v_add_u32 v19, s46, v8
  s_lshl_b32 s46, s44, 9
  s_add_u32 s46, s46, 4096
  v_and_b32 v5, 0x1ff, v8
  v_add_u32 v5, s46, v5
  s_mov_b32 s47, 262144
L_wdbg_58:
  buffer_load_dword v18, v3, s[36:39], 0 offen offset:40 sc1
  s_waitcnt vmcnt(0)
  s_sub_u32 s47, s47, 1
  s_cbranch_scc1 L_abort
  v_cmp_gt_u32 vcc, 64, v18
  s_cbranch_vccnz L_wdbg_58
  buffer_load_dword v18, v3, s[36:39], 0 offen offset:44 sc1
  s_waitcnt vmcnt(0)
  v_readfirstlane_b32 s52, v18
  s_lshr_b32 s55, s48, 1
  s_lshr_b32 s0, s52, s55
  s_and_b32 s0, s0, 1
  s_lshl_b32 s0, s0, 13
  s_lshl_b32 s46, s55, 14
  s_add_u32 s0, s0, s46
  s_add_u32 s0, s0, 76546048
  s_lshr_b32 s50, s52, 16
  s_and_b32 s50, s50, 1
  s_lshl_b32 s50, s50, 13
  s_lshl_b32 s46, 16, 14
  s_add_u32 s50, s50, s46
  s_add_u32 s50, s50, 76546048
  s_lshr_b32 s51, s52, 17
  s_and_b32 s51, s51, 1
  s_lshl_b32 s51, s51, 13
  s_lshl_b32 s46, 17, 14
  s_add_u32 s51, s51, s46
  s_add_u32 s51, s51, 76546048
  s_and_b32 s46, s48, 1
  s_lshl_b32 s46, s46, 12
  s_add_u32 s0, s0, s46
  s_lshl_b32 s46, s44, 10
  s_add_u32 s0, s0, s46
L_hstep_59:
  s_and_b32 s58, s49, 1
  v_mov_b32 v2, s58
  s_lshl_b32 s1, s49, 16
  s_add_u32 s2, s1, 67108864
  s_add_u32 s1, s1, 71303168
  v_mov_b64 v[72:73], 0
  v_mov_b64 v[74:75], 0
  v_mov_b64 v[76:77], 0
  v_mov_b64 v[78:79], 0
  v_mov_b64 v[80:81], 0
  v_mov_b64 v[82:83], 0
  v_mov_b64 v[84:85], 0
  v_mov_b64 v[86:87], 0
  s_add_u32 s53, s50, 0
  s_add_u32 s54, s53, 4096
  s_mov_b32 s47, 262144
  s_mov_b32 s55, s51
  buffer_load_dwordx4 v[100:103], v19, s[40:43], s53 offen sc1
  buffer_load_dwordx4 v[104:107], v5, s[40:43], s53 offen sc1
L_mp_60:
  s_waitcnt vmcnt(1)
  buffer_load_dwordx4 v[108:111], v19, s[40:43], s53 offen sc1
  buffer_load_dwordx4 v[112:115], v5, s[40:43], s53 offen sc1
  s_waitcnt vmcnt(2)
  ds_write_b128 v19, v[100:103]
  v_xor_b32 v18, v100, v2
  ds_write_b128 v5, v[104:107]
  v_bitop3_b32 v18, v18, v104, v2 bitop3:0xf6
  v_and_b32 v18, 1, v18
  v_cmp_ne_u32 vcc, 0, v18
  s_cbranch_vccz L_mj_61
  s_sub_u32 s47, s47, 1
  s_cbranch_scc1 L_abort
  s_waitcnt vmcnt(1)
  buffer_load_dwordx4 v[100:103], v19, s[40:43], s53 offen sc1
  buffer_load_dwordx4 v[104:107], v5, s[40:43], s53 offen sc1
  s_waitcnt vmcnt(2)
  ds_write_b128 v19, v[108:111]
  v_xor_b32 v18, v108, v2
  ds_write_b128 v5, v[112:115]
  v_bitop3_b32 v18, v18, v112, v2 bitop3:0xf6
  v_and_b32 v18, 1, v18
  v_cmp_ne_u32 vcc, 0, v18
  s_cbranch_vccnz L_mp_60
L_mj_61:
  buffer_load_dwordx4 v[56:59], v8, s[40:43], s54 offen offset:2048 sc1
  buffer_load_dwordx4 v[60:63], v8, s[40:43], s54 offen offset:3072 sc1
  buffer_load_dwordx4 v[64:67], v8, s[40:43], s55 offen sc1
  buffer_load_dwordx4 v[68:71], v8, s[40:43], s55 offen offset:1024 sc1
  s_waitcnt lgkmcnt(0)
  s_barrier
  ds_read_b128 v[32:35], v8 offset:0
  ds_read_b128 v[36:39], v8 offset:1024
  ds_read_b128 v[40:43], v8 offset:2048
  ds_read_b128 v[44:47], v8 offset:3072
  ds_read_b128 v[48:51], v8 offset:4096
  ds_read_b128 v[52:55], v8 offset:5120
  s_waitcnt lgkmcnt(5)
  v_smfmac_f32_16x16x64_bf16 v[72:75], v[32:35], a[0:7], v9
  v_smfmac_f32_16x16x64_bf16 v[76:79], v[32:35], a[8:15], v9
  s_waitcnt lgkmcnt(4)
  v_smfmac_f32_16x16x64_bf16 v[72:75], v[36:39], a[16:23], v9
  v_smfmac_f32_16x16x64_bf16 v[76:79], v[36:39], a[24:31], v9
  s_waitcnt lgkmcnt(3)
  v_smfmac_f32_16x16x64_bf16 v[72:75], v[40:43], a[32:39], v9
  v_smfmac_f32_16x16x64_bf16 v[76:79], v[40:43], a[40:47], v9
  buffer_load_dwordx4 v[112:115], v8, s[40:43], s54 offen offset:2048 sc1
  buffer_load_dwordx4 v[116:119], v8, s[40:43], s54 offen offset:3072 sc1
  buffer_load_dwordx4 v[120:123], v8, s[40:43], s55 offen sc1
  buffer_load_dwordx4 v[124:127], v8, s[40:43], s55 offen offset:1024 sc1
  s_waitcnt lgkmcnt(2)
  v_smfmac_f32_16x16x64_bf16 v[72:75], v[44:47], a[48:55], v9
  v_smfmac_f32_16x16x64_bf16 v[76:79], v[44:47], a[56:63], v9
  s_waitcnt lgkmcnt(1)
  v_smfmac_f32_16x16x64_bf16 v[72:75], v[48:51], a[64:71], v9
  v_smfmac_f32_16x16x64_bf16 v[76:79], v[48:51], a[72:79], v9
  s_waitcnt lgkmcnt(0)
  v_smfmac_f32_16x16x64_bf16 v[72:75], v[52:55], a[80:87], v9
  v_smfmac_f32_16x16x64_bf16 v[76:79], v[52:55], a[88:95], v9
L_m2_62:
  s_waitcnt vmcnt(4)
  v_xor_b32 v18, v56, v2
  v_bitop3_b32 v18, v18, v60, v2 bitop3:0xf6
  v_bitop3_b32 v18, v18, v64, v2 bitop3:0xf6
  v_bitop3_b32 v18, v18, v68, v2 bitop3:0xf6
  v_and_b32 v18, 1, v18
  v_cmp_ne_u32 vcc, 0, v18
  s_cbranch_vccz L_mx_64
  buffer_load_dwordx4 v[56:59], v8, s[40:43], s54 offen offset:2048 sc1
  buffer_load_dwordx4 v[60:63], v8, s[40:43], s54 offen offset:3072 sc1
  buffer_load_dwordx4 v[64:67], v8, s[40:43], s55 offen sc1
  buffer_load_dwordx4 v[68:71], v8, s[40:43], s55 offen offset:1024 sc1
  s_sub_u32 s47, s47, 1
  s_cbranch_scc1 L_abort
  s_waitcnt vmcnt(4)
  v_xor_b32 v18, v112, v2
  v_bitop3_b32 v18, v18, v116, v2 bitop3:0xf6
  v_bitop3_b32 v18, v18, v120, v2 bitop3:0xf6
  v_bitop3_b32 v18, v18, v124, v2 bitop3:0xf6
  v_and_b32 v18, 1, v18
  v_cmp_ne_u32 vcc, 0, v18
  s_cbranch_vccz L_mb_63
  buffer_load_dwordx4 v[112:115], v8, s[40:43], s54 offen offset:2048 sc1
  buffer_load_dwordx4 v[116:119], v8, s[40:43], s54 offen offset:3072 sc1
  buffer_load_dwordx4 v[120:123], v8, s[40:43], s55 offen sc1
  buffer_load_dwordx4 v[124:127], v8, s[40:43], s55 offen offset:1024 sc1
  s_branch L_m2_62
L_mb_63:
  v_mov_b64 v[56:57], v[112:113]
  v_mov_b64 v[58:59], v[114:115]
  v_mov_b64 v[60:61], v[116:117]
  v_mov_b64 v[62:63], v[118:119]
  v_mov_b64 v[64:65], v[120:121]
  v_mov_b64 v[66:67], v[122:123]
  v_mov_b64 v[68:69], v[124:125]
  v_mov_b64 v[70:71], v[126:127]
L_mx_64:
  v_smfmac_f32_16x16x64_bf16 v[72:75], v[56:59], a[96:103], v9
  v_smfmac_f32_16x16x64_bf16 v[76:79], v[56:59], a[104:111], v9
  v_smfmac_f32_16x16x64_bf16 v[72:75], v[60:63], a[112:119], v9
  v_smfmac_f32_16x16x64_bf16 v[76:79], v[60:63], a[120:127], v9
  v_smfmac_f32_16x16x64_bf16 v[72:75], v[64:67], a[128:135], v9
  v_smfmac_f32_16x16x64_bf16 v[76:79], v[64:67], a[136:143], v9
  v_smfmac_f32_16x16x64_bf16 v[72:75], v[68:71], a[144:151], v9
  v_smfmac_f32_16x16x64_bf16 v[76:79], v[68:71], a[152:159], v9
  s_nop 6
  v_cvt_pk_bf16_f32 v96, v72, v73
  v_cvt_pk_bf16_f32 v97, v74, v75
  v_and_or_b32 v96, v96, s61, v2
  v_cvt_pk_bf16_f32 v98, v76, v77
  v_cvt_pk_bf16_f32 v99, v78, v79
  buffer_store_dwordx4 v[96:99], v8, s[40:43], s0 offen sc1
  v_smfmac_f32_16x16x64_bf16 v[80:83], v[32:35], a[160:167], v9
  v_smfmac_f32_16x16x64_bf16 v[84:87], v[32:35], a[168:175], v9
  v_smfmac_f32_16x16x64_bf16 v[80:83], v[36:39], a[176:183], v9
  v_smfmac_f32_16x16x64_bf16 v[84:87], v[36:39], a[184:191], v9
  v_permlane32_swap_b32 v72, v76
  v_permlane32_swap_b32 v73, v77
  v_permlane32_swap_b32 v74, v78
  v_permlane32_swap_b32 v75, v79
  v_pk_add_f32 v[72:73], v[72:73], v[76:77]
  v_pk_add_f32 v[74:75], v[74:75], v[78:79]
  v_cvt_pk_bf16_f32 v88, v72, v73
  v_cvt_pk_bf16_f32 v89, v74, v75
  v_cvt_pk_bf16_f32 v90, v72, v73
  v_cvt_pk_bf16_f32 v91, v74, v75
  s_nop 0
  v_permlane32_swap_b32 v88, v90
  v_permlane32_swap_b32 v89, v91
  s_mov_b32 exec_hi, 0
  buffer_store_dwordx4 v[88:91], v15, s[40:43], s1 offen sc1
  s_mov_b64 exec, -1
  v_smfmac_f32_16x16x64_bf16 v[80:83], v[40:43], a[192:199], v9
  v_smfmac_f32_16x16x64_bf16 v[84:87], v[40:43], a[200:207], v9
  v_smfmac_f32_16x16x64_bf16 v[80:83], v[44:47], a[208:215], v9
  v_smfmac_f32_16x16x64_bf16 v[84:87], v[44:47], a[216:223], v9
  v_smfmac_f32_16x16x64_bf16 v[80:83], v[48:51], a[224:231], v9
  v_smfmac_f32_16x16x64_bf16 v[84:87], v[48:51], a[232:239], v9
  v_smfmac_f32_16x16x64_bf16 v[80:83], v[52:55], a[240:247], v9
  v_smfmac_f32_16x16x64_bf16 v[84:87], v[52:55], a[248:255], v9
  v_smfmac_f32_16x16x64_bf16 v[80:83], v[56:59], v[128:135], v9
  v_smfmac_f32_16x16x64_bf16 v[84:87], v[56:59], v[136:143], v9
  v_smfmac_f32_16x16x64_bf16 v[80:83], v[60:63], v[144:151], v9
  v_smfmac_f32_16x16x64_bf16 v[84:87], v[60:63], v[152:159], v9
  v_smfmac_f32_16x16x64_bf16 v[80:83], v[64:67], v[160:167], v9
  v_smfmac_f32_16x16x64_bf16 v[84:87], v[64:67], v[168:175], v9
  v_smfmac_f32_16x16x64_bf16 v[80:83], v[68:71], v[176:183], v9
  v_smfmac_f32_16x16x64_bf16 v[84:87], v[68:71], v[184:191], v9
  s_nop 7
  v_permlane32_swap_b32 v80, v84
  v_permlane32_swap_b32 v81, v85
  v_permlane32_swap_b32 v82, v86
  v_permlane32_swap_b32 v83, v87
  v_pk_add_f32 v[80:81], v[80:81], v[84:85]
  v_pk_add_f32 v[82:83], v[82:83], v[86:87]
  v_cvt_pk_bf16_f32 v84, v80, v81
  v_cvt_pk_bf16_f32 v85, v82, v83
  ds_write_b64 v10, v[84:85]
  s_waitcnt lgkmcnt(0)
  ds_read_b64_tr_b16 v[92:93], v11
  ds_read_b64_tr_b16 v[94:95], v11 offset:256
  s_mov_b32 exec_lo, 0x00ff00ff
  s_mov_b32 exec_hi, 0x00ff00ff
  s_waitcnt lgkmcnt(0)
  buffer_store_dwordx4 v[92:95], v0, s[40:43], s2 offen sc1
  s_mov_b64 exec, -1
  s_waitcnt vmcnt(0)
  s_lshl_b32 s46, s49, 5
  s_add_u32 s46, s46, s48
  s_lshl_b32 s46, s46, 5
  s_add_u32 s46, s46, 78659600
  s_lshl_b32 s53, s44, 2
  s_add_u32 s46, s46, s53
  v_mov_b32 v18, 1
  s_mov_b64 exec, 1
  buffer_store_dword v18, v3, s[40:43], s46 offen sc1
  s_mov_b64 exec, -1
  s_add_u32 s49, s49, 1
  s_cmp_le_u32 s49, 63
  s_cbranch_scc1 L_hstep_59
  s_branch L_end
L_abort:
  s_mov_b64 exec, 1
  v_mov_b32 v3, 0
  v_mov_b32 v4, 1
  buffer_atomic_add v4, v3, s[36:39], 0 offen offset:60
  s_waitcnt vmcnt(0)
L_end:
  s_endpgm
.section .rodata,"a"
.p2align 6
.amdhsa_kernel standalone__memory_aug_recurrent_mem_tr__prompt_kernel
.amdhsa_next_free_vgpr 512
.amdhsa_next_free_sgpr 102
.amdhsa_accum_offset 256
.amdhsa_group_segment_fixed_size 0
.amdhsa_kernarg_size 80
.amdhsa_user_sgpr_count 2
.amdhsa_user_sgpr_kernarg_segment_ptr 1
.amdhsa_system_sgpr_workgroup_id_x 1
.end_amdhsa_kernel
```
